```python
import torch

def _softmax(x, axis=-1):
    return torch.softmax(x, dim=axis)
def _gelu(x):
    return torch.nn.functional.gelu(x, approximate="tanh")
def _silu(x):
    return torch.nn.functional.silu(x)
def _sigmoid(x):
    return torch.sigmoid(x)
def _layernorm(x, axis=-1, eps=1e-5):
    m = x.mean(dim=axis, keepdim=True)
    v = x.var(dim=axis, keepdim=True, unbiased=False)
    return (x - m) / torch.sqrt(v + eps)
def _scatter_add(tgt, idx, src, axis=0):
    return tgt.clone().index_add_(axis, idx, src)
def _segment_sum(src, seg, n):
    out = torch.zeros((n,) + src.shape[1:], dtype=src.dtype)
    return out.index_add_(0, seg, src)
def _pad(x, pw):
    flat = tuple(v for pair in reversed(pw) for v in pair)
    return torch.nn.functional.pad(x, flat)

kernel_name = 'parallel_sum__linear_attn_block__dense_activation_gelu__prompt'

def setup_inputs():

    _w = (lambda a: (lambda t: t.to(torch.bfloat16) if t.is_floating_point() else t)(torch.as_tensor(a)))
    def _A_setup():
        B, S, D = 1, 2048, 448
        return {
            "x": _w((lambda *s: torch.randn(*s, dtype=torch.bfloat16) * 0.05)(B, S, D)),
            "wqkv": _w((lambda *s: torch.randn(*s, dtype=torch.bfloat16) * 0.1)(D, 3 * D)),
            "wo": _w((lambda *s: torch.randn(*s, dtype=torch.bfloat16) * 0.05)(D, D)),
        }
    _A_in = _A_setup()

    def _B_setup():
        B, S, D, F = 1, 2048, 448, 1792
        return {
            "x": _w((lambda *s: torch.randn(*s, dtype=torch.bfloat16) * 0.05)(B, S, D)),
            "w1": _w((lambda *s: torch.randn(*s, dtype=torch.bfloat16) * 0.8)(D, F) * (D ** -0.5)),
            "b1": _w((lambda *s: torch.randn(*s, dtype=torch.bfloat16) * 12.8)(F) * 0.01),
            "w2": _w((lambda *s: torch.randn(*s, dtype=torch.bfloat16) * 0.2)(F, D) * (F ** -0.5)),
            "b2": _w((lambda *s: torch.randn(*s, dtype=torch.bfloat16) * 3.2)(D) * 0.01),
        }
    _B_in = _B_setup()

    return {
        "A_x": _A_in["x"],
        "A_wqkv": _A_in["wqkv"],
        "A_wo": _A_in["wo"],
        "B_x": _B_in["x"],
        "B_w1": _B_in["w1"],
        "B_b1": _B_in["b1"],
        "B_w2": _B_in["w2"],
        "B_b2": _B_in["b2"],
    }

def reference(A_x, A_wqkv, A_wo, B_x, B_w1, B_b1, B_w2, B_b2):
    def _A_ref(x, wqkv, wo):
        B, S, D = x.shape
        H = 16; Dh = D // H
        qkv = (lambda x, *d: x.permute(*d))((x @ wqkv).reshape(B, S, 3, H, Dh), 2, 0, 3, 1, 4)
        q, k, v = qkv[0], qkv[1], qkv[2]
        phi = lambda t: torch.where(t > 0, t + 1, torch.exp(t)) + 1e-6
        pq, pk = phi(q), phi(k)
        kv = torch.einsum("bhsd,bhse->bhde", pk, v)
        z = torch.einsum("bhsd->bhd", pk)
        num = torch.einsum("bhqd,bhde->bhqe", pq, kv)
        den = torch.einsum("bhqd,bhd->bhq", pq, z)[..., None] + 1e-6
        o = num / den
        return (lambda x, *d: x.permute(*d))(o, 0, 2, 1, 3).reshape(B, S, D) @ wo

    def _B_ref(x, w1, b1, w2, b2):
        h = torch.einsum("bsd,df->bsf", x, w1) + b1
        h = _gelu(h)
        return torch.einsum("bsf,fd->bsd", h, w2) + b2

    x = A_x
    xn = _layernorm(x, axis=-1)
    return x + _A_ref(xn, A_wqkv, A_wo) + _B_ref(xn, B_w1, B_b1, B_w2, B_b2)
```

```asm
; @launch grid=(256,1,1) block=(512,1,1) lds=163840
.amdgcn_target "amdgcn-amd-amdhsa--gfx950"
.text
.globl parallel_sum__linear_attn_block__dense_activation_gelu__prompt_kernel
.p2align 8
.type parallel_sum__linear_attn_block__dense_activation_gelu__prompt_kernel,@function
parallel_sum__linear_attn_block__dense_activation_gelu__prompt_kernel:
    s_load_dwordx16 s[36:51], s[0:1], 0
    s_cmpk_ge_u32 s2, 0x100
    s_cbranch_scc1 L_end
    s_lshr_b32 s67, s2, 3
    s_getpc_b64 s[16:17]
L_pc:
    v_lshrrev_b32 v2, 5, v0
    v_lshl_add_u32 v2, s67, 4, v2
    v_lshlrev_b32 v2, 7, v2
    v_min_u32 v2, L_end-L_pc, v2
    global_load_dword v246, v2, s[16:17]
    s_and_b32 s68, s2, 7
    s_lshl_b32 s68, s68, 5
    s_add_u32 s67, s67, s68
    s_and_b32 s65, s2, 6
    s_min_u32 s65, s65, 5
    v_bfe_u32 v3, v0, 5, 3
    v_lshl_add_u32 v3, s67, 3, v3
    v_mul_u32_u24 v3, 7, v3
    v_lshrrev_b32 v4, 8, v0
    v_add3_u32 v3, v3, v4, s65
    v_lshlrev_b32 v3, 7, v3
    s_waitcnt lgkmcnt(0)
    global_load_dword v247, v3, s[36:37]
    s_mov_b32 s76, s67
    s_mulk_i32 s67, 56
    v_lshrrev_b32 v3, 3, v0
    v_min_u32 v3, 55, v3
    v_add_lshl_u32 v3, v3, s67, 7
    global_load_dword v247, v3, s[36:37]
    s_load_dwordx4 s[52:55], s[0:1], 64
    s_load_dwordx2 s[56:57], s[0:1], 80
    v_lshrrev_b32 v1, 6, v0
    v_and_b32 v0, 63, v0
    v_readfirstlane_b32 s3, v1
    v_lshlrev_b32 v1, 4, v0
    s_bfe_u32 s67, s2, 0x20001
    s_and_b32 s68, s2, 1
    s_bfe_u32 s69, s2, 0x20003
    s_lshr_b32 s7, s2, 5
    s_lshl2_add_u32 s5, s67, s69
    s_and_b32 s6, s7, 3
    s_mul_i32 s66, s68, 7
    s_xor_b32 s6, s6, s66
    s_and_b32 s66, s2, 7
    s_lshl2_add_u32 s66, s66, s69
    s_and_b32 s4, s3, 3
    s_lshl_b32 s75, s4, 11
    s_mov_b32 s71, 0x40000
    s_cmp_lt_u32 s3, 4
    s_cbranch_scc1 L_M
    v_lshrrev_b32 v15, 3, v0
    v_lshrrev_b32 v11, 4, v0
    v_and_b32 v10, 7, v0
    v_xor_b32 v12, v10, v11
    v_mul_u32_u24 v13, 896, v15
    v_lshl_add_u32 v240, v12, 4, v13
    v_xor_b32 v241, 64, v240
    v_add_u32 v241, 6144, v241
    v_add_u32 v242, 12288, v240
    v_add_u32 v243, 12288, v241
    s_lshl2_add_u32 s69, s5, s4
    s_mul_i32 s69, s69, 28672
    s_add_u32 s73, s69, 896
    s_lshl_b32 s72, s65, 7
    s_add_u32 s72, s72, s69
    s_mul_i32 s74, s4, 28672
    s_add_u32 s74, s74, 49152
    s_mov_b32 s10, 0x1c0000
    s_mov_b32 s11, 0x20000
    s_mov_b32 s8, s36
    s_mov_b32 s9, s37
    s_add_u32 m0, s74, 0
    s_nop 0
    buffer_load_dwordx4 v240, s[8:11], s72 offen offset:0 lds
    buffer_load_dwordx4 v241, s[8:11], s72 offen offset:1024 lds
    buffer_load_dwordx4 v242, s[8:11], s72 offen offset:2048 lds
    buffer_load_dwordx4 v243, s[8:11], s72 offen offset:3072 lds
    s_add_u32 m0, s74, 4096
    s_add_u32 s72, s72, 128
    s_cmp_ge_u32 s72, s73
    s_cselect_b32 s67, 896, 0
    s_sub_u32 s72, s72, s67
    buffer_load_dwordx4 v240, s[8:11], s72 offen offset:0 lds
    buffer_load_dwordx4 v241, s[8:11], s72 offen offset:1024 lds
    buffer_load_dwordx4 v242, s[8:11], s72 offen offset:2048 lds
    buffer_load_dwordx4 v243, s[8:11], s72 offen offset:3072 lds
    s_add_u32 m0, s74, 8192
    s_add_u32 s72, s72, 128
    s_cmp_ge_u32 s72, s73
    s_cselect_b32 s67, 896, 0
    s_sub_u32 s72, s72, s67
    buffer_load_dwordx4 v240, s[8:11], s72 offen offset:0 lds
    buffer_load_dwordx4 v241, s[8:11], s72 offen offset:1024 lds
    buffer_load_dwordx4 v242, s[8:11], s72 offen offset:2048 lds
    buffer_load_dwordx4 v243, s[8:11], s72 offen offset:3072 lds
    s_bitcmp1_b32 s4, 0
    s_cselect_b64 s[24:25], s[38:39], s[44:45]
    s_cselect_b64 s[32:33], s[40:41], s[48:49]
    s_cselect_b32 s67, 0x62000, 0
    s_cselect_b32 s68, 0x126000, 0
    s_cmp_ge_u32 s4, 2
    s_cselect_b64 s[24:25], s[32:33], s[24:25]
    s_cselect_b32 s67, s68, s67
    s_sub_u32 s26, 0x188000, s67
    s_mov_b32 s27, 0x20000
    v_and_b32 v11, 1, v11
    v_lshlrev_b32 v11, 2, v11
    v_xor_b32 v14, v10, v11
    s_lshl_b32 s69, s4, 4
    s_cmp_eq_u32 s7, 7
    s_cbranch_scc1 L_HM
    s_cmp_ge_u32 s7, 4
    s_cbranch_scc1 L_HA
    s_mov_b32 s12, s44
    s_mov_b32 s13, s45
    s_mov_b32 s14, 0x188000
    s_mov_b32 s15, 0x20000
    v_mov_b32 v16, v14
    v_add_u32 v17, s69, v15
    v_mul_u32_u24 v17, 3584, v17
    v_lshl_add_u32 v2, v16, 4, v17
    v_add_u32 v3, 27648, v2
    s_mul_i32 s69, s6, 448
    s_and_b32 s36, s6, 1
    s_lshl_b32 s67, s36, 6
    s_add_u32 s69, s69, s67
    s_mul_i32 s67, s65, 229376
    s_add_u32 s58, s67, s69
    s_add_u32 s68, s69, 1605632
    s_add_u32 s67, s58, 229376
    s_cmp_eq_u32 s67, s68
    s_cselect_b32 s59, s69, s67
    s_add_u32 s67, s59, 229376
    s_cmp_eq_u32 s67, s68
    s_cselect_b32 s60, s69, s67
    s_add_u32 s67, s60, 229376
    s_cmp_eq_u32 s67, s68
    s_cselect_b32 s61, s69, s67
    s_add_u32 s67, s61, 229376
    s_cmp_eq_u32 s67, s68
    s_cselect_b32 s62, s69, s67
    s_add_u32 s67, s62, 229376
    s_cmp_eq_u32 s67, s68
    s_cselect_b32 s63, s69, s67
    s_add_u32 s67, s63, 229376
    s_cmp_eq_u32 s67, s68
    s_cselect_b32 s64, s69, s67
    s_waitcnt vmcnt(8)
    s_barrier
    s_add_u32 m0, s74, 12288
    s_add_u32 s72, s72, 128
    s_cmp_ge_u32 s72, s73
    s_cselect_b32 s67, 896, 0
    s_sub_u32 s72, s72, s67
    buffer_load_dwordx4 v240, s[8:11], s72 offen offset:0 lds
    buffer_load_dwordx4 v241, s[8:11], s72 offen offset:1024 lds
    buffer_load_dwordx4 v242, s[8:11], s72 offen offset:2048 lds
    buffer_load_dwordx4 v243, s[8:11], s72 offen offset:3072 lds
    s_waitcnt vmcnt(8)
    s_barrier
    s_add_u32 m0, s74, 16384
    s_add_u32 s72, s72, 128
    s_cmp_ge_u32 s72, s73
    s_cselect_b32 s67, 896, 0
    s_sub_u32 s72, s72, s67
    buffer_load_dwordx4 v240, s[8:11], s72 offen offset:0 lds
    buffer_load_dwordx4 v241, s[8:11], s72 offen offset:1024 lds
    buffer_load_dwordx4 v242, s[8:11], s72 offen offset:2048 lds
    buffer_load_dwordx4 v243, s[8:11], s72 offen offset:3072 lds
    s_waitcnt vmcnt(8)
    s_barrier
    s_add_u32 m0, s74, 20480
    s_add_u32 s72, s72, 128
    s_cmp_ge_u32 s72, s73
    s_cselect_b32 s67, 896, 0
    s_sub_u32 s72, s72, s67
    buffer_load_dwordx4 v240, s[8:11], s72 offen offset:0 lds
    buffer_load_dwordx4 v241, s[8:11], s72 offen offset:1024 lds
    buffer_load_dwordx4 v242, s[8:11], s72 offen offset:2048 lds
    buffer_load_dwordx4 v243, s[8:11], s72 offen offset:3072 lds
    s_waitcnt vmcnt(8)
    s_barrier
    s_add_u32 m0, s74, 24576
    s_add_u32 s72, s72, 128
    s_cmp_ge_u32 s72, s73
    s_cselect_b32 s67, 896, 0
    s_sub_u32 s72, s72, s67
    buffer_load_dwordx4 v240, s[8:11], s72 offen offset:0 lds
    buffer_load_dwordx4 v241, s[8:11], s72 offen offset:1024 lds
    buffer_load_dwordx4 v242, s[8:11], s72 offen offset:2048 lds
    buffer_load_dwordx4 v243, s[8:11], s72 offen offset:3072 lds
    s_waitcnt vmcnt(8)
    s_barrier
    s_add_u32 m0, s75, 8192
    s_add_u32 s67, s58, 0
    buffer_load_dwordx4 v2, s[12:15], s67 offen lds
    buffer_load_dwordx4 v3, s[12:15], s67 offen offset:1024 lds
    s_add_u32 m0, s75, 16384
    s_add_u32 s67, s59, 0
    buffer_load_dwordx4 v2, s[12:15], s67 offen lds
    buffer_load_dwordx4 v3, s[12:15], s67 offen offset:1024 lds
    s_waitcnt vmcnt(8)
    s_barrier
    s_add_u32 m0, s75, 24576
    s_add_u32 s67, s60, 0
    buffer_load_dwordx4 v2, s[12:15], s67 offen lds
    buffer_load_dwordx4 v3, s[12:15], s67 offen offset:1024 lds
    s_add_u32 m0, s75, 32768
    s_add_u32 s67, s61, 0
    buffer_load_dwordx4 v2, s[12:15], s67 offen lds
    buffer_load_dwordx4 v3, s[12:15], s67 offen offset:1024 lds
    s_waitcnt vmcnt(8)
    s_barrier
    s_add_u32 m0, s75, 40960
    s_add_u32 s67, s62, 0
    buffer_load_dwordx4 v2, s[12:15], s67 offen lds
    buffer_load_dwordx4 v3, s[12:15], s67 offen offset:1024 lds
    s_bfe_u32 s67, s2, 0x20001
    s_xor_b32 s67, s67, 0
    s_lshr_b32 s68, s2, 3
    s_lshl_b32 s67, s67, 5
    s_add_u32 s67, s67, s68
    s_and_b32 s68, s2, 1
    s_cmp_lg_u32 s4, 0
    s_cbranch_scc1 Lt19
    s_mul_i32 s67, s67, 49
    s_mul_i32 s68, s68, 14
    v_min_u32 v246, 48, v0
    v_add_u32 v246, s67, v246
    v_mul_u32_u24 v247, 37450, v246
    v_lshrrev_b32 v247, 19, v247
    v_mul_u32_u24 v247, 14, v247
    v_add3_u32 v246, v246, v247, s68
    v_lshlrev_b32 v246, 7, v246
    buffer_load_dword v245, v246, s[24:27], 0 offen
Lt19:
    s_cmp_lg_u32 s4, 1
    s_cbranch_scc1 Lt210
    s_mul_i32 s67, s67, 42
    s_mul_i32 s68, s68, 3
    v_min_u32 v246, 41, v0
    v_add_u32 v246, s67, v246
    v_lshrrev_b32 v247, 2, v246
    v_mul_u32_u24 v247, 3, v247
    v_add3_u32 v246, v246, v247, s68
    v_lshlrev_b32 v246, 7, v246
    buffer_load_dword v245, v246, s[24:27], 0 offen
Lt210:
    s_barrier
    s_add_u32 m0, s75, 49152
    s_add_u32 s67, s63, 0
    buffer_load_dwordx4 v2, s[12:15], s67 offen lds
    buffer_load_dwordx4 v3, s[12:15], s67 offen offset:1024 lds
    s_add_u32 m0, s75, 57344
    s_add_u32 s67, s64, 0
    buffer_load_dwordx4 v2, s[12:15], s67 offen lds
    buffer_load_dwordx4 v3, s[12:15], s67 offen offset:1024 lds
    s_add_u32 m0, s75, 65536
    s_add_u32 s67, s58, 128
    buffer_load_dwordx4 v2, s[12:15], s67 offen lds
    buffer_load_dwordx4 v3, s[12:15], s67 offen offset:1024 lds
    s_waitcnt vmcnt(10)
    s_barrier
    s_add_u32 m0, s75, 73728
    s_add_u32 s67, s59, 128
    buffer_load_dwordx4 v2, s[12:15], s67 offen lds
    buffer_load_dwordx4 v3, s[12:15], s67 offen offset:1024 lds
    s_add_u32 m0, s75, 81920
    s_add_u32 s67, s60, 128
    buffer_load_dwordx4 v2, s[12:15], s67 offen lds
    buffer_load_dwordx4 v3, s[12:15], s67 offen offset:1024 lds
    s_waitcnt vmcnt(12)
    s_add_u32 m0, s75, 90112
    s_add_u32 s67, s61, 128
    buffer_load_dwordx4 v2, s[12:15], s67 offen lds
    buffer_load_dwordx4 v3, s[12:15], s67 offen offset:1024 lds
    s_waitcnt vmcnt(12)
    s_add_u32 m0, s75, 98304
    s_add_u32 s67, s62, 128
    buffer_load_dwordx4 v2, s[12:15], s67 offen lds
    buffer_load_dwordx4 v3, s[12:15], s67 offen offset:1024 lds
    s_waitcnt vmcnt(12)
    s_add_u32 m0, s75, 106496
    s_add_u32 s67, s63, 128
    buffer_load_dwordx4 v2, s[12:15], s67 offen lds
    buffer_load_dwordx4 v3, s[12:15], s67 offen offset:1024 lds
    s_cmp_lg_u32 s4, 2
    s_cbranch_scc1 Lt411
    s_xor_b32 s67, s2, 0
    s_mul_i32 s67, s67, 49
    v_min_u32 v246, 48, v0
    v_add_u32 v246, s67, v246
    v_lshlrev_b32 v246, 7, v246
    buffer_load_dword v245, v246, s[24:27], 0 offen
Lt411:
    s_cmp_lg_u32 s4, 3
    s_cbranch_scc1 Lt512
    s_mul_i32 s67, s2, 13
    v_min_u32 v246, 12, v0
    v_add_u32 v246, s67, v246
    v_lshlrev_b32 v246, 7, v246
    buffer_load_dword v245, v246, s[24:27], 0 offen
Lt512:
    s_waitcnt lgkmcnt(0)
    s_add_u32 s20, s56, 0x0
    s_addc_u32 s21, s57, 0
    s_mov_b32 s22, 0xc00000
    s_mov_b32 s23, 0x20000
    s_mov_b32 s28, s54
    s_mov_b32 s29, s55
    s_mov_b32 s30, 0x100
    s_mov_b32 s31, 0x20000
    v_lshrrev_b32 v16, 5, v0
    v_mul_u32_u24 v16, 4, v16
    v_bfe_u32 v17, v0, 2, 2
    v_add_u32 v16, v16, v17
    v_lshlrev_b32 v16, 7, v16
    v_bfe_u32 v17, v0, 4, 1
    v_lshlrev_b32 v17, 5, v17
    v_and_b32 v8, 3, v0
    v_lshl_add_u32 v8, v8, 3, v17
    v_bfe_u32 v17, v0, 3, 1
    v_lshlrev_b32 v17, 6, v17
    v_xor_b32 v8, v8, v17
    v_add_u32 v8, v8, v16
    v_add_u32 v8, s75, v8
    v_add_u32 v9, 0x10000, v8
    v_add_u32 v10, 0x20000, v8
    v_lshrrev_b32 v16, 5, v0
    v_mul_u32_u24 v16, 4, v16
    v_bfe_u32 v17, v0, 2, 2
    v_add_u32 v16, v16, v17
    v_lshlrev_b32 v16, 7, v16
    v_bfe_u32 v17, v0, 4, 1
    v_lshlrev_b32 v17, 5, v17
    v_and_b32 v11, 3, v0
    v_lshl_add_u32 v11, v11, 3, v17
    v_add_u32 v11, 64, v11
    v_bfe_u32 v17, v0, 3, 1
    v_lshlrev_b32 v17, 6, v17
    v_xor_b32 v11, v11, v17
    v_add_u32 v11, v11, v16
    v_add_u32 v11, s75, v11
    v_add_u32 v12, 0x10000, v11
    v_add_u32 v13, 0x20000, v11
    s_mov_b32 s16, s48
    s_mov_b32 s17, s49
    s_mov_b32 s18, 0x188000
    s_mov_b32 s19, 0x20000
    s_mul_i32 s69, s4, 448
    s_lshl_b32 s77, s7, 7
    v_mov_b32 v16, v14
    v_add_u32 v17, s69, v15
    v_mul_u32_u24 v17, 896, v17
    v_lshl_add_u32 v5, v16, 4, v17
    v_add_u32 v6, 6144, v5
    s_lshl_b32 s69, s4, 4
    v_lshrrev_b32 v16, 2, v0
    v_add_u32 v16, s69, v16
    v_mul_u32_u24 v16, 3584, v16
    v_and_b32 v17, 3, v0
    v_lshl_add_u32 v4, v17, 4, v16
    s_mul_i32 s76, s36, 448
    s_sub_u32 s76, 384, s76
    s_barrier
    s_waitcnt vmcnt(12)
    s_add_u32 m0, s75, 114688
    s_add_u32 s67, s64, 128
    buffer_load_dwordx4 v2, s[12:15], s67 offen lds
    buffer_load_dwordx4 v3, s[12:15], s67 offen offset:1024 lds
    s_waitcnt vmcnt(12)
    s_add_u32 m0, s75, 122880
    s_add_u32 s67, s77, 0
    buffer_load_dwordx4 v5, s[16:19], s67 offen lds
    buffer_load_dwordx4 v6, s[16:19], s67 offen offset:1024 lds
    s_waitcnt vmcnt(12)
    s_add_u32 m0, s75, 131072
    s_add_u32 s67, s77, 14336
    buffer_load_dwordx4 v5, s[16:19], s67 offen lds
    buffer_load_dwordx4 v6, s[16:19], s67 offen offset:1024 lds
    s_waitcnt vmcnt(12)
    s_add_u32 m0, s75, 139264
    s_add_u32 s67, s77, 28672
    buffer_load_dwordx4 v5, s[16:19], s67 offen lds
    buffer_load_dwordx4 v6, s[16:19], s67 offen offset:1024 lds
    s_waitcnt vmcnt(12)
    s_add_u32 m0, s75, 147456
    s_add_u32 s67, s77, 43008
    buffer_load_dwordx4 v5, s[16:19], s67 offen lds
    buffer_load_dwordx4 v6, s[16:19], s67 offen offset:1024 lds
    s_waitcnt vmcnt(12)
    s_add_u32 m0, s75, 155648
    s_add_u32 s67, s77, 229376
    buffer_load_dwordx4 v5, s[16:19], s67 offen lds
    buffer_load_dwordx4 v6, s[16:19], s67 offen offset:1024 lds
    s_waitcnt vmcnt(12)
    s_add_u32 m0, s75, 8192
    s_add_u32 s67, s77, 243712
    buffer_load_dwordx4 v5, s[16:19], s67 offen lds
    buffer_load_dwordx4 v6, s[16:19], s67 offen offset:1024 lds
    s_waitcnt vmcnt(12)
    s_add_u32 m0, s75, 16384
    s_add_u32 s67, s77, 258048
    buffer_load_dwordx4 v5, s[16:19], s67 offen lds
    buffer_load_dwordx4 v6, s[16:19], s67 offen offset:1024 lds
    s_waitcnt vmcnt(12)
    ds_read_b64_tr_b16 v[80:81], v9 offset:57344
    ds_read_b64_tr_b16 v[82:83], v9 offset:58368
    ds_read_b64_tr_b16 v[84:85], v12 offset:57344
    ds_read_b64_tr_b16 v[86:87], v12 offset:58368
    s_barrier
    s_buffer_load_dword s56, s[28:31], 0
    s_add_u32 m0, s75, 24576
    s_add_u32 s67, s58, 256
    buffer_load_dwordx4 v2, s[12:15], s67 offen lds
    buffer_load_dwordx4 v3, s[12:15], s67 offen offset:1024 lds
    s_waitcnt vmcnt(12)
    s_add_u32 m0, s75, 32768
    s_add_u32 s67, s59, 256
    buffer_load_dwordx4 v2, s[12:15], s67 offen lds
    buffer_load_dwordx4 v3, s[12:15], s67 offen offset:1024 lds
    s_waitcnt vmcnt(12)
    s_add_u32 m0, s75, 40960
    s_add_u32 s67, s60, 256
    buffer_load_dwordx4 v2, s[12:15], s67 offen lds
    buffer_load_dwordx4 v3, s[12:15], s67 offen offset:1024 lds
    s_waitcnt lgkmcnt(0)
    s_waitcnt vmcnt(12)
    s_add_u32 m0, s75, 122880
    s_add_u32 s67, s61, 256
    buffer_load_dwordx4 v2, s[12:15], s67 offen lds
    buffer_load_dwordx4 v3, s[12:15], s67 offen offset:1024 lds
    ds_read_b64_tr_b16 v[88:89], v10 offset:0
    ds_read_b64_tr_b16 v[90:91], v10 offset:1024
    ds_read_b64_tr_b16 v[92:93], v13 offset:0
    ds_read_b64_tr_b16 v[94:95], v13 offset:1024
    s_waitcnt lgkmcnt(0)
    s_waitcnt vmcnt(12)
    s_add_u32 m0, s75, 131072
    s_add_u32 s67, s77, 272384
    buffer_load_dwordx4 v5, s[16:19], s67 offen lds
    buffer_load_dwordx4 v6, s[16:19], s67 offen offset:1024 lds
    ds_read_b64_tr_b16 v[96:97], v10 offset:8192
    ds_read_b64_tr_b16 v[98:99], v10 offset:9216
    ds_read_b64_tr_b16 v[100:101], v13 offset:8192
    ds_read_b64_tr_b16 v[102:103], v13 offset:9216
    s_waitcnt lgkmcnt(0)
    s_waitcnt vmcnt(12)
    s_add_u32 m0, s75, 139264
    s_add_u32 s67, s77, 57344
    buffer_load_dwordx4 v5, s[16:19], s67 offen lds
    buffer_load_dwordx4 v6, s[16:19], s67 offen offset:1024 lds
    ds_read_b64_tr_b16 v[104:105], v10 offset:16384
    ds_read_b64_tr_b16 v[106:107], v10 offset:17408
    ds_read_b64_tr_b16 v[108:109], v13 offset:16384
    ds_read_b64_tr_b16 v[110:111], v13 offset:17408
    s_waitcnt lgkmcnt(0)
    s_waitcnt vmcnt(12)
    s_add_u32 m0, s75, 147456
    s_add_u32 s67, s77, 71680
    buffer_load_dwordx4 v5, s[16:19], s67 offen lds
    buffer_load_dwordx4 v6, s[16:19], s67 offen offset:1024 lds
    ds_read_b64_tr_b16 v[112:113], v10 offset:24576
    ds_read_b64_tr_b16 v[114:115], v10 offset:25600
    ds_read_b64_tr_b16 v[116:117], v13 offset:24576
    ds_read_b64_tr_b16 v[118:119], v13 offset:25600
    s_waitcnt lgkmcnt(0)
    s_waitcnt vmcnt(12)
    s_add_u32 m0, s75, 155648
    s_add_u32 s67, s77, 86016
    buffer_load_dwordx4 v5, s[16:19], s67 offen lds
    buffer_load_dwordx4 v6, s[16:19], s67 offen offset:1024 lds
    ds_read_b64_tr_b16 v[120:121], v8 offset:8192
    ds_read_b64_tr_b16 v[122:123], v8 offset:9216
    ds_read_b64_tr_b16 v[124:125], v11 offset:8192
    ds_read_b64_tr_b16 v[126:127], v11 offset:9216
Lagain13:
    s_waitcnt lgkmcnt(0)
    s_cmp_ge_u32 s56, 0x10
    s_cbranch_scc1 Lok14
    s_cmp_eq_u32 s71, 0
    s_cbranch_scc1 Lok14
    s_sub_u32 s71, s71, 1
    buffer_load_dword v7, off, s[28:31], 0 sc1
    s_waitcnt vmcnt(0)
    v_readfirstlane_b32 s56, v7
    s_nop 1
    s_branch Lagain13
Lok14:
    s_barrier
    s_waitcnt vmcnt(12)
    s_add_u32 m0, s75, 49152
    s_add_u32 s67, s62, 256
    buffer_load_dwordx4 v2, s[12:15], s67 offen lds
    buffer_load_dwordx4 v3, s[12:15], s67 offen offset:1024 lds
    s_waitcnt vmcnt(12)
    s_add_u32 m0, s75, 57344
    s_add_u32 s67, s63, 256
    buffer_load_dwordx4 v2, s[12:15], s67 offen lds
    buffer_load_dwordx4 v3, s[12:15], s67 offen offset:1024 lds
    s_waitcnt vmcnt(12)
    s_add_u32 m0, s75, 65536
    s_add_u32 s67, s64, 256
    buffer_load_dwordx4 v2, s[12:15], s67 offen lds
    buffer_load_dwordx4 v3, s[12:15], s67 offen offset:1024 lds
    s_waitcnt vmcnt(12)
    s_add_u32 m0, s75, 73728
    s_add_u32 s67, s77, 100352
    buffer_load_dwordx4 v5, s[16:19], s67 offen lds
    buffer_load_dwordx4 v6, s[16:19], s67 offen offset:1024 lds
    s_waitcnt vmcnt(12)
    s_add_u32 m0, s75, 8192
    s_add_u32 s67, s77, 286720
    buffer_load_dwordx4 v5, s[16:19], s67 offen lds
    buffer_load_dwordx4 v6, s[16:19], s67 offen offset:1024 lds
    ds_read_b64_tr_b16 v[128:129], v8 offset:16384
    ds_read_b64_tr_b16 v[130:131], v8 offset:17408
    ds_read_b64_tr_b16 v[132:133], v11 offset:16384
    ds_read_b64_tr_b16 v[134:135], v11 offset:17408
    s_waitcnt lgkmcnt(0)
    s_waitcnt vmcnt(12)
    s_add_u32 m0, s75, 16384
    s_add_u32 s67, s77, 301056
    buffer_load_dwordx4 v5, s[16:19], s67 offen lds
    buffer_load_dwordx4 v6, s[16:19], s67 offen offset:1024 lds
    ds_read_b64_tr_b16 v[136:137], v10 offset:0
    ds_read_b64_tr_b16 v[138:139], v10 offset:1024
    ds_read_b64_tr_b16 v[140:141], v13 offset:0
    ds_read_b64_tr_b16 v[142:143], v13 offset:1024
    s_waitcnt lgkmcnt(0)
    s_waitcnt vmcnt(12)
    s_add_u32 m0, s75, 131072
    s_add_u32 s67, s77, 315392
    buffer_load_dwordx4 v5, s[16:19], s67 offen lds
    buffer_load_dwordx4 v6, s[16:19], s67 offen offset:1024 lds
    ds_read_b64_tr_b16 v[144:145], v10 offset:8192
    ds_read_b64_tr_b16 v[146:147], v10 offset:9216
    ds_read_b64_tr_b16 v[148:149], v13 offset:8192
    ds_read_b64_tr_b16 v[150:151], v13 offset:9216
    s_waitcnt lgkmcnt(0)
    s_waitcnt vmcnt(12)
    s_add_u32 m0, s75, 139264
    s_add_u32 s67, s77, 329728
    buffer_load_dwordx4 v5, s[16:19], s67 offen lds
    buffer_load_dwordx4 v6, s[16:19], s67 offen offset:1024 lds
    ds_read_b64_tr_b16 v[152:153], v10 offset:16384
    ds_read_b64_tr_b16 v[154:155], v10 offset:17408
    ds_read_b64_tr_b16 v[156:157], v13 offset:16384
    ds_read_b64_tr_b16 v[158:159], v13 offset:17408
    s_barrier
    s_waitcnt vmcnt(6)
    s_add_u32 m0, s75, 81920
    s_add_u32 s67, s58, s76
    buffer_load_dwordx4 v4, s[12:15], s67 offen lds
    s_waitcnt vmcnt(6)
    s_add_u32 m0, s75, 82944
    s_add_u32 s67, s59, s76
    buffer_load_dwordx4 v4, s[12:15], s67 offen lds
    s_waitcnt vmcnt(6)
    s_add_u32 m0, s75, 90112
    s_add_u32 s67, s60, s76
    buffer_load_dwordx4 v4, s[12:15], s67 offen lds
    s_waitcnt vmcnt(6)
    s_add_u32 m0, s75, 91136
    s_add_u32 s67, s61, s76
    buffer_load_dwordx4 v4, s[12:15], s67 offen lds
    s_add_u32 m0, s75, 98304
    s_add_u32 s67, s77, 114688
    buffer_load_dwordx4 v5, s[16:19], s67 offen lds
    buffer_load_dwordx4 v6, s[16:19], s67 offen offset:1024 lds
    s_add_u32 m0, s75, 106496
    s_add_u32 s67, s77, 129024
    buffer_load_dwordx4 v5, s[16:19], s67 offen lds
    buffer_load_dwordx4 v6, s[16:19], s67 offen offset:1024 lds
    s_waitcnt lgkmcnt(0)
    s_add_u32 m0, s75, 147456
    s_add_u32 s67, s77, 143360
    buffer_load_dwordx4 v5, s[16:19], s67 offen lds
    buffer_load_dwordx4 v6, s[16:19], s67 offen offset:1024 lds
    ds_read_b64_tr_b16 v[160:161], v10 offset:24576
    ds_read_b64_tr_b16 v[162:163], v10 offset:25600
    ds_read_b64_tr_b16 v[164:165], v13 offset:24576
    ds_read_b64_tr_b16 v[166:167], v13 offset:25600
    s_barrier
    s_waitcnt vmcnt(6)
    s_add_u32 m0, s75, 114688
    s_add_u32 s67, s62, s76
    buffer_load_dwordx4 v4, s[12:15], s67 offen lds
    s_waitcnt vmcnt(6)
    s_add_u32 m0, s75, 115712
    s_add_u32 s67, s63, s76
    buffer_load_dwordx4 v4, s[12:15], s67 offen lds
    s_waitcnt vmcnt(6)
    s_add_u32 m0, s75, 24576
    s_add_u32 s67, s64, s76
    buffer_load_dwordx4 v4, s[12:15], s67 offen lds
    v_add_u32 v248, 0x0, v1
    v_add_u32 v252, 0x0, v1
    v_add_u32 v249, 0x100000, v1
    v_add_u32 v253, 0x800, v1
    v_add_u32 v250, 0x800, v1
    v_add_u32 v254, 0x1000, v1
    v_add_u32 v251, 0x100800, v1
    v_add_u32 v255, 0x1800, v1
    s_lshl2_add_u32 s36, s66, s4
    s_lshl_b32 s36, s36, 12
    s_add_u32 s37, s36, 0x80000
    s_lshl3_add_u32 s44, s66, s4
    s_lshl_b32 s44, s44, 13
    s_add_u32 s44, s44, 0x700000
    s_add_u32 s45, s44, 32768
    s_lshl3_add_u32 s46, s7, s4
    s_lshl_b32 s46, s46, 13
    s_add_u32 s46, s46, 0x900000
    s_add_u32 s47, s46, 32768
    s_lshr_b32 s67, s66, 1
    s_lshl2_add_u32 s67, s67, s4
    s_and_b32 s68, s66, 1
    s_lshl3_add_u32 s67, s67, s68
    s_lshl_b32 s67, s67, 4
    s_add_u32 s49, s67, 0xa90000
    s_add_u32 s50, s49, 8192
    s_lshr_b32 s68, s7, 1
    s_lshl2_add_u32 s67, s4, s68
    s_lshl_b32 s67, s67, 7
    s_lshr_b32 s68, s66, 2
    s_mul_i32 s68, s68, 2304
    s_add_u32 s67, s67, s68
    s_add_u32 s51, s67, 0xa98000
    s_add_u32 s38, s36, 0x200000
    s_add_u32 s39, s37, 0x200000
    s_add_u32 s40, s38, 0x200000
    s_add_u32 s41, s39, 0x200000
    s_add_u32 s42, s40, 0x200000
    s_add_u32 s43, s41, 0x200000
    s_waitcnt vmcnt(0)
    s_barrier
    s_add_u32 m0, s75, 32768
    s_add_u32 s67, s77, 157696
    buffer_load_dwordx4 v5, s[16:19], s67 offen lds
    buffer_load_dwordx4 v6, s[16:19], s67 offen offset:1024 lds
    s_add_u32 m0, s75, 40960
    s_add_u32 s67, s77, 344064
    buffer_load_dwordx4 v5, s[16:19], s67 offen lds
    buffer_load_dwordx4 v6, s[16:19], s67 offen offset:1024 lds
    s_add_u32 m0, s75, 122880
    s_add_u32 s67, s77, 358400
    buffer_load_dwordx4 v5, s[16:19], s67 offen lds
    buffer_load_dwordx4 v6, s[16:19], s67 offen offset:1024 lds
    s_add_u32 m0, s75, 49152
    s_add_u32 s67, s77, 372736
    buffer_load_dwordx4 v5, s[16:19], s67 offen lds
    buffer_load_dwordx4 v6, s[16:19], s67 offen offset:1024 lds
    ds_read_b64_tr_b16 v[168:169], v9 offset:8192
    ds_read_b64_tr_b16 v[170:171], v9 offset:9216
    ds_read_b64_tr_b16 v[172:173], v12 offset:8192
    ds_read_b64_tr_b16 v[174:175], v12 offset:9216
    ds_read_b64_tr_b16 v[176:177], v8 offset:8192
    ds_read_b64_tr_b16 v[178:179], v8 offset:9216
    ds_read_b64_tr_b16 v[180:181], v11 offset:8192
    ds_read_b64_tr_b16 v[182:183], v11 offset:9216
    ds_read_b64_tr_b16 v[184:185], v8 offset:16384
    ds_read_b64_tr_b16 v[186:187], v8 offset:17408
    ds_read_b64_tr_b16 v[188:189], v11 offset:16384
    ds_read_b64_tr_b16 v[190:191], v11 offset:17408
    s_waitcnt lgkmcnt(0)
    s_buffer_load_dwordx4 s[52:55], s[20:23], s49 glc
    s_add_u32 m0, s75, 57344
    s_add_u32 s67, s77, 387072
    buffer_load_dwordx4 v5, s[16:19], s67 offen lds
    buffer_load_dwordx4 v6, s[16:19], s67 offen offset:1024 lds
    s_add_u32 m0, s75, 155648
    s_add_u32 s67, s77, 172032
    buffer_load_dwordx4 v5, s[16:19], s67 offen lds
    buffer_load_dwordx4 v6, s[16:19], s67 offen offset:1024 lds
    s_add_u32 m0, s75, 73728
    s_add_u32 s67, s77, 186368
    buffer_load_dwordx4 v5, s[16:19], s67 offen lds
    buffer_load_dwordx4 v6, s[16:19], s67 offen offset:1024 lds
    s_waitcnt vmcnt(12)
    s_add_u32 m0, s75, 8192
    s_add_u32 s67, s77, 200704
    buffer_load_dwordx4 v5, s[16:19], s67 offen lds
    buffer_load_dwordx4 v6, s[16:19], s67 offen offset:1024 lds
    s_waitcnt vmcnt(12)
    s_add_u32 m0, s75, 16384
    s_add_u32 s67, s77, 215040
    buffer_load_dwordx4 v5, s[16:19], s67 offen lds
    buffer_load_dwordx4 v6, s[16:19], s67 offen offset:1024 lds
Lagain15:
    s_waitcnt lgkmcnt(0)
    s_min_u32 s52, s52, s54
    s_min_u32 s53, s53, s55
    s_min_u32 s52, s52, s53
    s_cmp_ge_u32 s52, 0x1
    s_cbranch_scc1 Lok16
    s_cmp_eq_u32 s71, 0
    s_cbranch_scc1 Lok16
    s_sub_u32 s71, s71, 1
    s_buffer_load_dwordx4 s[52:55], s[20:23], s49 glc
    s_branch Lagain15
Lok16:
    buffer_load_dwordx4 v[192:195], v248, s[20:23], s36 offen offset:0 sc1
    buffer_load_dwordx4 v[196:199], v248, s[20:23], s36 offen offset:1024 sc1
    buffer_load_dwordx4 v[200:203], v248, s[20:23], s37 offen offset:0 sc1
    buffer_load_dwordx4 v[204:207], v248, s[20:23], s37 offen offset:1024 sc1
    buffer_load_dwordx4 v[208:211], v249, s[20:23], s36 offen offset:0 sc1
    buffer_load_dwordx4 v[212:215], v249, s[20:23], s36 offen offset:1024 sc1
    buffer_load_dwordx4 v[216:219], v249, s[20:23], s37 offen offset:0 sc1
    buffer_load_dwordx4 v[220:223], v249, s[20:23], s37 offen offset:1024 sc1
    s_cmp_ge_u32 s52, 0x2
    s_cbranch_scc1 Lseen17
    s_buffer_load_dwordx4 s[52:55], s[20:23], s49 glc
Lseen17:
    buffer_load_dwordx4 v[224:227], v250, s[20:23], s36 offen offset:0 sc1
    buffer_load_dwordx4 v[228:231], v250, s[20:23], s36 offen offset:1024 sc1
    buffer_load_dwordx4 v[232:235], v250, s[20:23], s37 offen offset:0 sc1
    buffer_load_dwordx4 v[236:239], v250, s[20:23], s37 offen offset:1024 sc1
    s_waitcnt vmcnt(10)
    v_mfma_f32_32x32x16_bf16 v[16:31], v[192:195], v[80:83], 0
    v_mfma_f32_32x32x16_bf16 v[32:47], v[196:199], v[80:83], 0
    v_mfma_f32_32x32x16_bf16 v[48:63], v[192:195], v[84:87], 0
    v_mfma_f32_32x32x16_bf16 v[64:79], v[196:199], v[84:87], 0
    s_waitcnt vmcnt(8)
    v_mfma_f32_32x32x16_bf16 v[16:31], v[200:203], v[88:91], v[16:31]
    buffer_load_dwordx4 v[240:243], v251, s[20:23], s36 offen offset:0 sc1
    v_mfma_f32_32x32x16_bf16 v[32:47], v[204:207], v[88:91], v[32:47]
    buffer_load_dwordx4 v[244:247], v251, s[20:23], s36 offen offset:1024 sc1
    v_mfma_f32_32x32x16_bf16 v[48:63], v[200:203], v[92:95], v[48:63]
    buffer_load_dwordx4 v[192:195], v251, s[20:23], s37 offen offset:0 sc1
    v_mfma_f32_32x32x16_bf16 v[64:79], v[204:207], v[92:95], v[64:79]
    buffer_load_dwordx4 v[196:199], v251, s[20:23], s37 offen offset:1024 sc1
    s_waitcnt vmcnt(10)
    v_mfma_f32_32x32x16_bf16 v[16:31], v[208:211], v[96:99], v[16:31]
    v_mfma_f32_32x32x16_bf16 v[32:47], v[212:215], v[96:99], v[32:47]
Lagain18:
    s_waitcnt lgkmcnt(0)
    s_min_u32 s52, s52, s54
    s_min_u32 s53, s53, s55
    s_min_u32 s52, s52, s53
    s_cmp_ge_u32 s52, 0x2
    s_cbranch_scc1 Lok19
    s_cmp_eq_u32 s71, 0
    s_cbranch_scc1 Lok19
    s_sub_u32 s71, s71, 1
    s_buffer_load_dwordx4 s[52:55], s[20:23], s49 glc
    s_branch Lagain18
Lok19:
    buffer_load_dwordx4 v[80:83], v248, s[20:23], s38 offen offset:0 sc1
    v_mfma_f32_32x32x16_bf16 v[48:63], v[208:211], v[100:103], v[48:63]
    buffer_load_dwordx4 v[84:87], v248, s[20:23], s38 offen offset:1024 sc1
    v_mfma_f32_32x32x16_bf16 v[64:79], v[212:215], v[100:103], v[64:79]
    buffer_load_dwordx4 v[200:203], v248, s[20:23], s39 offen offset:0 sc1
    s_waitcnt vmcnt(11)
    v_mfma_f32_32x32x16_bf16 v[16:31], v[216:219], v[104:107], v[16:31]
    v_mfma_f32_32x32x16_bf16 v[32:47], v[220:223], v[104:107], v[32:47]
    buffer_load_dwordx4 v[204:207], v248, s[20:23], s39 offen offset:1024 sc1
    v_mfma_f32_32x32x16_bf16 v[48:63], v[216:219], v[108:111], v[48:63]
    buffer_load_dwordx4 v[88:91], v249, s[20:23], s38 offen offset:0 sc1
    v_mfma_f32_32x32x16_bf16 v[64:79], v[220:223], v[108:111], v[64:79]
    buffer_load_dwordx4 v[92:95], v249, s[20:23], s38 offen offset:1024 sc1
    s_waitcnt vmcnt(12)
    v_mfma_f32_32x32x16_bf16 v[16:31], v[224:227], v[112:115], v[16:31]
    v_mfma_f32_32x32x16_bf16 v[32:47], v[228:231], v[112:115], v[32:47]
    buffer_load_dwordx4 v[208:211], v249, s[20:23], s39 offen offset:0 sc1
    v_mfma_f32_32x32x16_bf16 v[48:63], v[224:227], v[116:119], v[48:63]
    buffer_load_dwordx4 v[212:215], v249, s[20:23], s39 offen offset:1024 sc1
    v_mfma_f32_32x32x16_bf16 v[64:79], v[228:231], v[116:119], v[64:79]
    s_buffer_load_dwordx4 s[56:59], s[20:23], s50 glc
    buffer_load_dwordx4 v[96:99], v250, s[20:23], s38 offen offset:0 sc1
    s_waitcnt vmcnt(13)
    v_mfma_f32_32x32x16_bf16 v[16:31], v[232:235], v[120:123], v[16:31]
    v_mfma_f32_32x32x16_bf16 v[32:47], v[236:239], v[120:123], v[32:47]
    buffer_load_dwordx4 v[100:103], v250, s[20:23], s38 offen offset:1024 sc1
    v_mfma_f32_32x32x16_bf16 v[48:63], v[232:235], v[124:127], v[48:63]
    buffer_load_dwordx4 v[216:219], v250, s[20:23], s39 offen offset:0 sc1
    v_mfma_f32_32x32x16_bf16 v[64:79], v[236:239], v[124:127], v[64:79]
    buffer_load_dwordx4 v[220:223], v250, s[20:23], s39 offen offset:1024 sc1
    s_waitcnt vmcnt(14)
    v_mfma_f32_32x32x16_bf16 v[16:31], v[240:243], v[128:131], v[16:31]
    v_mfma_f32_32x32x16_bf16 v[32:47], v[244:247], v[128:131], v[32:47]
    buffer_load_dwordx4 v[104:107], v251, s[20:23], s38 offen offset:0 sc1
    v_mfma_f32_32x32x16_bf16 v[48:63], v[240:243], v[132:135], v[48:63]
    buffer_load_dwordx4 v[108:111], v251, s[20:23], s38 offen offset:1024 sc1
    v_mfma_f32_32x32x16_bf16 v[64:79], v[244:247], v[132:135], v[64:79]
    buffer_load_dwordx4 v[224:227], v251, s[20:23], s39 offen offset:0 sc1
    s_waitcnt vmcnt(15)
    v_mfma_f32_32x32x16_bf16 v[16:31], v[192:195], v[136:139], v[16:31]
    v_mfma_f32_32x32x16_bf16 v[32:47], v[196:199], v[136:139], v[32:47]
    buffer_load_dwordx4 v[228:231], v251, s[20:23], s39 offen offset:1024 sc1
    v_mfma_f32_32x32x16_bf16 v[48:63], v[192:195], v[140:143], v[48:63]
Lagain20:
    s_waitcnt lgkmcnt(0)
    s_min_u32 s56, s56, s58
    s_min_u32 s57, s57, s59
    s_min_u32 s56, s56, s57
    s_cmp_ge_u32 s56, 0x1
    s_cbranch_scc1 Lok21
    s_cmp_eq_u32 s71, 0
    s_cbranch_scc1 Lok21
    s_sub_u32 s71, s71, 1
    s_buffer_load_dwordx4 s[56:59], s[20:23], s50 glc
    s_branch Lagain20
Lok21:
    s_cmp_ge_u32 s52, 0x3
    s_cbranch_scc1 Lseen22
    s_buffer_load_dwordx4 s[52:55], s[20:23], s49 glc
Lseen22:
    buffer_load_dwordx4 v[112:115], v252, s[20:23], s44 offen offset:0 sc1
    v_mfma_f32_32x32x16_bf16 v[64:79], v[196:199], v[140:143], v[64:79]
    buffer_load_dwordx4 v[116:119], v252, s[20:23], s45 offen offset:0 sc1
    s_waitcnt vmcnt(16)
    v_mfma_f32_32x32x16_bf16 v[16:31], v[80:83], v[144:147], v[16:31]
    v_mfma_f32_32x32x16_bf16 v[32:47], v[84:87], v[144:147], v[32:47]
    buffer_load_dwordx4 v[232:235], v252, s[20:23], s44 offen offset:1024 sc1
    v_mfma_f32_32x32x16_bf16 v[48:63], v[80:83], v[148:151], v[48:63]
    buffer_load_dwordx4 v[236:239], v252, s[20:23], s45 offen offset:1024 sc1
    v_mfma_f32_32x32x16_bf16 v[64:79], v[84:87], v[148:151], v[64:79]
    s_waitcnt vmcnt(16)
    v_mfma_f32_32x32x16_bf16 v[16:31], v[200:203], v[152:155], v[16:31]
    ds_read_b64_tr_b16 v[120:121], v10 offset:0
    ds_read_b64_tr_b16 v[122:123], v10 offset:1024
    v_mfma_f32_32x32x16_bf16 v[32:47], v[204:207], v[152:155], v[32:47]
    buffer_load_dwordx4 v[240:243], v253, s[20:23], s44 offen offset:0 sc1
    v_mfma_f32_32x32x16_bf16 v[48:63], v[200:203], v[156:159], v[48:63]
    ds_read_b64_tr_b16 v[124:125], v13 offset:0
    ds_read_b64_tr_b16 v[126:127], v13 offset:1024
    v_mfma_f32_32x32x16_bf16 v[64:79], v[204:207], v[156:159], v[64:79]
    buffer_load_dwordx4 v[244:247], v253, s[20:23], s44 offen offset:1024 sc1
    s_waitcnt vmcnt(16)
    v_mfma_f32_32x32x16_bf16 v[16:31], v[88:91], v[160:163], v[16:31]
    ds_read_b64_tr_b16 v[128:129], v10 offset:8192
    ds_read_b64_tr_b16 v[130:131], v10 offset:9216
    v_mfma_f32_32x32x16_bf16 v[32:47], v[92:95], v[160:163], v[32:47]
Lagain23:
    s_waitcnt lgkmcnt(0)
    s_min_u32 s52, s52, s54
    s_min_u32 s53, s53, s55
    s_min_u32 s52, s52, s53
    s_cmp_ge_u32 s52, 0x3
    s_cbranch_scc1 Lok24
    s_cmp_eq_u32 s71, 0
    s_cbranch_scc1 Lok24
    s_sub_u32 s71, s71, 1
    s_buffer_load_dwordx4 s[52:55], s[20:23], s49 glc
    s_branch Lagain23
Lok24:
    s_cmp_ge_u32 s52, 0x4
    s_cbranch_scc1 Lseen25
    s_buffer_load_dwordx4 s[52:55], s[20:23], s49 glc
Lseen25:
    buffer_load_dwordx4 v[192:195], v248, s[20:23], s40 offen offset:0 sc1
    v_mfma_f32_32x32x16_bf16 v[48:63], v[88:91], v[164:167], v[48:63]
    ds_read_b64_tr_b16 v[132:133], v13 offset:8192
    ds_read_b64_tr_b16 v[134:135], v13 offset:9216
    v_mfma_f32_32x32x16_bf16 v[64:79], v[92:95], v[164:167], v[64:79]
    buffer_load_dwordx4 v[196:199], v248, s[20:23], s40 offen offset:1024 sc1
    s_waitcnt vmcnt(16)
    v_mfma_f32_32x32x16_bf16 v[16:31], v[208:211], v[168:171], v[16:31]
    ds_read_b64_tr_b16 v[136:137], v9 offset:32768
    ds_read_b64_tr_b16 v[138:139], v9 offset:33792
    v_mfma_f32_32x32x16_bf16 v[32:47], v[212:215], v[168:171], v[32:47]
    buffer_load_dwordx4 v[80:83], v248, s[20:23], s41 offen offset:0 sc1
    v_mfma_f32_32x32x16_bf16 v[48:63], v[208:211], v[172:175], v[48:63]
    ds_read_b64_tr_b16 v[140:141], v12 offset:32768
    ds_read_b64_tr_b16 v[142:143], v12 offset:33792
    v_mfma_f32_32x32x16_bf16 v[64:79], v[212:215], v[172:175], v[64:79]
    buffer_load_dwordx4 v[84:87], v248, s[20:23], s41 offen offset:1024 sc1
    s_waitcnt vmcnt(16)
    v_mfma_f32_32x32x16_bf16 v[16:31], v[96:99], v[176:179], v[16:31]
    ds_read_b64_tr_b16 v[144:145], v9 offset:40960
    ds_read_b64_tr_b16 v[146:147], v9 offset:41984
    v_mfma_f32_32x32x16_bf16 v[32:47], v[100:103], v[176:179], v[32:47]
    buffer_load_dwordx4 v[200:203], v250, s[20:23], s40 offen offset:0 sc1
    v_mfma_f32_32x32x16_bf16 v[48:63], v[96:99], v[180:183], v[48:63]
    ds_read_b64_tr_b16 v[148:149], v12 offset:40960
    ds_read_b64_tr_b16 v[150:151], v12 offset:41984
    v_mfma_f32_32x32x16_bf16 v[64:79], v[100:103], v[180:183], v[64:79]
    buffer_load_dwordx4 v[204:207], v250, s[20:23], s40 offen offset:1024 sc1
    s_waitcnt vmcnt(16)
    v_mfma_f32_32x32x16_bf16 v[16:31], v[216:219], v[184:187], v[16:31]
    ds_read_b64_tr_b16 v[152:153], v8 offset:40960
    ds_read_b64_tr_b16 v[154:155], v8 offset:41984
    v_mfma_f32_32x32x16_bf16 v[32:47], v[220:223], v[184:187], v[32:47]
    buffer_load_dwordx4 v[88:91], v250, s[20:23], s41 offen offset:0 sc1
    v_mfma_f32_32x32x16_bf16 v[48:63], v[216:219], v[188:191], v[48:63]
    ds_read_b64_tr_b16 v[156:157], v11 offset:40960
    ds_read_b64_tr_b16 v[158:159], v11 offset:41984
    v_mfma_f32_32x32x16_bf16 v[64:79], v[220:223], v[188:191], v[64:79]
    buffer_load_dwordx4 v[92:95], v250, s[20:23], s41 offen offset:1024 sc1
    s_waitcnt vmcnt(16)
    v_mfma_f32_32x32x16_bf16 v[16:31], v[104:107], v[120:123], v[16:31]
    ds_read_b64_tr_b16 v[160:161], v9 offset:57344
    ds_read_b64_tr_b16 v[162:163], v9 offset:58368
    v_mfma_f32_32x32x16_bf16 v[32:47], v[108:111], v[120:123], v[32:47]
Lagain26:
    s_waitcnt lgkmcnt(0)
    s_min_u32 s52, s52, s54
    s_min_u32 s53, s53, s55
    s_min_u32 s52, s52, s53
    s_cmp_ge_u32 s52, 0x4
    s_cbranch_scc1 Lok27
    s_cmp_eq_u32 s71, 0
    s_cbranch_scc1 Lok27
    s_sub_u32 s71, s71, 1
    s_buffer_load_dwordx4 s[52:55], s[20:23], s49 glc
    s_branch Lagain26
Lok27:
    s_cmp_ge_u32 s52, 0x5
    s_cbranch_scc1 Lseen28
    s_buffer_load_dwordx4 s[52:55], s[20:23], s49 glc
Lseen28:
    buffer_load_dwordx4 v[208:211], v249, s[20:23], s40 offen offset:0 sc1
    v_mfma_f32_32x32x16_bf16 v[48:63], v[104:107], v[124:127], v[48:63]
    ds_read_b64_tr_b16 v[164:165], v12 offset:57344
    ds_read_b64_tr_b16 v[166:167], v12 offset:58368
    v_mfma_f32_32x32x16_bf16 v[64:79], v[108:111], v[124:127], v[64:79]
    buffer_load_dwordx4 v[212:215], v249, s[20:23], s40 offen offset:1024 sc1
    s_waitcnt vmcnt(16)
    v_mfma_f32_32x32x16_bf16 v[16:31], v[224:227], v[128:131], v[16:31]
    ds_read_b64_tr_b16 v[168:169], v10 offset:16384
    ds_read_b64_tr_b16 v[170:171], v10 offset:17408
    v_mfma_f32_32x32x16_bf16 v[32:47], v[228:231], v[128:131], v[32:47]
    buffer_load_dwordx4 v[96:99], v249, s[20:23], s41 offen offset:0 sc1
    v_mfma_f32_32x32x16_bf16 v[48:63], v[224:227], v[132:135], v[48:63]
    ds_read_b64_tr_b16 v[172:173], v13 offset:16384
    ds_read_b64_tr_b16 v[174:175], v13 offset:17408
    v_mfma_f32_32x32x16_bf16 v[64:79], v[228:231], v[132:135], v[64:79]
    buffer_load_dwordx4 v[100:103], v249, s[20:23], s41 offen offset:1024 sc1
    s_waitcnt vmcnt(10)
    v_mfma_f32_32x32x16_bf16 v[16:31], v[192:195], v[136:139], v[16:31]
    ds_read_b64_tr_b16 v[176:177], v8 offset:32768
    ds_read_b64_tr_b16 v[178:179], v8 offset:33792
    v_mfma_f32_32x32x16_bf16 v[32:47], v[196:199], v[136:139], v[32:47]
    buffer_load_dwordx4 v[216:219], v251, s[20:23], s40 offen offset:0 sc1
    v_mfma_f32_32x32x16_bf16 v[48:63], v[192:195], v[140:143], v[48:63]
    ds_read_b64_tr_b16 v[180:181], v11 offset:32768
    ds_read_b64_tr_b16 v[182:183], v11 offset:33792
    v_mfma_f32_32x32x16_bf16 v[64:79], v[196:199], v[140:143], v[64:79]
    buffer_load_dwordx4 v[220:223], v251, s[20:23], s40 offen offset:1024 sc1
    s_waitcnt vmcnt(10)
    v_mfma_f32_32x32x16_bf16 v[16:31], v[80:83], v[144:147], v[16:31]
    ds_read_b64_tr_b16 v[184:185], v8 offset:49152
    ds_read_b64_tr_b16 v[186:187], v8 offset:50176
    v_mfma_f32_32x32x16_bf16 v[32:47], v[84:87], v[144:147], v[32:47]
    buffer_load_dwordx4 v[104:107], v251, s[20:23], s41 offen offset:0 sc1
    v_mfma_f32_32x32x16_bf16 v[48:63], v[80:83], v[148:151], v[48:63]
    ds_read_b64_tr_b16 v[188:189], v11 offset:49152
    ds_read_b64_tr_b16 v[190:191], v11 offset:50176
    v_mfma_f32_32x32x16_bf16 v[64:79], v[84:87], v[148:151], v[64:79]
    buffer_load_dwordx4 v[108:111], v251, s[20:23], s41 offen offset:1024 sc1
    s_waitcnt vmcnt(10)
    v_mfma_f32_32x32x16_bf16 v[16:31], v[200:203], v[152:155], v[16:31]
    ds_read_b64_tr_b16 v[120:121], v8 offset:57344
    ds_read_b64_tr_b16 v[122:123], v8 offset:58368
    v_mfma_f32_32x32x16_bf16 v[32:47], v[204:207], v[152:155], v[32:47]
Lagain29:
    s_waitcnt lgkmcnt(0)
    s_min_u32 s52, s52, s54
    s_min_u32 s53, s53, s55
    s_min_u32 s52, s52, s53
    s_cmp_ge_u32 s52, 0x5
    s_cbranch_scc1 Lok30
    s_cmp_eq_u32 s71, 0
    s_cbranch_scc1 Lok30
    s_sub_u32 s71, s71, 1
    s_buffer_load_dwordx4 s[52:55], s[20:23], s49 glc
    s_branch Lagain29
Lok30:
    s_buffer_load_dwordx8 s[56:63], s[20:23], s51 glc
    buffer_load_dwordx4 v[224:227], v1, s[20:23], s42 offen offset:0 sc1
    v_mfma_f32_32x32x16_bf16 v[48:63], v[200:203], v[156:159], v[48:63]
    ds_read_b64_tr_b16 v[124:125], v11 offset:57344
    ds_read_b64_tr_b16 v[126:127], v11 offset:58368
    v_mfma_f32_32x32x16_bf16 v[64:79], v[204:207], v[156:159], v[64:79]
    buffer_load_dwordx4 v[228:231], v1, s[20:23], s42 offen offset:1024 sc1
    s_waitcnt vmcnt(10)
    v_mfma_f32_32x32x16_bf16 v[16:31], v[88:91], v[160:163], v[16:31]
    ds_read_b64_tr_b16 v[128:129], v10 offset:24576
    ds_read_b64_tr_b16 v[130:131], v10 offset:25600
    v_mfma_f32_32x32x16_bf16 v[32:47], v[92:95], v[160:163], v[32:47]
    buffer_load_dwordx4 v[192:195], v1, s[20:23], s43 offen offset:0 sc1
    v_mfma_f32_32x32x16_bf16 v[48:63], v[88:91], v[164:167], v[48:63]
    ds_read_b64_tr_b16 v[132:133], v13 offset:24576
    ds_read_b64_tr_b16 v[134:135], v13 offset:25600
    v_mfma_f32_32x32x16_bf16 v[64:79], v[92:95], v[164:167], v[64:79]
    buffer_load_dwordx4 v[196:199], v1, s[20:23], s43 offen offset:1024 sc1
    s_waitcnt vmcnt(10)
    v_mfma_f32_32x32x16_bf16 v[16:31], v[208:211], v[168:171], v[16:31]
    ds_read_b64_tr_b16 v[136:137], v9 offset:8192
    ds_read_b64_tr_b16 v[138:139], v9 offset:9216
    v_mfma_f32_32x32x16_bf16 v[32:47], v[212:215], v[168:171], v[32:47]
    buffer_load_dwordx4 v[80:83], v1, s[20:23], s42 offen offset:2048 sc1
    v_mfma_f32_32x32x16_bf16 v[48:63], v[208:211], v[172:175], v[48:63]
    ds_read_b64_tr_b16 v[140:141], v12 offset:8192
    ds_read_b64_tr_b16 v[142:143], v12 offset:9216
    v_mfma_f32_32x32x16_bf16 v[64:79], v[212:215], v[172:175], v[64:79]
    buffer_load_dwordx4 v[84:87], v1, s[20:23], s42 offen offset:3072 sc1
    s_waitcnt vmcnt(10)
    v_mfma_f32_32x32x16_bf16 v[16:31], v[96:99], v[176:179], v[16:31]
    ds_read_b64_tr_b16 v[144:145], v8 offset:8192
    ds_read_b64_tr_b16 v[146:147], v8 offset:9216
    v_mfma_f32_32x32x16_bf16 v[32:47], v[100:103], v[176:179], v[32:47]
    buffer_load_dwordx4 v[200:203], v1, s[20:23], s43 offen offset:2048 sc1
    v_mfma_f32_32x32x16_bf16 v[48:63], v[96:99], v[180:183], v[48:63]
    ds_read_b64_tr_b16 v[148:149], v11 offset:8192
    ds_read_b64_tr_b16 v[150:151], v11 offset:9216
    v_mfma_f32_32x32x16_bf16 v[64:79], v[100:103], v[180:183], v[64:79]
    buffer_load_dwordx4 v[204:207], v1, s[20:23], s43 offen offset:3072 sc1
    s_waitcnt vmcnt(10)
    v_mfma_f32_32x32x16_bf16 v[16:31], v[216:219], v[184:187], v[16:31]
    ds_read_b64_tr_b16 v[152:153], v8 offset:16384
    ds_read_b64_tr_b16 v[154:155], v8 offset:17408
    v_mfma_f32_32x32x16_bf16 v[32:47], v[220:223], v[184:187], v[32:47]
Lagain31:
    s_waitcnt lgkmcnt(0)
    s_min_u32 s56, s56, s60
    s_min_u32 s57, s57, s61
    s_min_u32 s58, s58, s62
    s_min_u32 s59, s59, s63
    s_min_u32 s56, s56, s58
    s_min_u32 s57, s57, s59
    s_min_u32 s56, s56, s57
    s_cmp_ge_u32 s56, 0x1
    s_cbranch_scc1 Lok32
    s_cmp_eq_u32 s71, 0
    s_cbranch_scc1 Lok32
    s_sub_u32 s71, s71, 1
    s_buffer_load_dwordx8 s[56:63], s[20:23], s51 glc
    s_branch Lagain31
Lok32:
    buffer_load_dwordx4 v[88:91], v252, s[20:23], s46 offen offset:0 sc1
    v_mfma_f32_32x32x16_bf16 v[48:63], v[216:219], v[188:191], v[48:63]
    ds_read_b64_tr_b16 v[156:157], v11 offset:16384
    ds_read_b64_tr_b16 v[158:159], v11 offset:17408
    buffer_load_dwordx4 v[92:95], v252, s[20:23], s47 offen offset:0 sc1
    v_mfma_f32_32x32x16_bf16 v[64:79], v[220:223], v[188:191], v[64:79]
    buffer_load_dwordx4 v[160:163], v252, s[20:23], s46 offen offset:1024 sc1
    s_waitcnt vmcnt(11)
    v_mfma_f32_32x32x16_bf16 v[16:31], v[104:107], v[120:123], v[16:31]
    buffer_load_dwordx4 v[164:167], v252, s[20:23], s47 offen offset:1024 sc1
    v_mfma_f32_32x32x16_bf16 v[32:47], v[108:111], v[120:123], v[32:47]
    buffer_load_dwordx4 v[212:215], v253, s[20:23], s46 offen offset:0 sc1
    v_mfma_f32_32x32x16_bf16 v[48:63], v[104:107], v[124:127], v[48:63]
    buffer_load_dwordx4 v[168:171], v253, s[20:23], s47 offen offset:0 sc1
    v_mfma_f32_32x32x16_bf16 v[64:79], v[108:111], v[124:127], v[64:79]
    buffer_load_dwordx4 v[96:99], v253, s[20:23], s46 offen offset:1024 sc1
    s_waitcnt vmcnt(13)
    v_mfma_f32_32x32x16_bf16 v[16:31], v[224:227], v[128:131], v[16:31]
    buffer_load_dwordx4 v[100:103], v253, s[20:23], s47 offen offset:1024 sc1
    v_mfma_f32_32x32x16_bf16 v[32:47], v[228:231], v[128:131], v[32:47]
    s_waitcnt lgkmcnt(0)
    buffer_load_dwordx4 v[176:179], v254, s[20:23], s44 offen offset:0 sc1
    v_mfma_f32_32x32x16_bf16 v[48:63], v[224:227], v[132:135], v[48:63]
    buffer_load_dwordx4 v[216:219], v254, s[20:23], s46 offen offset:0 sc1
    v_mfma_f32_32x32x16_bf16 v[64:79], v[228:231], v[132:135], v[64:79]
    buffer_load_dwordx4 v[220:223], v254, s[20:23], s47 offen offset:0 sc1
    s_waitcnt vmcnt(15)
    v_mfma_f32_32x32x16_bf16 v[16:31], v[192:195], v[136:139], v[16:31]
    buffer_load_dwordx4 v[184:187], v254, s[20:23], s44 offen offset:1024 sc1
    v_mfma_f32_32x32x16_bf16 v[32:47], v[196:199], v[136:139], v[32:47]
    buffer_load_dwordx4 v[104:107], v254, s[20:23], s46 offen offset:1024 sc1
    v_mfma_f32_32x32x16_bf16 v[48:63], v[192:195], v[140:143], v[48:63]
    buffer_load_dwordx4 v[108:111], v254, s[20:23], s47 offen offset:1024 sc1
    v_mfma_f32_32x32x16_bf16 v[64:79], v[196:199], v[140:143], v[64:79]
    s_waitcnt vmcnt(16)
    v_mfma_f32_32x32x16_bf16 v[16:31], v[80:83], v[144:147], v[16:31]
    buffer_load_dwordx4 v[120:123], v255, s[20:23], s44 offen offset:0 sc1
    v_mfma_f32_32x32x16_bf16 v[32:47], v[84:87], v[144:147], v[32:47]
    buffer_load_dwordx4 v[224:227], v255, s[20:23], s46 offen offset:0 sc1
    v_mfma_f32_32x32x16_bf16 v[48:63], v[80:83], v[148:151], v[48:63]
    v_mfma_f32_32x32x16_bf16 v[64:79], v[84:87], v[148:151], v[64:79]
    s_waitcnt vmcnt(16)
    v_mfma_f32_32x32x16_bf16 v[16:31], v[200:203], v[152:155], v[16:31]
    buffer_load_dwordx4 v[228:231], v255, s[20:23], s47 offen offset:0 sc1
    v_mfma_f32_32x32x16_bf16 v[32:47], v[204:207], v[152:155], v[32:47]
    buffer_load_dwordx4 v[128:131], v255, s[20:23], s44 offen offset:1024 sc1
    v_mfma_f32_32x32x16_bf16 v[48:63], v[200:203], v[156:159], v[48:63]
    v_mfma_f32_32x32x16_bf16 v[64:79], v[204:207], v[156:159], v[64:79]
    s_waitcnt vmcnt(16)
    v_mfma_f32_32x32x16_bf16 v[16:31], v[112:115], v[88:91], v[16:31]
    buffer_load_dwordx4 v[192:195], v255, s[20:23], s46 offen offset:1024 sc1
    v_mfma_f32_32x32x16_bf16 v[32:47], v[116:119], v[88:91], v[32:47]
    buffer_load_dwordx4 v[196:199], v255, s[20:23], s47 offen offset:1024 sc1
    v_mfma_f32_32x32x16_bf16 v[48:63], v[112:115], v[92:95], v[48:63]
    v_mfma_f32_32x32x16_bf16 v[64:79], v[116:119], v[92:95], v[64:79]
    s_barrier
    s_mul_i32 m0, s4, 16448
    s_waitcnt vmcnt(16)
    v_mfma_f32_32x32x16_bf16 v[16:31], v[232:235], v[160:163], v[16:31]
    buffer_load_dwordx4 v[208:211], v253, s[20:23], s45 offen offset:0 sc1
    v_mfma_f32_32x32x16_bf16 v[32:47], v[236:239], v[160:163], v[32:47]
    buffer_load_dwordx4 v[172:175], v253, s[20:23], s45 offen offset:1024 sc1
    v_mfma_f32_32x32x16_bf16 v[48:63], v[232:235], v[164:167], v[48:63]
    v_mfma_f32_32x32x16_bf16 v[64:79], v[236:239], v[164:167], v[64:79]
    s_waitcnt vmcnt(16)
    v_mfma_f32_32x32x16_bf16 v[16:31], v[240:243], v[212:215], v[16:31]
    buffer_load_dwordx4 v[180:183], v254, s[20:23], s45 offen offset:0 sc1
    buffer_load_dwordx4 v[188:191], v254, s[20:23], s45 offen offset:1024 sc1
    v_mfma_f32_32x32x16_bf16 v[48:63], v[240:243], v[168:171], v[48:63]
    s_waitcnt vmcnt(16)
    v_mfma_f32_32x32x16_bf16 v[16:31], v[244:247], v[96:99], v[16:31]
    buffer_load_dwordx4 v[124:127], v255, s[20:23], s45 offen offset:0 sc1
    buffer_load_dwordx4 v[132:135], v255, s[20:23], s45 offen offset:1024 sc1
    v_mfma_f32_32x32x16_bf16 v[48:63], v[244:247], v[100:103], v[48:63]
    s_waitcnt vmcnt(15)
    v_mfma_f32_32x32x16_bf16 v[16:31], v[176:179], v[216:219], v[16:31]
    v_mfma_f32_32x32x16_bf16 v[48:63], v[176:179], v[220:223], v[48:63]
    s_waitcnt vmcnt(12)
    v_mfma_f32_32x32x16_bf16 v[16:31], v[184:187], v[104:107], v[16:31]
    v_mfma_f32_32x32x16_bf16 v[48:63], v[184:187], v[108:111], v[48:63]
    s_waitcnt vmcnt(9)
    v_mfma_f32_32x32x16_bf16 v[16:31], v[120:123], v[224:227], v[16:31]
    s_waitcnt vmcnt(6)
    v_mfma_f32_32x32x16_bf16 v[16:31], v[128:131], v[192:195], v[16:31]
    v_mfma_f32_32x32x16_bf16 v[48:63], v[120:123], v[228:231], v[48:63]
    v_mfma_f32_32x32x16_bf16 v[48:63], v[128:131], v[196:199], v[48:63]
    s_waitcnt vmcnt(5)
    v_mfma_f32_32x32x16_bf16 v[32:47], v[208:211], v[212:215], v[32:47]
    s_nop 7
    ds_write_addtid_b32 v16 offset:0
    ds_write_addtid_b32 v17 offset:256
    ds_write_addtid_b32 v18 offset:512
    ds_write_addtid_b32 v19 offset:768
    ds_write_addtid_b32 v20 offset:1024
    ds_write_addtid_b32 v21 offset:1280
    ds_write_addtid_b32 v22 offset:1536
    ds_write_addtid_b32 v23 offset:1792
    v_mfma_f32_32x32x16_bf16 v[64:79], v[208:211], v[168:171], v[64:79]
    ds_write_addtid_b32 v24 offset:2048
    ds_write_addtid_b32 v25 offset:2304
    ds_write_addtid_b32 v26 offset:2560
    ds_write_addtid_b32 v27 offset:2816
    ds_write_addtid_b32 v28 offset:3072
    ds_write_addtid_b32 v29 offset:3328
    ds_write_addtid_b32 v30 offset:3584
    ds_write_addtid_b32 v31 offset:3840
    s_waitcnt vmcnt(4)
    v_mfma_f32_32x32x16_bf16 v[32:47], v[172:175], v[96:99], v[32:47]
    ds_write_addtid_b32 v48 offset:4112
    ds_write_addtid_b32 v49 offset:4368
    ds_write_addtid_b32 v50 offset:4624
    ds_write_addtid_b32 v51 offset:4880
    ds_write_addtid_b32 v52 offset:5136
    ds_write_addtid_b32 v53 offset:5392
    ds_write_addtid_b32 v54 offset:5648
    ds_write_addtid_b32 v55 offset:5904
    v_mfma_f32_32x32x16_bf16 v[64:79], v[172:175], v[100:103], v[64:79]
    ds_write_addtid_b32 v56 offset:6160
    ds_write_addtid_b32 v57 offset:6416
    ds_write_addtid_b32 v58 offset:6672
    ds_write_addtid_b32 v59 offset:6928
    ds_write_addtid_b32 v60 offset:7184
    ds_write_addtid_b32 v61 offset:7440
    ds_write_addtid_b32 v62 offset:7696
    ds_write_addtid_b32 v63 offset:7952
    s_waitcnt vmcnt(3)
    v_mfma_f32_32x32x16_bf16 v[32:47], v[180:183], v[216:219], v[32:47]
    s_waitcnt lgkmcnt(0)
    s_barrier
    v_mfma_f32_32x32x16_bf16 v[64:79], v[180:183], v[220:223], v[64:79]
    s_waitcnt vmcnt(2)
    v_mfma_f32_32x32x16_bf16 v[32:47], v[188:191], v[104:107], v[32:47]
    v_mfma_f32_32x32x16_bf16 v[64:79], v[188:191], v[108:111], v[64:79]
    s_waitcnt vmcnt(1)
    v_mfma_f32_32x32x16_bf16 v[32:47], v[124:127], v[224:227], v[32:47]
    s_waitcnt vmcnt(0)
    v_mfma_f32_32x32x16_bf16 v[32:47], v[132:135], v[192:195], v[32:47]
    v_mfma_f32_32x32x16_bf16 v[64:79], v[124:127], v[228:231], v[64:79]
    v_mfma_f32_32x32x16_bf16 v[64:79], v[132:135], v[196:199], v[64:79]
    s_nop 9
    ds_write_addtid_b32 v32 offset:8224
    ds_write_addtid_b32 v33 offset:8480
    ds_write_addtid_b32 v34 offset:8736
    ds_write_addtid_b32 v35 offset:8992
    ds_write_addtid_b32 v36 offset:9248
    ds_write_addtid_b32 v37 offset:9504
    ds_write_addtid_b32 v38 offset:9760
    ds_write_addtid_b32 v39 offset:10016
    ds_write_addtid_b32 v40 offset:10272
    ds_write_addtid_b32 v41 offset:10528
    ds_write_addtid_b32 v42 offset:10784
    ds_write_addtid_b32 v43 offset:11040
    ds_write_addtid_b32 v44 offset:11296
    ds_write_addtid_b32 v45 offset:11552
    ds_write_addtid_b32 v46 offset:11808
    ds_write_addtid_b32 v47 offset:12064
    ds_write_addtid_b32 v64 offset:12336
    ds_write_addtid_b32 v65 offset:12592
    ds_write_addtid_b32 v66 offset:12848
    ds_write_addtid_b32 v67 offset:13104
    ds_write_addtid_b32 v68 offset:13360
    ds_write_addtid_b32 v69 offset:13616
    ds_write_addtid_b32 v70 offset:13872
    ds_write_addtid_b32 v71 offset:14128
    ds_write_addtid_b32 v72 offset:14384
    ds_write_addtid_b32 v73 offset:14640
    ds_write_addtid_b32 v74 offset:14896
    ds_write_addtid_b32 v75 offset:15152
    ds_write_addtid_b32 v76 offset:15408
    ds_write_addtid_b32 v77 offset:15664
    ds_write_addtid_b32 v78 offset:15920
    ds_write_addtid_b32 v79 offset:16176
    s_waitcnt lgkmcnt(0)
    s_barrier
    s_endpgm
L_HA:
    s_mov_b32 s12, s38
    s_mov_b32 s13, s39
    s_mov_b32 s14, 0x126000
    s_mov_b32 s15, 0x20000
    v_min_u32 v16, 6, v14
    v_add_u32 v17, s69, v15
    v_mul_u32_u24 v17, 2688, v17
    v_lshl_add_u32 v2, v16, 4, v17
    v_add_u32 v3, 20480, v2
    s_mul_i32 s69, s6, 112
    s_mul_i32 s67, s65, 172032
    s_add_u32 s58, s67, s69
    s_add_u32 s68, s69, 1204224
    s_add_u32 s67, s58, 172032
    s_cmp_eq_u32 s67, s68
    s_cselect_b32 s59, s69, s67
    s_add_u32 s67, s59, 172032
    s_cmp_eq_u32 s67, s68
    s_cselect_b32 s60, s69, s67
    s_add_u32 s67, s60, 172032
    s_cmp_eq_u32 s67, s68
    s_cselect_b32 s61, s69, s67
    s_add_u32 s67, s61, 172032
    s_cmp_eq_u32 s67, s68
    s_cselect_b32 s62, s69, s67
    s_add_u32 s67, s62, 172032
    s_cmp_eq_u32 s67, s68
    s_cselect_b32 s63, s69, s67
    s_add_u32 s67, s63, 172032
    s_cmp_eq_u32 s67, s68
    s_cselect_b32 s64, s69, s67
    s_waitcnt vmcnt(8)
    s_barrier
    s_add_u32 m0, s74, 12288
    s_add_u32 s72, s72, 128
    s_cmp_ge_u32 s72, s73
    s_cselect_b32 s67, 896, 0
    s_sub_u32 s72, s72, s67
    buffer_load_dwordx4 v240, s[8:11], s72 offen offset:0 lds
    buffer_load_dwordx4 v241, s[8:11], s72 offen offset:1024 lds
    buffer_load_dwordx4 v242, s[8:11], s72 offen offset:2048 lds
    buffer_load_dwordx4 v243, s[8:11], s72 offen offset:3072 lds
    s_waitcnt vmcnt(8)
    s_barrier
    s_add_u32 m0, s74, 16384
    s_add_u32 s72, s72, 128
    s_cmp_ge_u32 s72, s73
    s_cselect_b32 s67, 896, 0
    s_sub_u32 s72, s72, s67
    buffer_load_dwordx4 v240, s[8:11], s72 offen offset:0 lds
    buffer_load_dwordx4 v241, s[8:11], s72 offen offset:1024 lds
    buffer_load_dwordx4 v242, s[8:11], s72 offen offset:2048 lds
    buffer_load_dwordx4 v243, s[8:11], s72 offen offset:3072 lds
    s_waitcnt vmcnt(8)
    s_barrier
    s_add_u32 m0, s74, 20480
    s_add_u32 s72, s72, 128
    s_cmp_ge_u32 s72, s73
    s_cselect_b32 s67, 896, 0
    s_sub_u32 s72, s72, s67
    buffer_load_dwordx4 v240, s[8:11], s72 offen offset:0 lds
    buffer_load_dwordx4 v241, s[8:11], s72 offen offset:1024 lds
    buffer_load_dwordx4 v242, s[8:11], s72 offen offset:2048 lds
    buffer_load_dwordx4 v243, s[8:11], s72 offen offset:3072 lds
    s_waitcnt vmcnt(8)
    s_barrier
    s_add_u32 m0, s74, 24576
    s_add_u32 s72, s72, 128
    s_cmp_ge_u32 s72, s73
    s_cselect_b32 s67, 896, 0
    s_sub_u32 s72, s72, s67
    buffer_load_dwordx4 v240, s[8:11], s72 offen offset:0 lds
    buffer_load_dwordx4 v241, s[8:11], s72 offen offset:1024 lds
    buffer_load_dwordx4 v242, s[8:11], s72 offen offset:2048 lds
    buffer_load_dwordx4 v243, s[8:11], s72 offen offset:3072 lds
    s_waitcnt vmcnt(8)
    s_barrier
    s_add_u32 m0, s75, 8192
    s_add_u32 s67, s58, 896
    buffer_load_dwordx4 v2, s[12:15], s67 offen lds
    buffer_load_dwordx4 v3, s[12:15], s67 offen offset:1024 lds
    s_add_u32 m0, s75, 16384
    s_add_u32 s67, s59, 896
    buffer_load_dwordx4 v2, s[12:15], s67 offen lds
    buffer_load_dwordx4 v3, s[12:15], s67 offen offset:1024 lds
    s_waitcnt vmcnt(8)
    s_barrier
    s_add_u32 m0, s75, 24576
    s_add_u32 s67, s60, 896
    buffer_load_dwordx4 v2, s[12:15], s67 offen lds
    buffer_load_dwordx4 v3, s[12:15], s67 offen offset:1024 lds
    s_add_u32 m0, s75, 32768
    s_add_u32 s67, s61, 896
    buffer_load_dwordx4 v2, s[12:15], s67 offen lds
    buffer_load_dwordx4 v3, s[12:15], s67 offen offset:1024 lds
    s_waitcnt vmcnt(8)
    s_barrier
    s_add_u32 m0, s75, 40960
    s_add_u32 s67, s62, 896
    buffer_load_dwordx4 v2, s[12:15], s67 offen lds
    buffer_load_dwordx4 v3, s[12:15], s67 offen offset:1024 lds
    s_bfe_u32 s67, s2, 0x20001
    s_xor_b32 s67, s67, 0
    s_lshr_b32 s68, s2, 3
    s_lshl_b32 s67, s67, 5
    s_add_u32 s67, s67, s68
    s_and_b32 s68, s2, 1
    s_cmp_lg_u32 s4, 0
    s_cbranch_scc1 Lt133
    s_mul_i32 s67, s67, 49
    s_mul_i32 s68, s68, 14
    v_min_u32 v246, 48, v0
    v_add_u32 v246, s67, v246
    v_mul_u32_u24 v247, 37450, v246
    v_lshrrev_b32 v247, 19, v247
    v_mul_u32_u24 v247, 14, v247
    v_add3_u32 v246, v246, v247, s68
    v_lshlrev_b32 v246, 7, v246
    buffer_load_dword v245, v246, s[24:27], 0 offen
Lt133:
    s_cmp_lg_u32 s4, 1
    s_cbranch_scc1 Lt234
    s_mul_i32 s67, s67, 42
    s_mul_i32 s68, s68, 3
    v_min_u32 v246, 41, v0
    v_add_u32 v246, s67, v246
    v_lshrrev_b32 v247, 2, v246
    v_mul_u32_u24 v247, 3, v247
    v_add3_u32 v246, v246, v247, s68
    v_lshlrev_b32 v246, 7, v246
    buffer_load_dword v245, v246, s[24:27], 0 offen
Lt234:
    s_barrier
    s_add_u32 m0, s75, 49152
    s_add_u32 s67, s63, 896
    buffer_load_dwordx4 v2, s[12:15], s67 offen lds
    buffer_load_dwordx4 v3, s[12:15], s67 offen offset:1024 lds
    s_add_u32 m0, s75, 57344
    s_add_u32 s67, s64, 896
    buffer_load_dwordx4 v2, s[12:15], s67 offen lds
    buffer_load_dwordx4 v3, s[12:15], s67 offen offset:1024 lds
    s_waitcnt vmcnt(8)
    s_barrier
    s_add_u32 m0, s75, 65536
    s_add_u32 s67, s58, 1792
    buffer_load_dwordx4 v2, s[12:15], s67 offen lds
    buffer_load_dwordx4 v3, s[12:15], s67 offen offset:1024 lds
    s_add_u32 m0, s75, 73728
    s_add_u32 s67, s59, 1792
    buffer_load_dwordx4 v2, s[12:15], s67 offen lds
    buffer_load_dwordx4 v3, s[12:15], s67 offen offset:1024 lds
    s_add_u32 m0, s75, 81920
    s_add_u32 s67, s60, 1792
    buffer_load_dwordx4 v2, s[12:15], s67 offen lds
    buffer_load_dwordx4 v3, s[12:15], s67 offen offset:1024 lds
    s_waitcnt vmcnt(12)
    s_add_u32 m0, s75, 90112
    s_add_u32 s67, s61, 1792
    buffer_load_dwordx4 v2, s[12:15], s67 offen lds
    buffer_load_dwordx4 v3, s[12:15], s67 offen offset:1024 lds
    s_cmp_lg_u32 s4, 2
    s_cbranch_scc1 Lt435
    s_xor_b32 s67, s2, 0
    s_mul_i32 s67, s67, 49
    v_min_u32 v246, 48, v0
    v_add_u32 v246, s67, v246
    v_lshlrev_b32 v246, 7, v246
    buffer_load_dword v245, v246, s[24:27], 0 offen
Lt435:
    s_cmp_lg_u32 s4, 3
    s_cbranch_scc1 Lt536
    s_mul_i32 s67, s2, 13
    v_min_u32 v246, 12, v0
    v_add_u32 v246, s67, v246
    v_lshlrev_b32 v246, 7, v246
    buffer_load_dword v245, v246, s[24:27], 0 offen
Lt536:
    s_waitcnt lgkmcnt(0)
    s_add_u32 s20, s56, 0x0
    s_addc_u32 s21, s57, 0
    s_mov_b32 s22, 0xc00000
    s_mov_b32 s23, 0x20000
    s_mov_b32 s28, s54
    s_mov_b32 s29, s55
    s_mov_b32 s30, 0x100
    s_mov_b32 s31, 0x20000
    v_lshrrev_b32 v16, 5, v0
    v_mul_u32_u24 v16, 4, v16
    v_bfe_u32 v17, v0, 2, 2
    v_add_u32 v16, v16, v17
    v_lshlrev_b32 v16, 7, v16
    v_bfe_u32 v17, v0, 4, 1
    v_lshlrev_b32 v17, 5, v17
    v_and_b32 v8, 3, v0
    v_lshl_add_u32 v8, v8, 3, v17
    v_bfe_u32 v17, v0, 3, 1
    v_lshlrev_b32 v17, 6, v17
    v_xor_b32 v8, v8, v17
    v_add_u32 v8, v8, v16
    v_add_u32 v8, s75, v8
    v_add_u32 v9, 0x10000, v8
    v_add_u32 v10, 0x20000, v8
    v_lshrrev_b32 v16, 5, v0
    v_mul_u32_u24 v16, 4, v16
    v_bfe_u32 v17, v0, 2, 2
    v_add_u32 v16, v16, v17
    v_lshlrev_b32 v16, 7, v16
    v_bfe_u32 v17, v0, 4, 1
    v_lshlrev_b32 v17, 5, v17
    v_and_b32 v11, 3, v0
    v_lshl_add_u32 v11, v11, 3, v17
    v_add_u32 v11, 64, v11
    v_bfe_u32 v17, v0, 3, 1
    v_lshlrev_b32 v17, 6, v17
    v_xor_b32 v11, v11, v17
    v_add_u32 v11, v11, v16
    v_add_u32 v11, s75, v11
    v_add_u32 v12, 0x10000, v11
    v_add_u32 v13, 0x20000, v11
    s_mov_b32 s16, s48
    s_mov_b32 s17, s49
    s_mov_b32 s18, 0x188000
    s_mov_b32 s19, 0x20000
    s_mul_i32 s69, s4, 448
    s_lshl_b32 s77, s7, 7
    v_mov_b32 v16, v14
    v_add_u32 v17, s69, v15
    v_mul_u32_u24 v17, 896, v17
    v_lshl_add_u32 v5, v16, 4, v17
    v_add_u32 v6, 6144, v5
    s_and_b32 s67, s4, 1
    s_lshl1_add_u32 s68, s6, s67
    s_lshl_b32 s67, s67, 13
    s_add_u32 s67, s67, 131072
    v_add_u32 v4, s67, v1
    s_and_b32 s67, s4, 1
    s_lshl3_add_u32 s46, s6, s67
    s_lshl4_add_u32 s46, s46, s5
    s_lshl_b32 s46, s46, 4
    s_add_u32 s46, s46, 0xa94000
    s_lshl_b32 s47, s68, 5
    s_add_u32 s47, s47, s5
    s_lshl_b32 s47, s47, 10
    s_add_u32 s47, s47, 0x980000
    v_lshrrev_b32 v16, 5, v0
    v_lshlrev_b32 v14, 4, v16
    v_and_b32 v17, 15, v0
    v_add_u32 v17, v17, v14
    v_lshlrev_b32 v17, 4, v17
    v_bfe_u32 v16, v0, 4, 1
    v_lshl_add_u32 v15, v16, 14, v17
    v_lshl_add_u32 v254, v16, 10, v17
    v_lshlrev_b32 v14, 5, v14
    v_mov_b32 v32, 0x3f803f80
    v_mov_b32 v33, 0x3f803f80
    v_mov_b32 v34, 0x3f803f80
    v_mov_b32 v35, 0x3f803f80
    s_waitcnt vmcnt(10)
    s_barrier
    s_add_u32 m0, s75, 98304
    s_add_u32 s67, s62, 1792
    buffer_load_dwordx4 v2, s[12:15], s67 offen lds
    buffer_load_dwordx4 v3, s[12:15], s67 offen offset:1024 lds
    s_add_u32 m0, s75, 106496
    s_add_u32 s67, s63, 1792
    buffer_load_dwordx4 v2, s[12:15], s67 offen lds
    buffer_load_dwordx4 v3, s[12:15], s67 offen offset:1024 lds
    s_waitcnt vmcnt(12)
    s_add_u32 m0, s75, 114688
    s_add_u32 s67, s77, 0
    buffer_load_dwordx4 v5, s[16:19], s67 offen lds
    buffer_load_dwordx4 v6, s[16:19], s67 offen offset:1024 lds
    s_waitcnt vmcnt(12)
    s_add_u32 m0, s75, 122880
    s_add_u32 s67, s77, 14336
    buffer_load_dwordx4 v5, s[16:19], s67 offen lds
    buffer_load_dwordx4 v6, s[16:19], s67 offen offset:1024 lds
    s_waitcnt vmcnt(12)
    s_add_u32 m0, s75, 8192
    s_add_u32 s67, s77, 28672
    buffer_load_dwordx4 v5, s[16:19], s67 offen lds
    buffer_load_dwordx4 v6, s[16:19], s67 offen offset:1024 lds
    s_waitcnt vmcnt(12)
    s_add_u32 m0, s75, 16384
    s_add_u32 s67, s77, 43008
    buffer_load_dwordx4 v5, s[16:19], s67 offen lds
    buffer_load_dwordx4 v6, s[16:19], s67 offen offset:1024 lds
    s_waitcnt vmcnt(6)
    ds_read_b64_tr_b16 v[80:81], v9 offset:49152
    ds_read_b64_tr_b16 v[82:83], v9 offset:50176
    ds_read_b64_tr_b16 v[84:85], v12 offset:49152
    ds_read_b64_tr_b16 v[86:87], v12 offset:50176
    s_barrier
    s_add_u32 m0, s75, 24576
    s_add_u32 s67, s64, 1792
    buffer_load_dwordx4 v2, s[12:15], s67 offen lds
    buffer_load_dwordx4 v3, s[12:15], s67 offen offset:1024 lds
    s_add_u32 m0, s75, 32768
    s_add_u32 s67, s58, 0
    buffer_load_dwordx4 v2, s[12:15], s67 offen lds
    buffer_load_dwordx4 v3, s[12:15], s67 offen offset:1024 lds
    s_add_u32 m0, s75, 40960
    s_add_u32 s67, s59, 0
    buffer_load_dwordx4 v2, s[12:15], s67 offen lds
    buffer_load_dwordx4 v3, s[12:15], s67 offen offset:1024 lds
    s_waitcnt lgkmcnt(0)
    s_add_u32 m0, s75, 114688
    s_add_u32 s67, s77, 229376
    buffer_load_dwordx4 v5, s[16:19], s67 offen lds
    buffer_load_dwordx4 v6, s[16:19], s67 offen offset:1024 lds
    s_waitcnt vmcnt(12)
    ds_read_b64_tr_b16 v[88:89], v9 offset:57344
    ds_read_b64_tr_b16 v[90:91], v9 offset:58368
    ds_read_b64_tr_b16 v[92:93], v12 offset:57344
    ds_read_b64_tr_b16 v[94:95], v12 offset:58368
    s_waitcnt lgkmcnt(0)
    s_add_u32 m0, s75, 122880
    s_add_u32 s67, s77, 243712
    buffer_load_dwordx4 v5, s[16:19], s67 offen lds
    buffer_load_dwordx4 v6, s[16:19], s67 offen offset:1024 lds
    s_waitcnt vmcnt(12)
    ds_read_b64_tr_b16 v[96:97], v8 offset:8192
    ds_read_b64_tr_b16 v[98:99], v8 offset:9216
    ds_read_b64_tr_b16 v[100:101], v11 offset:8192
    ds_read_b64_tr_b16 v[102:103], v11 offset:9216
    s_barrier
    s_buffer_load_dword s56, s[28:31], 0
    s_add_u32 m0, s75, 49152
    s_add_u32 s67, s60, 0
    buffer_load_dwordx4 v2, s[12:15], s67 offen lds
    buffer_load_dwordx4 v3, s[12:15], s67 offen offset:1024 lds
    s_waitcnt vmcnt(12)
    s_add_u32 m0, s75, 57344
    s_add_u32 s67, s61, 0
    buffer_load_dwordx4 v2, s[12:15], s67 offen lds
    buffer_load_dwordx4 v3, s[12:15], s67 offen offset:1024 lds
    s_waitcnt vmcnt(12)
    s_add_u32 m0, s75, 65536
    s_add_u32 s67, s62, 0
    buffer_load_dwordx4 v2, s[12:15], s67 offen lds
    buffer_load_dwordx4 v3, s[12:15], s67 offen offset:1024 lds
    s_waitcnt lgkmcnt(0)
    s_waitcnt vmcnt(12)
    s_add_u32 m0, s75, 8192
    s_add_u32 s67, s77, 258048
    buffer_load_dwordx4 v5, s[16:19], s67 offen lds
    buffer_load_dwordx4 v6, s[16:19], s67 offen offset:1024 lds
    ds_read_b64_tr_b16 v[104:105], v8 offset:16384
    ds_read_b64_tr_b16 v[106:107], v8 offset:17408
    ds_read_b64_tr_b16 v[108:109], v11 offset:16384
    ds_read_b64_tr_b16 v[110:111], v11 offset:17408
    s_waitcnt lgkmcnt(0)
    s_waitcnt vmcnt(12)
    s_add_u32 m0, s75, 16384
    s_add_u32 s67, s77, 272384
    buffer_load_dwordx4 v5, s[16:19], s67 offen lds
    buffer_load_dwordx4 v6, s[16:19], s67 offen offset:1024 lds
    s_waitcnt vmcnt(12)
    ds_read_b64_tr_b16 v[112:113], v9 offset:49152
    ds_read_b64_tr_b16 v[114:115], v9 offset:50176
    ds_read_b64_tr_b16 v[116:117], v12 offset:49152
    ds_read_b64_tr_b16 v[118:119], v12 offset:50176
Lagain37:
    s_waitcnt lgkmcnt(0)
    s_cmp_ge_u32 s56, 0x10
    s_cbranch_scc1 Lok38
    s_cmp_eq_u32 s71, 0
    s_cbranch_scc1 Lok38
    s_sub_u32 s71, s71, 1
    buffer_load_dword v7, off, s[28:31], 0 sc1
    s_waitcnt vmcnt(0)
    v_readfirstlane_b32 s56, v7
    s_nop 1
    s_branch Lagain37
Lok38:
    s_barrier
    ds_read_b128 v[208:211], v4 offset:16384
    ds_read_b128 v[212:215], v4 offset:17408
    ds_read_b128 v[216:219], v4 offset:18432
    ds_read_b128 v[220:223], v4 offset:19456
    ds_read_b128 v[224:227], v4 offset:20480
    ds_read_b128 v[228:231], v4 offset:21504
    ds_read_b128 v[232:235], v4 offset:22528
    ds_read_b128 v[236:239], v4 offset:23552
    s_waitcnt lgkmcnt(0)
    s_cmp_lt_u32 s4, 2
    s_cbranch_scc1 Lnoz39
    v_mfma_f32_32x32x16_bf16 v[16:31], v[208:211], v[32:35], 0
    v_mfma_f32_32x32x16_bf16 v[16:31], v[212:215], v[32:35], v[16:31]
    v_mfma_f32_32x32x16_bf16 v[16:31], v[216:219], v[32:35], v[16:31]
    v_mfma_f32_32x32x16_bf16 v[16:31], v[220:223], v[32:35], v[16:31]
    v_mfma_f32_32x32x16_bf16 v[16:31], v[224:227], v[32:35], v[16:31]
    v_mfma_f32_32x32x16_bf16 v[16:31], v[228:231], v[32:35], v[16:31]
    v_mfma_f32_32x32x16_bf16 v[16:31], v[232:235], v[32:35], v[16:31]
    v_mfma_f32_32x32x16_bf16 v[16:31], v[236:239], v[32:35], v[16:31]
    s_nop 11
    v_cvt_pk_bf16_f32 v36, v16, v17
    v_cvt_pk_bf16_f32 v37, v18, v19
    v_cvt_pk_bf16_f32 v38, v20, v21
    v_cvt_pk_bf16_f32 v39, v22, v23
    v_cvt_pk_bf16_f32 v40, v24, v25
    v_cvt_pk_bf16_f32 v41, v26, v27
    v_cvt_pk_bf16_f32 v42, v28, v29
    v_cvt_pk_bf16_f32 v43, v30, v31
    s_mov_b32 exec_lo, 1
    s_mov_b32 exec_hi, 1
    buffer_store_dwordx4 v[36:39], v14, s[20:23], s46 offen offset:0 sc1
    buffer_store_dwordx4 v[40:43], v14, s[20:23], s46 offen offset:1024 sc1
    s_mov_b64 exec, -1
Lnoz39:
    s_add_u32 m0, s75, 73728
    s_add_u32 s67, s63, 0
    buffer_load_dwordx4 v2, s[12:15], s67 offen lds
    buffer_load_dwordx4 v3, s[12:15], s67 offen offset:1024 lds
    s_waitcnt vmcnt(12)
    s_add_u32 m0, s75, 81920
    s_add_u32 s67, s64, 0
    buffer_load_dwordx4 v2, s[12:15], s67 offen lds
    buffer_load_dwordx4 v3, s[12:15], s67 offen offset:1024 lds
    s_waitcnt vmcnt(12)
    s_add_u32 m0, s75, 90112
    s_add_u32 s67, s77, 57344
    buffer_load_dwordx4 v5, s[16:19], s67 offen lds
    buffer_load_dwordx4 v6, s[16:19], s67 offen offset:1024 lds
    s_waitcnt vmcnt(12)
    s_add_u32 m0, s75, 114688
    s_add_u32 s67, s77, 71680
    buffer_load_dwordx4 v5, s[16:19], s67 offen lds
    buffer_load_dwordx4 v6, s[16:19], s67 offen offset:1024 lds
    ds_read_b64_tr_b16 v[120:121], v9 offset:57344
    ds_read_b64_tr_b16 v[122:123], v9 offset:58368
    ds_read_b64_tr_b16 v[124:125], v12 offset:57344
    ds_read_b64_tr_b16 v[126:127], v12 offset:58368
    s_waitcnt vmcnt(12)
    s_barrier
    s_waitcnt lgkmcnt(0)
    s_cmp_ge_u32 s4, 2
    s_cbranch_scc1 Lkvdone40
    ds_read_b128 v[48:51], v4 offset:0
    ds_read_b128 v[52:55], v4 offset:1024
    ds_read_b128 v[56:59], v4 offset:2048
    ds_read_b128 v[60:63], v4 offset:3072
    ds_read_b128 v[64:67], v4 offset:4096
    ds_read_b128 v[68:71], v4 offset:5120
    ds_read_b128 v[72:75], v4 offset:6144
    ds_read_b128 v[76:79], v4 offset:7168
    s_setprio 2
    s_waitcnt lgkmcnt(7)
    v_mfma_f32_32x32x16_bf16 v[16:31], v[48:51], v[208:211], 0
    s_waitcnt lgkmcnt(6)
    v_mfma_f32_32x32x16_bf16 v[16:31], v[52:55], v[212:215], v[16:31]
    s_waitcnt lgkmcnt(5)
    v_mfma_f32_32x32x16_bf16 v[16:31], v[56:59], v[216:219], v[16:31]
    s_waitcnt lgkmcnt(4)
    v_mfma_f32_32x32x16_bf16 v[16:31], v[60:63], v[220:223], v[16:31]
    s_waitcnt lgkmcnt(3)
    v_mfma_f32_32x32x16_bf16 v[16:31], v[64:67], v[224:227], v[16:31]
    s_waitcnt lgkmcnt(2)
    v_mfma_f32_32x32x16_bf16 v[16:31], v[68:71], v[228:231], v[16:31]
    s_waitcnt lgkmcnt(1)
    v_mfma_f32_32x32x16_bf16 v[16:31], v[72:75], v[232:235], v[16:31]
    s_waitcnt lgkmcnt(0)
    v_mfma_f32_32x32x16_bf16 v[16:31], v[76:79], v[236:239], v[16:31]
    s_nop 11
    v_cvt_pk_bf16_f32 v16, v16, v17
    v_cvt_pk_bf16_f32 v17, v18, v19
    v_cvt_pk_bf16_f32 v18, v20, v21
    v_cvt_pk_bf16_f32 v19, v22, v23
    v_cvt_pk_bf16_f32 v20, v24, v25
    v_cvt_pk_bf16_f32 v21, v26, v27
    v_cvt_pk_bf16_f32 v22, v28, v29
    v_cvt_pk_bf16_f32 v23, v30, v31
    buffer_store_dwordx4 v[16:19], v15, s[20:23], s47 offen offset:0 sc1
    buffer_store_dwordx4 v[20:23], v15, s[20:23], s47 offen offset:512 sc1
    s_setprio 0
Lkvdone40:
    s_add_u32 m0, s75, 98304
    s_add_u32 s67, s77, 86016
    buffer_load_dwordx4 v5, s[16:19], s67 offen lds
    buffer_load_dwordx4 v6, s[16:19], s67 offen offset:1024 lds
    s_waitcnt vmcnt(12)
    s_add_u32 m0, s75, 106496
    s_add_u32 s67, s77, 100352
    buffer_load_dwordx4 v5, s[16:19], s67 offen lds
    buffer_load_dwordx4 v6, s[16:19], s67 offen offset:1024 lds
    s_waitcnt vmcnt(12)
    s_add_u32 m0, s75, 24576
    s_add_u32 s67, s77, 286720
    buffer_load_dwordx4 v5, s[16:19], s67 offen lds
    buffer_load_dwordx4 v6, s[16:19], s67 offen offset:1024 lds
    s_cmp_ge_u32 s4, 2
    s_cbranch_scc1 Lkfdone41
    s_lshl1_add_u32 s68, s6, s4
    s_lshl_b32 s68, s68, 8
    s_lshl2_add_u32 s68, s5, s68
    s_add_u32 s68, s68, 0xa9e000
    s_waitcnt vmcnt(6)
    v_mov_b32 v44, 1
    s_mov_b64 exec, 1
    buffer_store_dword v44, off, s[20:23], s68 sc1
    s_mov_b64 exec, -1
Lkfdone41:
    s_waitcnt vmcnt(10)
    s_barrier
    s_add_u32 m0, s75, 147456
    s_add_u32 s67, s77, 301056
    buffer_load_dwordx4 v5, s[16:19], s67 offen lds
    buffer_load_dwordx4 v6, s[16:19], s67 offen offset:1024 lds
    s_add_u32 m0, s75, 155648
    s_add_u32 s67, s77, 315392
    buffer_load_dwordx4 v5, s[16:19], s67 offen lds
    buffer_load_dwordx4 v6, s[16:19], s67 offen offset:1024 lds
    s_waitcnt vmcnt(12)
    s_add_u32 m0, s75, 32768
    s_add_u32 s67, s77, 329728
    buffer_load_dwordx4 v5, s[16:19], s67 offen lds
    buffer_load_dwordx4 v6, s[16:19], s67 offen offset:1024 lds
    s_waitcnt vmcnt(12)
    s_add_u32 m0, s75, 40960
    s_add_u32 s67, s77, 114688
    buffer_load_dwordx4 v5, s[16:19], s67 offen lds
    buffer_load_dwordx4 v6, s[16:19], s67 offen offset:1024 lds
    s_waitcnt vmcnt(12)
    s_add_u32 m0, s75, 49152
    s_add_u32 s67, s77, 129024
    buffer_load_dwordx4 v5, s[16:19], s67 offen lds
    buffer_load_dwordx4 v6, s[16:19], s67 offen offset:1024 lds
    s_waitcnt vmcnt(12)
    s_add_u32 m0, s75, 57344
    s_add_u32 s67, s77, 143360
    buffer_load_dwordx4 v5, s[16:19], s67 offen lds
    buffer_load_dwordx4 v6, s[16:19], s67 offen offset:1024 lds
    s_waitcnt vmcnt(12)
    s_add_u32 m0, s75, 131072
    s_add_u32 s67, s77, 157696
    buffer_load_dwordx4 v5, s[16:19], s67 offen lds
    buffer_load_dwordx4 v6, s[16:19], s67 offen offset:1024 lds
    s_waitcnt vmcnt(12)
    s_add_u32 m0, s75, 139264
    s_add_u32 s67, s77, 344064
    buffer_load_dwordx4 v5, s[16:19], s67 offen lds
    buffer_load_dwordx4 v6, s[16:19], s67 offen offset:1024 lds
    s_waitcnt vmcnt(12)
    s_add_u32 m0, s75, 122880
    s_add_u32 s67, s77, 358400
    buffer_load_dwordx4 v5, s[16:19], s67 offen lds
    buffer_load_dwordx4 v6, s[16:19], s67 offen offset:1024 lds
    ds_read_b64_tr_b16 v[128:129], v8 offset:8192
    ds_read_b64_tr_b16 v[130:131], v8 offset:9216
    ds_read_b64_tr_b16 v[132:133], v11 offset:8192
    ds_read_b64_tr_b16 v[134:135], v11 offset:9216
    s_waitcnt lgkmcnt(0)
    s_waitcnt vmcnt(12)
    s_add_u32 m0, s75, 8192
    s_add_u32 s67, s77, 372736
    buffer_load_dwordx4 v5, s[16:19], s67 offen lds
    buffer_load_dwordx4 v6, s[16:19], s67 offen offset:1024 lds
    ds_read_b64_tr_b16 v[136:137], v8 offset:16384
    ds_read_b64_tr_b16 v[138:139], v8 offset:17408
    ds_read_b64_tr_b16 v[140:141], v11 offset:16384
    ds_read_b64_tr_b16 v[142:143], v11 offset:17408
    s_waitcnt lgkmcnt(0)
    s_waitcnt vmcnt(12)
    s_add_u32 m0, s75, 16384
    s_add_u32 s67, s77, 387072
    buffer_load_dwordx4 v5, s[16:19], s67 offen lds
    buffer_load_dwordx4 v6, s[16:19], s67 offen offset:1024 lds
    ds_read_b64_tr_b16 v[144:145], v9 offset:24576
    ds_read_b64_tr_b16 v[146:147], v9 offset:25600
    ds_read_b64_tr_b16 v[148:149], v12 offset:24576
    ds_read_b64_tr_b16 v[150:151], v12 offset:25600
    ds_read_b64_tr_b16 v[152:153], v9 offset:49152
    ds_read_b64_tr_b16 v[154:155], v9 offset:50176
    ds_read_b64_tr_b16 v[156:157], v12 offset:49152
    ds_read_b64_tr_b16 v[158:159], v12 offset:50176
    ds_read_b64_tr_b16 v[160:161], v9 offset:32768
    ds_read_b64_tr_b16 v[162:163], v9 offset:33792
    ds_read_b64_tr_b16 v[164:165], v12 offset:32768
    ds_read_b64_tr_b16 v[166:167], v12 offset:33792
    ds_read_b64_tr_b16 v[168:169], v9 offset:40960
    ds_read_b64_tr_b16 v[170:171], v9 offset:41984
    ds_read_b64_tr_b16 v[172:173], v12 offset:40960
    ds_read_b64_tr_b16 v[174:175], v12 offset:41984
    ds_read_b64_tr_b16 v[176:177], v8 offset:24576
    ds_read_b64_tr_b16 v[178:179], v8 offset:25600
    ds_read_b64_tr_b16 v[180:181], v11 offset:24576
    ds_read_b64_tr_b16 v[182:183], v11 offset:25600
    ds_read_b64_tr_b16 v[184:185], v10 offset:16384
    ds_read_b64_tr_b16 v[186:187], v10 offset:17408
    ds_read_b64_tr_b16 v[188:189], v13 offset:16384
    ds_read_b64_tr_b16 v[190:191], v13 offset:17408
    s_waitcnt lgkmcnt(0)
    v_add_u32 v248, 0x0, v1
    v_add_u32 v252, 0x0, v1
    v_add_u32 v249, 0x100000, v1
    v_add_u32 v253, 0x800, v1
    v_add_u32 v250, 0x800, v1
    v_add_u32 v254, 0x1000, v1
    v_add_u32 v251, 0x100800, v1
    v_add_u32 v255, 0x1800, v1
    s_lshl2_add_u32 s36, s66, s4
    s_lshl_b32 s36, s36, 12
    s_add_u32 s37, s36, 0x80000
    s_lshl3_add_u32 s44, s66, s4
    s_lshl_b32 s44, s44, 13
    s_add_u32 s44, s44, 0x700000
    s_add_u32 s45, s44, 32768
    s_lshl3_add_u32 s46, s7, s4
    s_lshl_b32 s46, s46, 13
    s_add_u32 s46, s46, 0x900000
    s_add_u32 s47, s46, 32768
    s_lshr_b32 s67, s66, 1
    s_lshl2_add_u32 s67, s67, s4
    s_and_b32 s68, s66, 1
    s_lshl3_add_u32 s67, s67, s68
    s_lshl_b32 s67, s67, 4
    s_add_u32 s49, s67, 0xa90000
    s_add_u32 s50, s49, 8192
    s_lshr_b32 s68, s7, 1
    s_lshl2_add_u32 s67, s4, s68
    s_lshl_b32 s67, s67, 7
    s_lshr_b32 s68, s66, 2
    s_mul_i32 s68, s68, 2304
    s_add_u32 s67, s67, s68
    s_add_u32 s51, s67, 0xa98000
    s_add_u32 s38, s36, 0x200000
    s_add_u32 s39, s37, 0x200000
    s_add_u32 s40, s38, 0x200000
    s_add_u32 s41, s39, 0x200000
    s_add_u32 s42, s40, 0x200000
    s_add_u32 s43, s41, 0x200000
    s_buffer_load_dwordx4 s[52:55], s[20:23], s49 glc
    s_waitcnt vmcnt(12)
    s_add_u32 m0, s75, 90112
    s_add_u32 s67, s77, 172032
    buffer_load_dwordx4 v5, s[16:19], s67 offen lds
    buffer_load_dwordx4 v6, s[16:19], s67 offen offset:1024 lds
    s_waitcnt vmcnt(12)
    s_add_u32 m0, s75, 114688
    s_add_u32 s67, s77, 186368
    buffer_load_dwordx4 v5, s[16:19], s67 offen lds
    buffer_load_dwordx4 v6, s[16:19], s67 offen offset:1024 lds
    s_waitcnt vmcnt(12)
    s_add_u32 m0, s75, 98304
    s_add_u32 s67, s77, 200704
    buffer_load_dwordx4 v5, s[16:19], s67 offen lds
    buffer_load_dwordx4 v6, s[16:19], s67 offen offset:1024 lds
    s_waitcnt vmcnt(12)
    s_add_u32 m0, s75, 106496
    s_add_u32 s67, s77, 215040
    buffer_load_dwordx4 v5, s[16:19], s67 offen lds
    buffer_load_dwordx4 v6, s[16:19], s67 offen offset:1024 lds
Lagain42:
    s_waitcnt lgkmcnt(0)
    s_min_u32 s52, s52, s54
    s_min_u32 s53, s53, s55
    s_min_u32 s52, s52, s53
    s_cmp_ge_u32 s52, 0x1
    s_cbranch_scc1 Lok43
    s_cmp_eq_u32 s71, 0
    s_cbranch_scc1 Lok43
    s_sub_u32 s71, s71, 1
    s_buffer_load_dwordx4 s[52:55], s[20:23], s49 glc
    s_branch Lagain42
Lok43:
    buffer_load_dwordx4 v[192:195], v248, s[20:23], s36 offen offset:0 sc1
    buffer_load_dwordx4 v[196:199], v248, s[20:23], s36 offen offset:1024 sc1
    buffer_load_dwordx4 v[200:203], v248, s[20:23], s37 offen offset:0 sc1
    buffer_load_dwordx4 v[204:207], v248, s[20:23], s37 offen offset:1024 sc1
    buffer_load_dwordx4 v[208:211], v249, s[20:23], s36 offen offset:0 sc1
    buffer_load_dwordx4 v[212:215], v249, s[20:23], s36 offen offset:1024 sc1
    buffer_load_dwordx4 v[216:219], v249, s[20:23], s37 offen offset:0 sc1
    buffer_load_dwordx4 v[220:223], v249, s[20:23], s37 offen offset:1024 sc1
    s_cmp_ge_u32 s52, 0x2
    s_cbranch_scc1 Lseen44
    s_buffer_load_dwordx4 s[52:55], s[20:23], s49 glc
Lseen44:
    buffer_load_dwordx4 v[224:227], v250, s[20:23], s36 offen offset:0 sc1
    buffer_load_dwordx4 v[228:231], v250, s[20:23], s36 offen offset:1024 sc1
    buffer_load_dwordx4 v[232:235], v250, s[20:23], s37 offen offset:0 sc1
    buffer_load_dwordx4 v[236:239], v250, s[20:23], s37 offen offset:1024 sc1
    s_waitcnt vmcnt(10)
    v_mfma_f32_32x32x16_bf16 v[16:31], v[192:195], v[80:83], 0
    v_mfma_f32_32x32x16_bf16 v[32:47], v[196:199], v[80:83], 0
    v_mfma_f32_32x32x16_bf16 v[48:63], v[192:195], v[84:87], 0
    v_mfma_f32_32x32x16_bf16 v[64:79], v[196:199], v[84:87], 0
    s_waitcnt vmcnt(8)
    v_mfma_f32_32x32x16_bf16 v[16:31], v[200:203], v[88:91], v[16:31]
    buffer_load_dwordx4 v[240:243], v251, s[20:23], s36 offen offset:0 sc1
    v_mfma_f32_32x32x16_bf16 v[32:47], v[204:207], v[88:91], v[32:47]
    buffer_load_dwordx4 v[244:247], v251, s[20:23], s36 offen offset:1024 sc1
    v_mfma_f32_32x32x16_bf16 v[48:63], v[200:203], v[92:95], v[48:63]
    buffer_load_dwordx4 v[192:195], v251, s[20:23], s37 offen offset:0 sc1
    v_mfma_f32_32x32x16_bf16 v[64:79], v[204:207], v[92:95], v[64:79]
    buffer_load_dwordx4 v[196:199], v251, s[20:23], s37 offen offset:1024 sc1
    s_waitcnt vmcnt(10)
    v_mfma_f32_32x32x16_bf16 v[16:31], v[208:211], v[96:99], v[16:31]
    v_mfma_f32_32x32x16_bf16 v[32:47], v[212:215], v[96:99], v[32:47]
Lagain45:
    s_waitcnt lgkmcnt(0)
    s_min_u32 s52, s52, s54
    s_min_u32 s53, s53, s55
    s_min_u32 s52, s52, s53
    s_cmp_ge_u32 s52, 0x2
    s_cbranch_scc1 Lok46
    s_cmp_eq_u32 s71, 0
    s_cbranch_scc1 Lok46
    s_sub_u32 s71, s71, 1
    s_buffer_load_dwordx4 s[52:55], s[20:23], s49 glc
    s_branch Lagain45
Lok46:
    buffer_load_dwordx4 v[80:83], v248, s[20:23], s38 offen offset:0 sc1
    v_mfma_f32_32x32x16_bf16 v[48:63], v[208:211], v[100:103], v[48:63]
    buffer_load_dwordx4 v[84:87], v248, s[20:23], s38 offen offset:1024 sc1
    v_mfma_f32_32x32x16_bf16 v[64:79], v[212:215], v[100:103], v[64:79]
    buffer_load_dwordx4 v[200:203], v248, s[20:23], s39 offen offset:0 sc1
    s_waitcnt vmcnt(11)
    v_mfma_f32_32x32x16_bf16 v[16:31], v[216:219], v[104:107], v[16:31]
    v_mfma_f32_32x32x16_bf16 v[32:47], v[220:223], v[104:107], v[32:47]
    buffer_load_dwordx4 v[204:207], v248, s[20:23], s39 offen offset:1024 sc1
    v_mfma_f32_32x32x16_bf16 v[48:63], v[216:219], v[108:111], v[48:63]
    buffer_load_dwordx4 v[88:91], v249, s[20:23], s38 offen offset:0 sc1
    v_mfma_f32_32x32x16_bf16 v[64:79], v[220:223], v[108:111], v[64:79]
    buffer_load_dwordx4 v[92:95], v249, s[20:23], s38 offen offset:1024 sc1
    s_waitcnt vmcnt(12)
    v_mfma_f32_32x32x16_bf16 v[16:31], v[224:227], v[112:115], v[16:31]
    v_mfma_f32_32x32x16_bf16 v[32:47], v[228:231], v[112:115], v[32:47]
    buffer_load_dwordx4 v[208:211], v249, s[20:23], s39 offen offset:0 sc1
    v_mfma_f32_32x32x16_bf16 v[48:63], v[224:227], v[116:119], v[48:63]
    buffer_load_dwordx4 v[212:215], v249, s[20:23], s39 offen offset:1024 sc1
    v_mfma_f32_32x32x16_bf16 v[64:79], v[228:231], v[116:119], v[64:79]
    s_buffer_load_dwordx4 s[56:59], s[20:23], s50 glc
    buffer_load_dwordx4 v[96:99], v250, s[20:23], s38 offen offset:0 sc1
    s_waitcnt vmcnt(13)
    v_mfma_f32_32x32x16_bf16 v[16:31], v[232:235], v[120:123], v[16:31]
    v_mfma_f32_32x32x16_bf16 v[32:47], v[236:239], v[120:123], v[32:47]
    buffer_load_dwordx4 v[100:103], v250, s[20:23], s38 offen offset:1024 sc1
    v_mfma_f32_32x32x16_bf16 v[48:63], v[232:235], v[124:127], v[48:63]
    buffer_load_dwordx4 v[216:219], v250, s[20:23], s39 offen offset:0 sc1
    v_mfma_f32_32x32x16_bf16 v[64:79], v[236:239], v[124:127], v[64:79]
    buffer_load_dwordx4 v[220:223], v250, s[20:23], s39 offen offset:1024 sc1
    s_waitcnt vmcnt(14)
    v_mfma_f32_32x32x16_bf16 v[16:31], v[240:243], v[128:131], v[16:31]
    v_mfma_f32_32x32x16_bf16 v[32:47], v[244:247], v[128:131], v[32:47]
    buffer_load_dwordx4 v[104:107], v251, s[20:23], s38 offen offset:0 sc1
    v_mfma_f32_32x32x16_bf16 v[48:63], v[240:243], v[132:135], v[48:63]
    buffer_load_dwordx4 v[108:111], v251, s[20:23], s38 offen offset:1024 sc1
    v_mfma_f32_32x32x16_bf16 v[64:79], v[244:247], v[132:135], v[64:79]
    buffer_load_dwordx4 v[224:227], v251, s[20:23], s39 offen offset:0 sc1
    s_waitcnt vmcnt(15)
    v_mfma_f32_32x32x16_bf16 v[16:31], v[192:195], v[136:139], v[16:31]
    v_mfma_f32_32x32x16_bf16 v[32:47], v[196:199], v[136:139], v[32:47]
    buffer_load_dwordx4 v[228:231], v251, s[20:23], s39 offen offset:1024 sc1
    v_mfma_f32_32x32x16_bf16 v[48:63], v[192:195], v[140:143], v[48:63]
Lagain47:
    s_waitcnt lgkmcnt(0)
    s_min_u32 s56, s56, s58
    s_min_u32 s57, s57, s59
    s_min_u32 s56, s56, s57
    s_cmp_ge_u32 s56, 0x1
    s_cbranch_scc1 Lok48
    s_cmp_eq_u32 s71, 0
    s_cbranch_scc1 Lok48
    s_sub_u32 s71, s71, 1
    s_buffer_load_dwordx4 s[56:59], s[20:23], s50 glc
    s_branch Lagain47
Lok48:
    s_cmp_ge_u32 s52, 0x3
    s_cbranch_scc1 Lseen49
    s_buffer_load_dwordx4 s[52:55], s[20:23], s49 glc
Lseen49:
    buffer_load_dwordx4 v[112:115], v252, s[20:23], s44 offen offset:0 sc1
    v_mfma_f32_32x32x16_bf16 v[64:79], v[196:199], v[140:143], v[64:79]
    buffer_load_dwordx4 v[116:119], v252, s[20:23], s45 offen offset:0 sc1
    s_waitcnt vmcnt(16)
    v_mfma_f32_32x32x16_bf16 v[16:31], v[80:83], v[144:147], v[16:31]
    v_mfma_f32_32x32x16_bf16 v[32:47], v[84:87], v[144:147], v[32:47]
    buffer_load_dwordx4 v[232:235], v252, s[20:23], s44 offen offset:1024 sc1
    v_mfma_f32_32x32x16_bf16 v[48:63], v[80:83], v[148:151], v[48:63]
    buffer_load_dwordx4 v[236:239], v252, s[20:23], s45 offen offset:1024 sc1
    v_mfma_f32_32x32x16_bf16 v[64:79], v[84:87], v[148:151], v[64:79]
    s_waitcnt vmcnt(16)
    v_mfma_f32_32x32x16_bf16 v[16:31], v[200:203], v[152:155], v[16:31]
    ds_read_b64_tr_b16 v[120:121], v10 offset:24576
    ds_read_b64_tr_b16 v[122:123], v10 offset:25600
    v_mfma_f32_32x32x16_bf16 v[32:47], v[204:207], v[152:155], v[32:47]
    buffer_load_dwordx4 v[240:243], v253, s[20:23], s44 offen offset:0 sc1
    v_mfma_f32_32x32x16_bf16 v[48:63], v[200:203], v[156:159], v[48:63]
    ds_read_b64_tr_b16 v[124:125], v13 offset:24576
    ds_read_b64_tr_b16 v[126:127], v13 offset:25600
    v_mfma_f32_32x32x16_bf16 v[64:79], v[204:207], v[156:159], v[64:79]
    buffer_load_dwordx4 v[244:247], v253, s[20:23], s44 offen offset:1024 sc1
    s_waitcnt vmcnt(16)
    v_mfma_f32_32x32x16_bf16 v[16:31], v[88:91], v[160:163], v[16:31]
    ds_read_b64_tr_b16 v[128:129], v8 offset:32768
    ds_read_b64_tr_b16 v[130:131], v8 offset:33792
    v_mfma_f32_32x32x16_bf16 v[32:47], v[92:95], v[160:163], v[32:47]
Lagain50:
    s_waitcnt lgkmcnt(0)
    s_min_u32 s52, s52, s54
    s_min_u32 s53, s53, s55
    s_min_u32 s52, s52, s53
    s_cmp_ge_u32 s52, 0x3
    s_cbranch_scc1 Lok51
    s_cmp_eq_u32 s71, 0
    s_cbranch_scc1 Lok51
    s_sub_u32 s71, s71, 1
    s_buffer_load_dwordx4 s[52:55], s[20:23], s49 glc
    s_branch Lagain50
Lok51:
    s_cmp_ge_u32 s52, 0x4
    s_cbranch_scc1 Lseen52
    s_buffer_load_dwordx4 s[52:55], s[20:23], s49 glc
Lseen52:
    buffer_load_dwordx4 v[192:195], v248, s[20:23], s40 offen offset:0 sc1
    v_mfma_f32_32x32x16_bf16 v[48:63], v[88:91], v[164:167], v[48:63]
    ds_read_b64_tr_b16 v[132:133], v11 offset:32768
    ds_read_b64_tr_b16 v[134:135], v11 offset:33792
    v_mfma_f32_32x32x16_bf16 v[64:79], v[92:95], v[164:167], v[64:79]
    buffer_load_dwordx4 v[196:199], v248, s[20:23], s40 offen offset:1024 sc1
    s_waitcnt vmcnt(16)
    v_mfma_f32_32x32x16_bf16 v[16:31], v[208:211], v[168:171], v[16:31]
    ds_read_b64_tr_b16 v[136:137], v8 offset:40960
    ds_read_b64_tr_b16 v[138:139], v8 offset:41984
    v_mfma_f32_32x32x16_bf16 v[32:47], v[212:215], v[168:171], v[32:47]
    buffer_load_dwordx4 v[80:83], v248, s[20:23], s41 offen offset:0 sc1
    v_mfma_f32_32x32x16_bf16 v[48:63], v[208:211], v[172:175], v[48:63]
    ds_read_b64_tr_b16 v[140:141], v11 offset:40960
    ds_read_b64_tr_b16 v[142:143], v11 offset:41984
    v_mfma_f32_32x32x16_bf16 v[64:79], v[212:215], v[172:175], v[64:79]
    buffer_load_dwordx4 v[84:87], v248, s[20:23], s41 offen offset:1024 sc1
    s_waitcnt vmcnt(16)
    v_mfma_f32_32x32x16_bf16 v[16:31], v[96:99], v[176:179], v[16:31]
    ds_read_b64_tr_b16 v[144:145], v8 offset:49152
    ds_read_b64_tr_b16 v[146:147], v8 offset:50176
    v_mfma_f32_32x32x16_bf16 v[32:47], v[100:103], v[176:179], v[32:47]
    buffer_load_dwordx4 v[200:203], v250, s[20:23], s40 offen offset:0 sc1
    v_mfma_f32_32x32x16_bf16 v[48:63], v[96:99], v[180:183], v[48:63]
    ds_read_b64_tr_b16 v[148:149], v11 offset:49152
    ds_read_b64_tr_b16 v[150:151], v11 offset:50176
    v_mfma_f32_32x32x16_bf16 v[64:79], v[100:103], v[180:183], v[64:79]
    buffer_load_dwordx4 v[204:207], v250, s[20:23], s40 offen offset:1024 sc1
    s_waitcnt vmcnt(16)
    v_mfma_f32_32x32x16_bf16 v[16:31], v[216:219], v[184:187], v[16:31]
    ds_read_b64_tr_b16 v[152:153], v10 offset:8192
    ds_read_b64_tr_b16 v[154:155], v10 offset:9216
    v_mfma_f32_32x32x16_bf16 v[32:47], v[220:223], v[184:187], v[32:47]
    buffer_load_dwordx4 v[88:91], v250, s[20:23], s41 offen offset:0 sc1
    v_mfma_f32_32x32x16_bf16 v[48:63], v[216:219], v[188:191], v[48:63]
    ds_read_b64_tr_b16 v[156:157], v13 offset:8192
    ds_read_b64_tr_b16 v[158:159], v13 offset:9216
    v_mfma_f32_32x32x16_bf16 v[64:79], v[220:223], v[188:191], v[64:79]
    buffer_load_dwordx4 v[92:95], v250, s[20:23], s41 offen offset:1024 sc1
    s_waitcnt vmcnt(16)
    v_mfma_f32_32x32x16_bf16 v[16:31], v[104:107], v[120:123], v[16:31]
    ds_read_b64_tr_b16 v[160:161], v9 offset:57344
    ds_read_b64_tr_b16 v[162:163], v9 offset:58368
    v_mfma_f32_32x32x16_bf16 v[32:47], v[108:111], v[120:123], v[32:47]
Lagain53:
    s_waitcnt lgkmcnt(0)
    s_min_u32 s52, s52, s54
    s_min_u32 s53, s53, s55
    s_min_u32 s52, s52, s53
    s_cmp_ge_u32 s52, 0x4
    s_cbranch_scc1 Lok54
    s_cmp_eq_u32 s71, 0
    s_cbranch_scc1 Lok54
    s_sub_u32 s71, s71, 1
    s_buffer_load_dwordx4 s[52:55], s[20:23], s49 glc
    s_branch Lagain53
Lok54:
    s_cmp_ge_u32 s52, 0x5
    s_cbranch_scc1 Lseen55
    s_buffer_load_dwordx4 s[52:55], s[20:23], s49 glc
Lseen55:
    buffer_load_dwordx4 v[208:211], v249, s[20:23], s40 offen offset:0 sc1
    v_mfma_f32_32x32x16_bf16 v[48:63], v[104:107], v[124:127], v[48:63]
    ds_read_b64_tr_b16 v[164:165], v12 offset:57344
    ds_read_b64_tr_b16 v[166:167], v12 offset:58368
    v_mfma_f32_32x32x16_bf16 v[64:79], v[108:111], v[124:127], v[64:79]
    buffer_load_dwordx4 v[212:215], v249, s[20:23], s40 offen offset:1024 sc1
    s_waitcnt vmcnt(16)
    v_mfma_f32_32x32x16_bf16 v[16:31], v[224:227], v[128:131], v[16:31]
    ds_read_b64_tr_b16 v[168:169], v8 offset:57344
    ds_read_b64_tr_b16 v[170:171], v8 offset:58368
    v_mfma_f32_32x32x16_bf16 v[32:47], v[228:231], v[128:131], v[32:47]
    buffer_load_dwordx4 v[96:99], v249, s[20:23], s41 offen offset:0 sc1
    v_mfma_f32_32x32x16_bf16 v[48:63], v[224:227], v[132:135], v[48:63]
    ds_read_b64_tr_b16 v[172:173], v11 offset:57344
    ds_read_b64_tr_b16 v[174:175], v11 offset:58368
    v_mfma_f32_32x32x16_bf16 v[64:79], v[228:231], v[132:135], v[64:79]
    buffer_load_dwordx4 v[100:103], v249, s[20:23], s41 offen offset:1024 sc1
    s_waitcnt vmcnt(10)
    v_mfma_f32_32x32x16_bf16 v[16:31], v[192:195], v[136:139], v[16:31]
    ds_read_b64_tr_b16 v[176:177], v10 offset:0
    ds_read_b64_tr_b16 v[178:179], v10 offset:1024
    v_mfma_f32_32x32x16_bf16 v[32:47], v[196:199], v[136:139], v[32:47]
    buffer_load_dwordx4 v[216:219], v251, s[20:23], s40 offen offset:0 sc1
    v_mfma_f32_32x32x16_bf16 v[48:63], v[192:195], v[140:143], v[48:63]
    ds_read_b64_tr_b16 v[180:181], v13 offset:0
    ds_read_b64_tr_b16 v[182:183], v13 offset:1024
    v_mfma_f32_32x32x16_bf16 v[64:79], v[196:199], v[140:143], v[64:79]
    buffer_load_dwordx4 v[220:223], v251, s[20:23], s40 offen offset:1024 sc1
    s_waitcnt vmcnt(10)
    v_mfma_f32_32x32x16_bf16 v[16:31], v[80:83], v[144:147], v[16:31]
    ds_read_b64_tr_b16 v[184:185], v8 offset:8192
    ds_read_b64_tr_b16 v[186:187], v8 offset:9216
    v_mfma_f32_32x32x16_bf16 v[32:47], v[84:87], v[144:147], v[32:47]
    buffer_load_dwordx4 v[104:107], v251, s[20:23], s41 offen offset:0 sc1
    v_mfma_f32_32x32x16_bf16 v[48:63], v[80:83], v[148:151], v[48:63]
    ds_read_b64_tr_b16 v[188:189], v11 offset:8192
    ds_read_b64_tr_b16 v[190:191], v11 offset:9216
    v_mfma_f32_32x32x16_bf16 v[64:79], v[84:87], v[148:151], v[64:79]
    buffer_load_dwordx4 v[108:111], v251, s[20:23], s41 offen offset:1024 sc1
    s_waitcnt vmcnt(10)
    v_mfma_f32_32x32x16_bf16 v[16:31], v[200:203], v[152:155], v[16:31]
    ds_read_b64_tr_b16 v[120:121], v8 offset:16384
    ds_read_b64_tr_b16 v[122:123], v8 offset:17408
    v_mfma_f32_32x32x16_bf16 v[32:47], v[204:207], v[152:155], v[32:47]
Lagain56:
    s_waitcnt lgkmcnt(0)
    s_min_u32 s52, s52, s54
    s_min_u32 s53, s53, s55
    s_min_u32 s52, s52, s53
    s_cmp_ge_u32 s52, 0x5
    s_cbranch_scc1 Lok57
    s_cmp_eq_u32 s71, 0
    s_cbranch_scc1 Lok57
    s_sub_u32 s71, s71, 1
    s_buffer_load_dwordx4 s[52:55], s[20:23], s49 glc
    s_branch Lagain56
Lok57:
    s_buffer_load_dwordx8 s[56:63], s[20:23], s51 glc
    buffer_load_dwordx4 v[224:227], v1, s[20:23], s42 offen offset:0 sc1
    v_mfma_f32_32x32x16_bf16 v[48:63], v[200:203], v[156:159], v[48:63]
    ds_read_b64_tr_b16 v[124:125], v11 offset:16384
    ds_read_b64_tr_b16 v[126:127], v11 offset:17408
    v_mfma_f32_32x32x16_bf16 v[64:79], v[204:207], v[156:159], v[64:79]
    buffer_load_dwordx4 v[228:231], v1, s[20:23], s42 offen offset:1024 sc1
    s_waitcnt vmcnt(10)
    v_mfma_f32_32x32x16_bf16 v[16:31], v[88:91], v[160:163], v[16:31]
    ds_read_b64_tr_b16 v[128:129], v9 offset:24576
    ds_read_b64_tr_b16 v[130:131], v9 offset:25600
    v_mfma_f32_32x32x16_bf16 v[32:47], v[92:95], v[160:163], v[32:47]
    buffer_load_dwordx4 v[192:195], v1, s[20:23], s43 offen offset:0 sc1
    v_mfma_f32_32x32x16_bf16 v[48:63], v[88:91], v[164:167], v[48:63]
    ds_read_b64_tr_b16 v[132:133], v12 offset:24576
    ds_read_b64_tr_b16 v[134:135], v12 offset:25600
    v_mfma_f32_32x32x16_bf16 v[64:79], v[92:95], v[164:167], v[64:79]
    buffer_load_dwordx4 v[196:199], v1, s[20:23], s43 offen offset:1024 sc1
    s_waitcnt vmcnt(10)
    v_mfma_f32_32x32x16_bf16 v[16:31], v[208:211], v[168:171], v[16:31]
    ds_read_b64_tr_b16 v[136:137], v9 offset:49152
    ds_read_b64_tr_b16 v[138:139], v9 offset:50176
    v_mfma_f32_32x32x16_bf16 v[32:47], v[212:215], v[168:171], v[32:47]
    buffer_load_dwordx4 v[80:83], v1, s[20:23], s42 offen offset:2048 sc1
    v_mfma_f32_32x32x16_bf16 v[48:63], v[208:211], v[172:175], v[48:63]
    ds_read_b64_tr_b16 v[140:141], v12 offset:49152
    ds_read_b64_tr_b16 v[142:143], v12 offset:50176
    v_mfma_f32_32x32x16_bf16 v[64:79], v[212:215], v[172:175], v[64:79]
    buffer_load_dwordx4 v[84:87], v1, s[20:23], s42 offen offset:3072 sc1
    s_waitcnt vmcnt(10)
    v_mfma_f32_32x32x16_bf16 v[16:31], v[96:99], v[176:179], v[16:31]
    ds_read_b64_tr_b16 v[144:145], v9 offset:32768
    ds_read_b64_tr_b16 v[146:147], v9 offset:33792
    v_mfma_f32_32x32x16_bf16 v[32:47], v[100:103], v[176:179], v[32:47]
    buffer_load_dwordx4 v[200:203], v1, s[20:23], s43 offen offset:2048 sc1
    v_mfma_f32_32x32x16_bf16 v[48:63], v[96:99], v[180:183], v[48:63]
    ds_read_b64_tr_b16 v[148:149], v12 offset:32768
    ds_read_b64_tr_b16 v[150:151], v12 offset:33792
    v_mfma_f32_32x32x16_bf16 v[64:79], v[100:103], v[180:183], v[64:79]
    buffer_load_dwordx4 v[204:207], v1, s[20:23], s43 offen offset:3072 sc1
    s_waitcnt vmcnt(10)
    v_mfma_f32_32x32x16_bf16 v[16:31], v[216:219], v[184:187], v[16:31]
    ds_read_b64_tr_b16 v[152:153], v9 offset:40960
    ds_read_b64_tr_b16 v[154:155], v9 offset:41984
    v_mfma_f32_32x32x16_bf16 v[32:47], v[220:223], v[184:187], v[32:47]
Lagain58:
    s_waitcnt lgkmcnt(0)
    s_min_u32 s56, s56, s60
    s_min_u32 s57, s57, s61
    s_min_u32 s58, s58, s62
    s_min_u32 s59, s59, s63
    s_min_u32 s56, s56, s58
    s_min_u32 s57, s57, s59
    s_min_u32 s56, s56, s57
    s_cmp_ge_u32 s56, 0x1
    s_cbranch_scc1 Lok59
    s_cmp_eq_u32 s71, 0
    s_cbranch_scc1 Lok59
    s_sub_u32 s71, s71, 1
    s_buffer_load_dwordx8 s[56:63], s[20:23], s51 glc
    s_branch Lagain58
Lok59:
    buffer_load_dwordx4 v[88:91], v252, s[20:23], s46 offen offset:0 sc1
    v_mfma_f32_32x32x16_bf16 v[48:63], v[216:219], v[188:191], v[48:63]
    ds_read_b64_tr_b16 v[156:157], v12 offset:40960
    ds_read_b64_tr_b16 v[158:159], v12 offset:41984
    buffer_load_dwordx4 v[92:95], v252, s[20:23], s47 offen offset:0 sc1
    v_mfma_f32_32x32x16_bf16 v[64:79], v[220:223], v[188:191], v[64:79]
    buffer_load_dwordx4 v[160:163], v252, s[20:23], s46 offen offset:1024 sc1
    s_waitcnt vmcnt(11)
    v_mfma_f32_32x32x16_bf16 v[16:31], v[104:107], v[120:123], v[16:31]
    buffer_load_dwordx4 v[164:167], v252, s[20:23], s47 offen offset:1024 sc1
    v_mfma_f32_32x32x16_bf16 v[32:47], v[108:111], v[120:123], v[32:47]
    buffer_load_dwordx4 v[212:215], v253, s[20:23], s46 offen offset:0 sc1
    v_mfma_f32_32x32x16_bf16 v[48:63], v[104:107], v[124:127], v[48:63]
    buffer_load_dwordx4 v[168:171], v253, s[20:23], s47 offen offset:0 sc1
    v_mfma_f32_32x32x16_bf16 v[64:79], v[108:111], v[124:127], v[64:79]
    buffer_load_dwordx4 v[96:99], v253, s[20:23], s46 offen offset:1024 sc1
    s_waitcnt vmcnt(13)
    v_mfma_f32_32x32x16_bf16 v[16:31], v[224:227], v[128:131], v[16:31]
    buffer_load_dwordx4 v[100:103], v253, s[20:23], s47 offen offset:1024 sc1
    v_mfma_f32_32x32x16_bf16 v[32:47], v[228:231], v[128:131], v[32:47]
    s_waitcnt lgkmcnt(0)
    buffer_load_dwordx4 v[176:179], v254, s[20:23], s44 offen offset:0 sc1
    v_mfma_f32_32x32x16_bf16 v[48:63], v[224:227], v[132:135], v[48:63]
    buffer_load_dwordx4 v[216:219], v254, s[20:23], s46 offen offset:0 sc1
    v_mfma_f32_32x32x16_bf16 v[64:79], v[228:231], v[132:135], v[64:79]
    buffer_load_dwordx4 v[220:223], v254, s[20:23], s47 offen offset:0 sc1
    s_waitcnt vmcnt(15)
    v_mfma_f32_32x32x16_bf16 v[16:31], v[192:195], v[136:139], v[16:31]
    buffer_load_dwordx4 v[184:187], v254, s[20:23], s44 offen offset:1024 sc1
    v_mfma_f32_32x32x16_bf16 v[32:47], v[196:199], v[136:139], v[32:47]
    buffer_load_dwordx4 v[104:107], v254, s[20:23], s46 offen offset:1024 sc1
    v_mfma_f32_32x32x16_bf16 v[48:63], v[192:195], v[140:143], v[48:63]
    buffer_load_dwordx4 v[108:111], v254, s[20:23], s47 offen offset:1024 sc1
    v_mfma_f32_32x32x16_bf16 v[64:79], v[196:199], v[140:143], v[64:79]
    s_waitcnt vmcnt(16)
    v_mfma_f32_32x32x16_bf16 v[16:31], v[80:83], v[144:147], v[16:31]
    buffer_load_dwordx4 v[120:123], v255, s[20:23], s44 offen offset:0 sc1
    v_mfma_f32_32x32x16_bf16 v[32:47], v[84:87], v[144:147], v[32:47]
    buffer_load_dwordx4 v[224:227], v255, s[20:23], s46 offen offset:0 sc1
    v_mfma_f32_32x32x16_bf16 v[48:63], v[80:83], v[148:151], v[48:63]
    v_mfma_f32_32x32x16_bf16 v[64:79], v[84:87], v[148:151], v[64:79]
    s_waitcnt vmcnt(16)
    v_mfma_f32_32x32x16_bf16 v[16:31], v[200:203], v[152:155], v[16:31]
    buffer_load_dwordx4 v[228:231], v255, s[20:23], s47 offen offset:0 sc1
    v_mfma_f32_32x32x16_bf16 v[32:47], v[204:207], v[152:155], v[32:47]
    buffer_load_dwordx4 v[128:131], v255, s[20:23], s44 offen offset:1024 sc1
    v_mfma_f32_32x32x16_bf16 v[48:63], v[200:203], v[156:159], v[48:63]
    v_mfma_f32_32x32x16_bf16 v[64:79], v[204:207], v[156:159], v[64:79]
    s_waitcnt vmcnt(16)
    v_mfma_f32_32x32x16_bf16 v[16:31], v[112:115], v[88:91], v[16:31]
    buffer_load_dwordx4 v[192:195], v255, s[20:23], s46 offen offset:1024 sc1
    v_mfma_f32_32x32x16_bf16 v[32:47], v[116:119], v[88:91], v[32:47]
    buffer_load_dwordx4 v[196:199], v255, s[20:23], s47 offen offset:1024 sc1
    v_mfma_f32_32x32x16_bf16 v[48:63], v[112:115], v[92:95], v[48:63]
    v_mfma_f32_32x32x16_bf16 v[64:79], v[116:119], v[92:95], v[64:79]
    s_barrier
    s_mul_i32 m0, s4, 16448
    s_waitcnt vmcnt(16)
    v_mfma_f32_32x32x16_bf16 v[16:31], v[232:235], v[160:163], v[16:31]
    buffer_load_dwordx4 v[208:211], v253, s[20:23], s45 offen offset:0 sc1
    v_mfma_f32_32x32x16_bf16 v[32:47], v[236:239], v[160:163], v[32:47]
    buffer_load_dwordx4 v[172:175], v253, s[20:23], s45 offen offset:1024 sc1
    v_mfma_f32_32x32x16_bf16 v[48:63], v[232:235], v[164:167], v[48:63]
    v_mfma_f32_32x32x16_bf16 v[64:79], v[236:239], v[164:167], v[64:79]
    s_waitcnt vmcnt(16)
    v_mfma_f32_32x32x16_bf16 v[16:31], v[240:243], v[212:215], v[16:31]
    buffer_load_dwordx4 v[180:183], v254, s[20:23], s45 offen offset:0 sc1
    buffer_load_dwordx4 v[188:191], v254, s[20:23], s45 offen offset:1024 sc1
    v_mfma_f32_32x32x16_bf16 v[48:63], v[240:243], v[168:171], v[48:63]
    s_waitcnt vmcnt(16)
    v_mfma_f32_32x32x16_bf16 v[16:31], v[244:247], v[96:99], v[16:31]
    buffer_load_dwordx4 v[124:127], v255, s[20:23], s45 offen offset:0 sc1
    buffer_load_dwordx4 v[132:135], v255, s[20:23], s45 offen offset:1024 sc1
    v_mfma_f32_32x32x16_bf16 v[48:63], v[244:247], v[100:103], v[48:63]
    s_waitcnt vmcnt(15)
    v_mfma_f32_32x32x16_bf16 v[16:31], v[176:179], v[216:219], v[16:31]
    v_mfma_f32_32x32x16_bf16 v[48:63], v[176:179], v[220:223], v[48:63]
    s_waitcnt vmcnt(12)
    v_mfma_f32_32x32x16_bf16 v[16:31], v[184:187], v[104:107], v[16:31]
    v_mfma_f32_32x32x16_bf16 v[48:63], v[184:187], v[108:111], v[48:63]
    s_waitcnt vmcnt(9)
    v_mfma_f32_32x32x16_bf16 v[16:31], v[120:123], v[224:227], v[16:31]
    s_waitcnt vmcnt(6)
    v_mfma_f32_32x32x16_bf16 v[16:31], v[128:131], v[192:195], v[16:31]
    v_mfma_f32_32x32x16_bf16 v[48:63], v[120:123], v[228:231], v[48:63]
    v_mfma_f32_32x32x16_bf16 v[48:63], v[128:131], v[196:199], v[48:63]
    s_waitcnt vmcnt(5)
    v_mfma_f32_32x32x16_bf16 v[32:47], v[208:211], v[212:215], v[32:47]
    s_nop 7
    ds_write_addtid_b32 v16 offset:0
    ds_write_addtid_b32 v17 offset:256
    ds_write_addtid_b32 v18 offset:512
    ds_write_addtid_b32 v19 offset:768
    ds_write_addtid_b32 v20 offset:1024
    ds_write_addtid_b32 v21 offset:1280
    ds_write_addtid_b32 v22 offset:1536
    ds_write_addtid_b32 v23 offset:1792
    v_mfma_f32_32x32x16_bf16 v[64:79], v[208:211], v[168:171], v[64:79]
    ds_write_addtid_b32 v24 offset:2048
    ds_write_addtid_b32 v25 offset:2304
    ds_write_addtid_b32 v26 offset:2560
    ds_write_addtid_b32 v27 offset:2816
    ds_write_addtid_b32 v28 offset:3072
    ds_write_addtid_b32 v29 offset:3328
    ds_write_addtid_b32 v30 offset:3584
    ds_write_addtid_b32 v31 offset:3840
    s_waitcnt vmcnt(4)
    v_mfma_f32_32x32x16_bf16 v[32:47], v[172:175], v[96:99], v[32:47]
    ds_write_addtid_b32 v48 offset:4112
    ds_write_addtid_b32 v49 offset:4368
    ds_write_addtid_b32 v50 offset:4624
    ds_write_addtid_b32 v51 offset:4880
    ds_write_addtid_b32 v52 offset:5136
    ds_write_addtid_b32 v53 offset:5392
    ds_write_addtid_b32 v54 offset:5648
    ds_write_addtid_b32 v55 offset:5904
    v_mfma_f32_32x32x16_bf16 v[64:79], v[172:175], v[100:103], v[64:79]
    ds_write_addtid_b32 v56 offset:6160
    ds_write_addtid_b32 v57 offset:6416
    ds_write_addtid_b32 v58 offset:6672
    ds_write_addtid_b32 v59 offset:6928
    ds_write_addtid_b32 v60 offset:7184
    ds_write_addtid_b32 v61 offset:7440
    ds_write_addtid_b32 v62 offset:7696
    ds_write_addtid_b32 v63 offset:7952
    s_waitcnt vmcnt(3)
    v_mfma_f32_32x32x16_bf16 v[32:47], v[180:183], v[216:219], v[32:47]
    s_waitcnt lgkmcnt(0)
    s_barrier
    v_mfma_f32_32x32x16_bf16 v[64:79], v[180:183], v[220:223], v[64:79]
    s_waitcnt vmcnt(2)
    v_mfma_f32_32x32x16_bf16 v[32:47], v[188:191], v[104:107], v[32:47]
    v_mfma_f32_32x32x16_bf16 v[64:79], v[188:191], v[108:111], v[64:79]
    s_waitcnt vmcnt(1)
    v_mfma_f32_32x32x16_bf16 v[32:47], v[124:127], v[224:227], v[32:47]
    s_waitcnt vmcnt(0)
    v_mfma_f32_32x32x16_bf16 v[32:47], v[132:135], v[192:195], v[32:47]
    v_mfma_f32_32x32x16_bf16 v[64:79], v[124:127], v[228:231], v[64:79]
    v_mfma_f32_32x32x16_bf16 v[64:79], v[132:135], v[196:199], v[64:79]
    s_nop 9
    ds_write_addtid_b32 v32 offset:8224
    ds_write_addtid_b32 v33 offset:8480
    ds_write_addtid_b32 v34 offset:8736
    ds_write_addtid_b32 v35 offset:8992
    ds_write_addtid_b32 v36 offset:9248
    ds_write_addtid_b32 v37 offset:9504
    ds_write_addtid_b32 v38 offset:9760
    ds_write_addtid_b32 v39 offset:10016
    ds_write_addtid_b32 v40 offset:10272
    ds_write_addtid_b32 v41 offset:10528
    ds_write_addtid_b32 v42 offset:10784
    ds_write_addtid_b32 v43 offset:11040
    ds_write_addtid_b32 v44 offset:11296
    ds_write_addtid_b32 v45 offset:11552
    ds_write_addtid_b32 v46 offset:11808
    ds_write_addtid_b32 v47 offset:12064
    ds_write_addtid_b32 v64 offset:12336
    ds_write_addtid_b32 v65 offset:12592
    ds_write_addtid_b32 v66 offset:12848
    ds_write_addtid_b32 v67 offset:13104
    ds_write_addtid_b32 v68 offset:13360
    ds_write_addtid_b32 v69 offset:13616
    ds_write_addtid_b32 v70 offset:13872
    ds_write_addtid_b32 v71 offset:14128
    ds_write_addtid_b32 v72 offset:14384
    ds_write_addtid_b32 v73 offset:14640
    ds_write_addtid_b32 v74 offset:14896
    ds_write_addtid_b32 v75 offset:15152
    ds_write_addtid_b32 v76 offset:15408
    ds_write_addtid_b32 v77 offset:15664
    ds_write_addtid_b32 v78 offset:15920
    ds_write_addtid_b32 v79 offset:16176
    s_waitcnt lgkmcnt(0)
    s_barrier
    s_endpgm
L_HM:
    s_mov_b32 s12, s38
    s_mov_b32 s13, s39
    s_mov_b32 s14, 0x126000
    s_mov_b32 s15, 0x20000
    v_min_u32 v16, 6, v14
    v_add_u32 v17, s69, v15
    v_mul_u32_u24 v17, 2688, v17
    v_lshl_add_u32 v2, v16, 4, v17
    v_add_u32 v3, 20480, v2
    s_mul_i32 s69, s6, 112
    s_mul_i32 s67, s65, 172032
    s_add_u32 s58, s67, s69
    s_add_u32 s68, s69, 1204224
    s_add_u32 s67, s58, 172032
    s_cmp_eq_u32 s67, s68
    s_cselect_b32 s59, s69, s67
    s_add_u32 s67, s59, 172032
    s_cmp_eq_u32 s67, s68
    s_cselect_b32 s60, s69, s67
    s_add_u32 s67, s60, 172032
    s_cmp_eq_u32 s67, s68
    s_cselect_b32 s61, s69, s67
    s_add_u32 s67, s61, 172032
    s_cmp_eq_u32 s67, s68
    s_cselect_b32 s62, s69, s67
    s_add_u32 s67, s62, 172032
    s_cmp_eq_u32 s67, s68
    s_cselect_b32 s63, s69, s67
    s_add_u32 s67, s63, 172032
    s_cmp_eq_u32 s67, s68
    s_cselect_b32 s64, s69, s67
    s_waitcnt vmcnt(8)
    s_barrier
    s_add_u32 m0, s74, 12288
    s_add_u32 s72, s72, 128
    s_cmp_ge_u32 s72, s73
    s_cselect_b32 s67, 896, 0
    s_sub_u32 s72, s72, s67
    buffer_load_dwordx4 v240, s[8:11], s72 offen offset:0 lds
    buffer_load_dwordx4 v241, s[8:11], s72 offen offset:1024 lds
    buffer_load_dwordx4 v242, s[8:11], s72 offen offset:2048 lds
    buffer_load_dwordx4 v243, s[8:11], s72 offen offset:3072 lds
    s_waitcnt vmcnt(8)
    s_barrier
    s_add_u32 m0, s74, 16384
    s_add_u32 s72, s72, 128
    s_cmp_ge_u32 s72, s73
    s_cselect_b32 s67, 896, 0
    s_sub_u32 s72, s72, s67
    buffer_load_dwordx4 v240, s[8:11], s72 offen offset:0 lds
    buffer_load_dwordx4 v241, s[8:11], s72 offen offset:1024 lds
    buffer_load_dwordx4 v242, s[8:11], s72 offen offset:2048 lds
    buffer_load_dwordx4 v243, s[8:11], s72 offen offset:3072 lds
    s_waitcnt vmcnt(8)
    s_barrier
    s_add_u32 m0, s74, 20480
    s_add_u32 s72, s72, 128
    s_cmp_ge_u32 s72, s73
    s_cselect_b32 s67, 896, 0
    s_sub_u32 s72, s72, s67
    buffer_load_dwordx4 v240, s[8:11], s72 offen offset:0 lds
    buffer_load_dwordx4 v241, s[8:11], s72 offen offset:1024 lds
    buffer_load_dwordx4 v242, s[8:11], s72 offen offset:2048 lds
    buffer_load_dwordx4 v243, s[8:11], s72 offen offset:3072 lds
    s_waitcnt vmcnt(8)
    s_barrier
    s_add_u32 m0, s74, 24576
    s_add_u32 s72, s72, 128
    s_cmp_ge_u32 s72, s73
    s_cselect_b32 s67, 896, 0
    s_sub_u32 s72, s72, s67
    buffer_load_dwordx4 v240, s[8:11], s72 offen offset:0 lds
    buffer_load_dwordx4 v241, s[8:11], s72 offen offset:1024 lds
    buffer_load_dwordx4 v242, s[8:11], s72 offen offset:2048 lds
    buffer_load_dwordx4 v243, s[8:11], s72 offen offset:3072 lds
    s_waitcnt vmcnt(8)
    s_barrier
    s_add_u32 m0, s75, 8192
    s_add_u32 s67, s58, 896
    buffer_load_dwordx4 v2, s[12:15], s67 offen lds
    buffer_load_dwordx4 v3, s[12:15], s67 offen offset:1024 lds
    s_add_u32 m0, s75, 16384
    s_add_u32 s67, s59, 896
    buffer_load_dwordx4 v2, s[12:15], s67 offen lds
    buffer_load_dwordx4 v3, s[12:15], s67 offen offset:1024 lds
    s_waitcnt vmcnt(8)
    s_barrier
    s_add_u32 m0, s75, 24576
    s_add_u32 s67, s60, 896
    buffer_load_dwordx4 v2, s[12:15], s67 offen lds
    buffer_load_dwordx4 v3, s[12:15], s67 offen offset:1024 lds
    s_add_u32 m0, s75, 32768
    s_add_u32 s67, s61, 896
    buffer_load_dwordx4 v2, s[12:15], s67 offen lds
    buffer_load_dwordx4 v3, s[12:15], s67 offen offset:1024 lds
    s_waitcnt vmcnt(8)
    s_barrier
    s_add_u32 m0, s75, 40960
    s_add_u32 s67, s62, 896
    buffer_load_dwordx4 v2, s[12:15], s67 offen lds
    buffer_load_dwordx4 v3, s[12:15], s67 offen offset:1024 lds
    s_bfe_u32 s67, s2, 0x20001
    s_xor_b32 s67, s67, 0
    s_lshr_b32 s68, s2, 3
    s_lshl_b32 s67, s67, 5
    s_add_u32 s67, s67, s68
    s_and_b32 s68, s2, 1
    s_cmp_lg_u32 s4, 0
    s_cbranch_scc1 Lt160
    s_mul_i32 s67, s67, 49
    s_mul_i32 s68, s68, 14
    v_min_u32 v246, 48, v0
    v_add_u32 v246, s67, v246
    v_mul_u32_u24 v247, 37450, v246
    v_lshrrev_b32 v247, 19, v247
    v_mul_u32_u24 v247, 14, v247
    v_add3_u32 v246, v246, v247, s68
    v_lshlrev_b32 v246, 7, v246
    buffer_load_dword v245, v246, s[24:27], 0 offen
Lt160:
    s_cmp_lg_u32 s4, 1
    s_cbranch_scc1 Lt261
    s_mul_i32 s67, s67, 42
    s_mul_i32 s68, s68, 3
    v_min_u32 v246, 41, v0
    v_add_u32 v246, s67, v246
    v_lshrrev_b32 v247, 2, v246
    v_mul_u32_u24 v247, 3, v247
    v_add3_u32 v246, v246, v247, s68
    v_lshlrev_b32 v246, 7, v246
    buffer_load_dword v245, v246, s[24:27], 0 offen
Lt261:
    s_barrier
    s_add_u32 m0, s75, 49152
    s_add_u32 s67, s63, 896
    buffer_load_dwordx4 v2, s[12:15], s67 offen lds
    buffer_load_dwordx4 v3, s[12:15], s67 offen offset:1024 lds
    s_add_u32 m0, s75, 57344
    s_add_u32 s67, s64, 896
    buffer_load_dwordx4 v2, s[12:15], s67 offen lds
    buffer_load_dwordx4 v3, s[12:15], s67 offen offset:1024 lds
    s_waitcnt vmcnt(8)
    s_barrier
    s_add_u32 m0, s75, 65536
    s_add_u32 s67, s58, 1792
    buffer_load_dwordx4 v2, s[12:15], s67 offen lds
    buffer_load_dwordx4 v3, s[12:15], s67 offen offset:1024 lds
    s_add_u32 m0, s75, 73728
    s_add_u32 s67, s59, 1792
    buffer_load_dwordx4 v2, s[12:15], s67 offen lds
    buffer_load_dwordx4 v3, s[12:15], s67 offen offset:1024 lds
    s_add_u32 m0, s75, 81920
    s_add_u32 s67, s60, 1792
    buffer_load_dwordx4 v2, s[12:15], s67 offen lds
    buffer_load_dwordx4 v3, s[12:15], s67 offen offset:1024 lds
    s_waitcnt vmcnt(12)
    s_add_u32 m0, s75, 90112
    s_add_u32 s67, s61, 1792
    buffer_load_dwordx4 v2, s[12:15], s67 offen lds
    buffer_load_dwordx4 v3, s[12:15], s67 offen offset:1024 lds
    s_cmp_lg_u32 s4, 2
    s_cbranch_scc1 Lt462
    s_xor_b32 s67, s2, 0
    s_mul_i32 s67, s67, 49
    v_min_u32 v246, 48, v0
    v_add_u32 v246, s67, v246
    v_lshlrev_b32 v246, 7, v246
    buffer_load_dword v245, v246, s[24:27], 0 offen
Lt462:
    s_cmp_lg_u32 s4, 3
    s_cbranch_scc1 Lt563
    s_mul_i32 s67, s2, 13
    v_min_u32 v246, 12, v0
    v_add_u32 v246, s67, v246
    v_lshlrev_b32 v246, 7, v246
    buffer_load_dword v245, v246, s[24:27], 0 offen
Lt563:
    s_waitcnt lgkmcnt(0)
    s_add_u32 s20, s56, 0x0
    s_addc_u32 s21, s57, 0
    s_mov_b32 s22, 0xc00000
    s_mov_b32 s23, 0x20000
    s_mov_b32 s28, s54
    s_mov_b32 s29, s55
    s_mov_b32 s30, 0x100
    s_mov_b32 s31, 0x20000
    v_lshrrev_b32 v16, 5, v0
    v_mul_u32_u24 v16, 4, v16
    v_bfe_u32 v17, v0, 2, 2
    v_add_u32 v16, v16, v17
    v_lshlrev_b32 v16, 7, v16
    v_bfe_u32 v17, v0, 4, 1
    v_lshlrev_b32 v17, 5, v17
    v_and_b32 v8, 3, v0
    v_lshl_add_u32 v8, v8, 3, v17
    v_bfe_u32 v17, v0, 3, 1
    v_lshlrev_b32 v17, 6, v17
    v_xor_b32 v8, v8, v17
    v_add_u32 v8, v8, v16
    v_add_u32 v8, s75, v8
    v_add_u32 v9, 0x10000, v8
    v_add_u32 v10, 0x20000, v8
    v_lshrrev_b32 v16, 5, v0
    v_mul_u32_u24 v16, 4, v16
    v_bfe_u32 v17, v0, 2, 2
    v_add_u32 v16, v16, v17
    v_lshlrev_b32 v16, 7, v16
    v_bfe_u32 v17, v0, 4, 1
    v_lshlrev_b32 v17, 5, v17
    v_and_b32 v11, 3, v0
    v_lshl_add_u32 v11, v11, 3, v17
    v_add_u32 v11, 64, v11
    v_bfe_u32 v17, v0, 3, 1
    v_lshlrev_b32 v17, 6, v17
    v_xor_b32 v11, v11, v17
    v_add_u32 v11, v11, v16
    v_add_u32 v11, s75, v11
    v_add_u32 v12, 0x10000, v11
    v_add_u32 v13, 0x20000, v11
    s_lshr_b32 s67, s7, 2
    s_lshl4_add_u32 s67, s67, s5
    s_lshr_b32 s68, s6, 1
    s_lshl2_add_u32 s67, s67, s68
    s_lshr_b32 s68, s4, 1
    s_lshl3_add_u32 s67, s67, s68
    s_and_b32 s68, s6, 1
    s_lshl1_add_u32 s67, s67, s68
    s_and_b32 s68, s4, 1
    s_lshl1_add_u32 s67, s67, s68
    s_lshl_b32 s67, s67, 2
    s_add_u32 s70, s67, 0xa90000
    s_lshr_b32 s67, s66, 3
    s_lshl2_add_u32 s67, s67, s4
    s_lshl_b32 s67, s67, 5
    s_and_b32 s68, s66, 7
    s_add_u32 s67, s67, s68
    s_lshl_b32 s67, s67, 2
    s_add_u32 s79, s67, 0xa98000
    s_mov_b32 s16, s40
    s_mov_b32 s17, s41
    s_mov_b32 s18, 0x62000
    s_mov_b32 s19, 0x20000
    s_lshr_b32 s48, s66, 1
    s_mul_i32 s69, s48, 28
    s_lshl_b32 s77, s4, 8
    v_mov_b32 v16, v14
    v_add_u32 v17, s69, v15
    v_mul_u32_u24 v17, 896, v17
    v_lshl_add_u32 v5, v16, 4, v17
    v_add_u32 v6, 6144, v5
    s_and_b32 s67, s4, 1
    s_lshl1_add_u32 s68, s6, s67
    s_lshl_b32 s67, s67, 13
    s_add_u32 s67, s67, 131072
    v_add_u32 v4, s67, v1
    s_and_b32 s67, s4, 1
    s_lshl3_add_u32 s46, s6, s67
    s_lshl4_add_u32 s46, s46, s5
    s_lshl_b32 s46, s46, 4
    s_add_u32 s46, s46, 0xa94000
    s_lshl_b32 s47, s68, 5
    s_add_u32 s47, s47, s5
    s_lshl_b32 s47, s47, 10
    s_add_u32 s47, s47, 0x980000
    v_lshrrev_b32 v16, 5, v0
    v_lshlrev_b32 v14, 4, v16
    v_and_b32 v17, 15, v0
    v_add_u32 v17, v17, v14
    v_lshlrev_b32 v17, 4, v17
    v_bfe_u32 v16, v0, 4, 1
    v_lshl_add_u32 v15, v16, 14, v17
    v_lshl_add_u32 v254, v16, 10, v17
    v_lshlrev_b32 v14, 5, v14
    v_mov_b32 v32, 0x3f803f80
    v_mov_b32 v33, 0x3f803f80
    v_mov_b32 v34, 0x3f803f80
    v_mov_b32 v35, 0x3f803f80
    s_waitcnt vmcnt(10)
    s_barrier
    s_add_u32 m0, s75, 98304
    s_add_u32 s67, s62, 1792
    buffer_load_dwordx4 v2, s[12:15], s67 offen lds
    buffer_load_dwordx4 v3, s[12:15], s67 offen offset:1024 lds
    s_add_u32 m0, s75, 106496
    s_add_u32 s67, s63, 1792
    buffer_load_dwordx4 v2, s[12:15], s67 offen lds
    buffer_load_dwordx4 v3, s[12:15], s67 offen offset:1024 lds
    s_waitcnt vmcnt(8)
    s_barrier
    s_add_u32 m0, s75, 24576
    s_add_u32 s67, s64, 1792
    buffer_load_dwordx4 v2, s[12:15], s67 offen lds
    buffer_load_dwordx4 v3, s[12:15], s67 offen offset:1024 lds
    s_add_u32 m0, s75, 32768
    s_add_u32 s67, s58, 0
    buffer_load_dwordx4 v2, s[12:15], s67 offen lds
    buffer_load_dwordx4 v3, s[12:15], s67 offen offset:1024 lds
    s_add_u32 m0, s75, 40960
    s_add_u32 s67, s59, 0
    buffer_load_dwordx4 v2, s[12:15], s67 offen lds
    buffer_load_dwordx4 v3, s[12:15], s67 offen offset:1024 lds
    s_waitcnt vmcnt(12)
    s_add_u32 m0, s75, 114688
    s_add_u32 s67, s77, 0
    buffer_load_dwordx4 v5, s[16:19], s67 offen lds
    buffer_load_dwordx4 v6, s[16:19], s67 offen offset:1024 lds
    s_waitcnt vmcnt(12)
    s_add_u32 m0, s75, 122880
    s_add_u32 s67, s77, 14336
    buffer_load_dwordx4 v5, s[16:19], s67 offen lds
    buffer_load_dwordx4 v6, s[16:19], s67 offen offset:1024 lds
    s_waitcnt vmcnt(10)
    s_barrier
    s_buffer_load_dword s56, s[28:31], 0
    s_add_u32 m0, s75, 49152
    s_add_u32 s67, s60, 0
    buffer_load_dwordx4 v2, s[12:15], s67 offen lds
    buffer_load_dwordx4 v3, s[12:15], s67 offen offset:1024 lds
    s_add_u32 m0, s75, 57344
    s_add_u32 s67, s61, 0
    buffer_load_dwordx4 v2, s[12:15], s67 offen lds
    buffer_load_dwordx4 v3, s[12:15], s67 offen offset:1024 lds
    s_waitcnt vmcnt(12)
    s_add_u32 m0, s75, 65536
    s_add_u32 s67, s62, 0
    buffer_load_dwordx4 v2, s[12:15], s67 offen lds
    buffer_load_dwordx4 v3, s[12:15], s67 offen offset:1024 lds
    s_waitcnt vmcnt(12)
    s_add_u32 m0, s75, 8192
    s_add_u32 s67, s77, 128
    buffer_load_dwordx4 v5, s[16:19], s67 offen lds
    buffer_load_dwordx4 v6, s[16:19], s67 offen offset:1024 lds
    s_waitcnt vmcnt(12)
    s_add_u32 m0, s75, 16384
    s_add_u32 s67, s77, 14464
    buffer_load_dwordx4 v5, s[16:19], s67 offen lds
    buffer_load_dwordx4 v6, s[16:19], s67 offen offset:1024 lds
    s_waitcnt vmcnt(12)
    ds_read_b64_tr_b16 v[80:81], v9 offset:49152
    ds_read_b64_tr_b16 v[82:83], v9 offset:50176
    ds_read_b64_tr_b16 v[84:85], v12 offset:49152
    ds_read_b64_tr_b16 v[86:87], v12 offset:50176
Lagain64:
    s_waitcnt lgkmcnt(0)
    s_cmp_ge_u32 s56, 0x10
    s_cbranch_scc1 Lok65
    s_cmp_eq_u32 s71, 0
    s_cbranch_scc1 Lok65
    s_sub_u32 s71, s71, 1
    buffer_load_dword v7, off, s[28:31], 0 sc1
    s_waitcnt vmcnt(0)
    v_readfirstlane_b32 s56, v7
    s_nop 1
    s_branch Lagain64
Lok65:
    s_barrier
    ds_read_b128 v[208:211], v4 offset:16384
    ds_read_b128 v[212:215], v4 offset:17408
    ds_read_b128 v[216:219], v4 offset:18432
    ds_read_b128 v[220:223], v4 offset:19456
    ds_read_b128 v[224:227], v4 offset:20480
    ds_read_b128 v[228:231], v4 offset:21504
    ds_read_b128 v[232:235], v4 offset:22528
    ds_read_b128 v[236:239], v4 offset:23552
    s_waitcnt lgkmcnt(0)
    s_cmp_lt_u32 s4, 2
    s_cbranch_scc1 Lnoz66
    v_mfma_f32_32x32x16_bf16 v[16:31], v[208:211], v[32:35], 0
    v_mfma_f32_32x32x16_bf16 v[16:31], v[212:215], v[32:35], v[16:31]
    v_mfma_f32_32x32x16_bf16 v[16:31], v[216:219], v[32:35], v[16:31]
    v_mfma_f32_32x32x16_bf16 v[16:31], v[220:223], v[32:35], v[16:31]
    v_mfma_f32_32x32x16_bf16 v[16:31], v[224:227], v[32:35], v[16:31]
    v_mfma_f32_32x32x16_bf16 v[16:31], v[228:231], v[32:35], v[16:31]
    v_mfma_f32_32x32x16_bf16 v[16:31], v[232:235], v[32:35], v[16:31]
    v_mfma_f32_32x32x16_bf16 v[16:31], v[236:239], v[32:35], v[16:31]
    s_nop 11
    v_cvt_pk_bf16_f32 v36, v16, v17
    v_cvt_pk_bf16_f32 v37, v18, v19
    v_cvt_pk_bf16_f32 v38, v20, v21
    v_cvt_pk_bf16_f32 v39, v22, v23
    v_cvt_pk_bf16_f32 v40, v24, v25
    v_cvt_pk_bf16_f32 v41, v26, v27
    v_cvt_pk_bf16_f32 v42, v28, v29
    v_cvt_pk_bf16_f32 v43, v30, v31
    s_mov_b32 exec_lo, 1
    s_mov_b32 exec_hi, 1
    buffer_store_dwordx4 v[36:39], v14, s[20:23], s46 offen offset:0 sc1
    buffer_store_dwordx4 v[40:43], v14, s[20:23], s46 offen offset:1024 sc1
    s_mov_b64 exec, -1
Lnoz66:
    s_add_u32 m0, s75, 73728
    s_add_u32 s67, s63, 0
    buffer_load_dwordx4 v2, s[12:15], s67 offen lds
    buffer_load_dwordx4 v3, s[12:15], s67 offen offset:1024 lds
    s_waitcnt vmcnt(12)
    s_add_u32 m0, s75, 81920
    s_add_u32 s67, s64, 0
    buffer_load_dwordx4 v2, s[12:15], s67 offen lds
    buffer_load_dwordx4 v3, s[12:15], s67 offen offset:1024 lds
    ds_read_b64_tr_b16 v[88:89], v9 offset:57344
    ds_read_b64_tr_b16 v[90:91], v9 offset:58368
    ds_read_b64_tr_b16 v[92:93], v12 offset:57344
    ds_read_b64_tr_b16 v[94:95], v12 offset:58368
    s_waitcnt vmcnt(8)
    s_barrier
    s_waitcnt lgkmcnt(0)
    s_cmp_ge_u32 s4, 2
    s_cbranch_scc1 Lkvdone67
    ds_read_b128 v[48:51], v4 offset:0
    ds_read_b128 v[52:55], v4 offset:1024
    ds_read_b128 v[56:59], v4 offset:2048
    ds_read_b128 v[60:63], v4 offset:3072
    ds_read_b128 v[64:67], v4 offset:4096
    ds_read_b128 v[68:71], v4 offset:5120
    ds_read_b128 v[72:75], v4 offset:6144
    ds_read_b128 v[76:79], v4 offset:7168
    s_setprio 2
    s_waitcnt lgkmcnt(7)
    v_mfma_f32_32x32x16_bf16 v[16:31], v[48:51], v[208:211], 0
    s_waitcnt lgkmcnt(6)
    v_mfma_f32_32x32x16_bf16 v[16:31], v[52:55], v[212:215], v[16:31]
    s_waitcnt lgkmcnt(5)
    v_mfma_f32_32x32x16_bf16 v[16:31], v[56:59], v[216:219], v[16:31]
    s_waitcnt lgkmcnt(4)
    v_mfma_f32_32x32x16_bf16 v[16:31], v[60:63], v[220:223], v[16:31]
    s_waitcnt lgkmcnt(3)
    v_mfma_f32_32x32x16_bf16 v[16:31], v[64:67], v[224:227], v[16:31]
    s_waitcnt lgkmcnt(2)
    v_mfma_f32_32x32x16_bf16 v[16:31], v[68:71], v[228:231], v[16:31]
    s_waitcnt lgkmcnt(1)
    v_mfma_f32_32x32x16_bf16 v[16:31], v[72:75], v[232:235], v[16:31]
    s_waitcnt lgkmcnt(0)
    v_mfma_f32_32x32x16_bf16 v[16:31], v[76:79], v[236:239], v[16:31]
    s_nop 11
    v_cvt_pk_bf16_f32 v16, v16, v17
    v_cvt_pk_bf16_f32 v17, v18, v19
    v_cvt_pk_bf16_f32 v18, v20, v21
    v_cvt_pk_bf16_f32 v19, v22, v23
    v_cvt_pk_bf16_f32 v20, v24, v25
    v_cvt_pk_bf16_f32 v21, v26, v27
    v_cvt_pk_bf16_f32 v22, v28, v29
    v_cvt_pk_bf16_f32 v23, v30, v31
    buffer_store_dwordx4 v[16:19], v15, s[20:23], s47 offen offset:0 sc1
    buffer_store_dwordx4 v[20:23], v15, s[20:23], s47 offen offset:512 sc1
    s_setprio 0
Lkvdone67:
    s_cmp_ge_u32 s4, 2
    s_cbranch_scc1 Lkfdone68
    s_lshl1_add_u32 s68, s6, s4
    s_lshl_b32 s68, s68, 8
    s_lshl2_add_u32 s68, s5, s68
    s_add_u32 s68, s68, 0xa9e000
    s_waitcnt vmcnt(0)
    v_mov_b32 v44, 1
    s_mov_b64 exec, 1
    buffer_store_dword v44, off, s[20:23], s68 sc1
    s_mov_b64 exec, -1
Lkfdone68:
    s_waitcnt vmcnt(0)
    s_barrier
    ds_read_b64_tr_b16 v[96:97], v8 offset:8192
    ds_read_b64_tr_b16 v[98:99], v8 offset:9216
    ds_read_b64_tr_b16 v[100:101], v11 offset:8192
    ds_read_b64_tr_b16 v[102:103], v11 offset:9216
    s_waitcnt lgkmcnt(0)
    ds_read_b64_tr_b16 v[104:105], v8 offset:16384
    ds_read_b64_tr_b16 v[106:107], v8 offset:17408
    ds_read_b64_tr_b16 v[108:109], v11 offset:16384
    ds_read_b64_tr_b16 v[110:111], v11 offset:17408
    s_waitcnt lgkmcnt(0)
    s_waitcnt lgkmcnt(0)
    s_lshl2_add_u32 s67, s66, s4
    s_lshl_b32 s67, s67, 12
    s_add_u32 s37, s67, 0x980000
    s_add_u32 s38, s37, 2048
    s_lshl_b32 s67, s4, 7
    s_add_u32 s67, s67, s66
    s_lshl_b32 s67, s67, 10
    s_add_u32 s39, s67, 0x900000
    v_add_u32 v5, 131072, v1
    v_add_u32 v6, s75, v5
    v_mov_b32 v4, 1024
    v_mov_b32 v3, 1
    s_lshl4_add_u32 s67, s48, s4
    s_lshl_b32 s67, s67, 4
    s_add_u32 s36, s67, 0xa9e000
    s_buffer_load_dwordx4 s[52:55], s[20:23], s36 glc
Lagain69:
    s_waitcnt lgkmcnt(0)
    s_min_u32 s52, s52, s54
    s_min_u32 s53, s53, s55
    s_min_u32 s52, s52, s53
    s_cmp_ge_u32 s52, 0x1
    s_cbranch_scc1 Lok70
    s_cmp_eq_u32 s71, 0
    s_cbranch_scc1 Lok70
    s_sub_u32 s71, s71, 1
    s_buffer_load_dwordx4 s[52:55], s[20:23], s36 glc
    s_branch Lagain69
Lok70:
    buffer_load_dwordx4 v[48:51], v254, s[20:23], s37 offen offset:0 sc1
    buffer_load_dwordx4 v[52:55], v254, s[20:23], s37 offen offset:512 sc1
    buffer_load_dwordx4 v[56:59], v254, s[20:23], s38 offen offset:0 sc1
    buffer_load_dwordx4 v[60:63], v254, s[20:23], s38 offen offset:512 sc1
    s_waitcnt vmcnt(0)
    v_lshlrev_b32 v16, 16, v48
    v_and_b32 v17, 0xffff0000, v48
    v_lshlrev_b32 v18, 16, v49
    v_and_b32 v19, 0xffff0000, v49
    v_lshlrev_b32 v32, 16, v56
    v_and_b32 v33, 0xffff0000, v56
    v_lshlrev_b32 v34, 16, v57
    v_and_b32 v35, 0xffff0000, v57
    v_pk_add_f32 v[16:17], v[16:17], v[32:33]
    v_pk_add_f32 v[18:19], v[18:19], v[34:35]
    ds_write_b128 v6, v[16:19] offset:0
    v_lshlrev_b32 v20, 16, v50
    v_and_b32 v21, 0xffff0000, v50
    v_lshlrev_b32 v22, 16, v51
    v_and_b32 v23, 0xffff0000, v51
    v_lshlrev_b32 v36, 16, v58
    v_and_b32 v37, 0xffff0000, v58
    v_lshlrev_b32 v38, 16, v59
    v_and_b32 v39, 0xffff0000, v59
    v_pk_add_f32 v[20:21], v[20:21], v[36:37]
    v_pk_add_f32 v[22:23], v[22:23], v[38:39]
    ds_write_b128 v6, v[20:23] offset:1024
    v_lshlrev_b32 v24, 16, v52
    v_and_b32 v25, 0xffff0000, v52
    v_lshlrev_b32 v26, 16, v53
    v_and_b32 v27, 0xffff0000, v53
    v_lshlrev_b32 v40, 16, v60
    v_and_b32 v41, 0xffff0000, v60
    v_lshlrev_b32 v42, 16, v61
    v_and_b32 v43, 0xffff0000, v61
    v_pk_add_f32 v[24:25], v[24:25], v[40:41]
    v_pk_add_f32 v[26:27], v[26:27], v[42:43]
    ds_write_b128 v6, v[24:27] offset:8192
    v_lshlrev_b32 v28, 16, v54
    v_and_b32 v29, 0xffff0000, v54
    v_lshlrev_b32 v30, 16, v55
    v_and_b32 v31, 0xffff0000, v55
    v_lshlrev_b32 v44, 16, v62
    v_and_b32 v45, 0xffff0000, v62
    v_lshlrev_b32 v46, 16, v63
    v_and_b32 v47, 0xffff0000, v63
    v_pk_add_f32 v[28:29], v[28:29], v[44:45]
    v_pk_add_f32 v[30:31], v[30:31], v[46:47]
    ds_write_b128 v6, v[28:31] offset:9216
    s_waitcnt lgkmcnt(0)
    s_mov_b64 exec, 1
    ds_add_u32 v4, v3
    s_mov_b64 exec, -1
Llagain71:
    ds_read_b32 v14, v4
    s_waitcnt lgkmcnt(0)
    v_cmp_le_u32 vcc, 4, v14
    s_nop 1
    s_cmp_eq_u64 vcc, exec
    s_cbranch_scc1 Llok72
    s_cmp_eq_u32 s71, 0
    s_cbranch_scc1 Llok72
    s_sub_u32 s71, s71, 1
    s_branch Llagain71
Llok72:
    ds_read_b128 v[128:131], v5 offset:0
    ds_read_b128 v[132:135], v5 offset:2048
    ds_read_b128 v[136:139], v5 offset:4096
    ds_read_b128 v[140:143], v5 offset:6144
    ds_read_b128 v[144:147], v5 offset:1024
    ds_read_b128 v[148:151], v5 offset:3072
    ds_read_b128 v[152:155], v5 offset:5120
    ds_read_b128 v[156:159], v5 offset:7168
    ds_read_b128 v[160:163], v5 offset:8192
    ds_read_b128 v[164:167], v5 offset:10240
    ds_read_b128 v[168:171], v5 offset:12288
    ds_read_b128 v[172:175], v5 offset:14336
    ds_read_b128 v[176:179], v5 offset:9216
    ds_read_b128 v[180:183], v5 offset:11264
    ds_read_b128 v[184:187], v5 offset:13312
    ds_read_b128 v[188:191], v5 offset:15360
    s_waitcnt lgkmcnt(12)
    v_pk_add_f32 v[128:129], v[128:129], v[132:133]
    v_pk_add_f32 v[130:131], v[130:131], v[134:135]
    v_pk_add_f32 v[136:137], v[136:137], v[140:141]
    v_pk_add_f32 v[138:139], v[138:139], v[142:143]
    v_pk_add_f32 v[128:129], v[128:129], v[136:137]
    v_pk_add_f32 v[130:131], v[130:131], v[138:139]
    v_cvt_pk_bf16_f32 v64, v128, v129
    v_cvt_pk_bf16_f32 v65, v130, v131
    s_waitcnt lgkmcnt(8)
    v_pk_add_f32 v[144:145], v[144:145], v[148:149]
    v_pk_add_f32 v[146:147], v[146:147], v[150:151]
    v_pk_add_f32 v[152:153], v[152:153], v[156:157]
    v_pk_add_f32 v[154:155], v[154:155], v[158:159]
    v_pk_add_f32 v[144:145], v[144:145], v[152:153]
    v_pk_add_f32 v[146:147], v[146:147], v[154:155]
    v_cvt_pk_bf16_f32 v66, v144, v145
    v_cvt_pk_bf16_f32 v67, v146, v147
    s_waitcnt lgkmcnt(4)
    v_pk_add_f32 v[160:161], v[160:161], v[164:165]
    v_pk_add_f32 v[162:163], v[162:163], v[166:167]
    v_pk_add_f32 v[168:169], v[168:169], v[172:173]
    v_pk_add_f32 v[170:171], v[170:171], v[174:175]
    v_pk_add_f32 v[160:161], v[160:161], v[168:169]
    v_pk_add_f32 v[162:163], v[162:163], v[170:171]
    v_cvt_pk_bf16_f32 v68, v160, v161
    v_cvt_pk_bf16_f32 v69, v162, v163
    s_waitcnt lgkmcnt(0)
    v_pk_add_f32 v[176:177], v[176:177], v[180:181]
    v_pk_add_f32 v[178:179], v[178:179], v[182:183]
    v_pk_add_f32 v[184:185], v[184:185], v[188:189]
    v_pk_add_f32 v[186:187], v[186:187], v[190:191]
    v_pk_add_f32 v[176:177], v[176:177], v[184:185]
    v_pk_add_f32 v[178:179], v[178:179], v[186:187]
    v_cvt_pk_bf16_f32 v70, v176, v177
    v_cvt_pk_bf16_f32 v71, v178, v179
    s_mov_b32 exec_lo, 0
    v_mov_b32 v70, 0
    v_mov_b32 v71, 0
    s_mov_b32 exec_lo, -1
    s_nop 3
    v_mfma_f32_32x32x16_bf16 v[128:143], v[64:67], v[80:83], 0
    v_mfma_f32_32x32x16_bf16 v[144:159], v[64:67], v[84:87], 0
    v_mfma_f32_32x32x16_bf16 v[160:175], v[64:67], v[96:99], 0
    v_mfma_f32_32x32x16_bf16 v[176:191], v[64:67], v[100:103], 0
    v_mfma_f32_32x32x16_bf16 v[128:143], v[68:71], v[88:91], v[128:143]
    v_mfma_f32_32x32x16_bf16 v[144:159], v[68:71], v[92:95], v[144:159]
    v_mfma_f32_32x32x16_bf16 v[160:175], v[68:71], v[104:107], v[160:175]
    v_mfma_f32_32x32x16_bf16 v[176:191], v[68:71], v[108:111], v[176:191]
    s_nop 8
    v_add_f32 v128, v128, v136
    v_add_f32 v129, v129, v137
    v_add_f32 v130, v130, v138
    v_add_f32 v131, v131, v139
    v_add_f32 v132, v132, v140
    v_add_f32 v133, v133, v141
    v_add_f32 v134, v134, v142
    v_add_f32 v135, v135, v143
    v_cvt_pk_bf16_f32 v136, v128, v129
    v_cvt_pk_bf16_f32 v137, v130, v131
    v_cvt_pk_bf16_f32 v138, v132, v133
    v_cvt_pk_bf16_f32 v139, v134, v135
    s_add_u32 s67, s39, 0
    buffer_store_dwordx4 v[136:139], v1, s[20:23], s67 offen sc1
    v_add_f32 v144, v144, v152
    v_add_f32 v145, v145, v153
    v_add_f32 v146, v146, v154
    v_add_f32 v147, v147, v155
    v_add_f32 v148, v148, v156
    v_add_f32 v149, v149, v157
    v_add_f32 v150, v150, v158
    v_add_f32 v151, v151, v159
    v_cvt_pk_bf16_f32 v152, v144, v145
    v_cvt_pk_bf16_f32 v153, v146, v147
    v_cvt_pk_bf16_f32 v154, v148, v149
    v_cvt_pk_bf16_f32 v155, v150, v151
    s_add_u32 s67, s39, 32768
    buffer_store_dwordx4 v[152:155], v1, s[20:23], s67 offen sc1
    s_cmp_eq_u32 s4, 3
    s_cbranch_scc1 Lmlast73
    v_add_f32 v160, v160, v168
    v_add_f32 v161, v161, v169
    v_add_f32 v162, v162, v170
    v_add_f32 v163, v163, v171
    v_add_f32 v164, v164, v172
    v_add_f32 v165, v165, v173
    v_add_f32 v166, v166, v174
    v_add_f32 v167, v167, v175
    v_cvt_pk_bf16_f32 v168, v160, v161
    v_cvt_pk_bf16_f32 v169, v162, v163
    v_cvt_pk_bf16_f32 v170, v164, v165
    v_cvt_pk_bf16_f32 v171, v166, v167
    s_add_u32 s67, s39, 65536
    buffer_store_dwordx4 v[168:171], v1, s[20:23], s67 offen sc1
    v_add_f32 v176, v176, v184
    v_add_f32 v177, v177, v185
    v_add_f32 v178, v178, v186
    v_add_f32 v179, v179, v187
    v_add_f32 v180, v180, v188
    v_add_f32 v181, v181, v189
    v_add_f32 v182, v182, v190
    v_add_f32 v183, v183, v191
    v_cvt_pk_bf16_f32 v184, v176, v177
    v_cvt_pk_bf16_f32 v185, v178, v179
    v_cvt_pk_bf16_f32 v186, v180, v181
    v_cvt_pk_bf16_f32 v187, v182, v183
    s_add_u32 s67, s39, 98304
    buffer_store_dwordx4 v[184:187], v1, s[20:23], s67 offen sc1
Lmlast73:
    s_waitcnt vmcnt(0)
    v_mov_b32 v14, 1
    v_mul_u32_u24 v15, 2304, v0
    s_mov_b64 exec, 0xff
    buffer_store_dword v14, v15, s[20:23], s79 offen sc1
    s_mov_b64 exec, -1
    s_endpgm
L_M:
    s_lshr_b32 s67, s7, 2
    s_lshl4_add_u32 s67, s67, s5
    s_lshr_b32 s68, s6, 1
    s_lshl2_add_u32 s67, s67, s68
    s_lshr_b32 s68, s4, 1
    s_lshl3_add_u32 s67, s67, s68
    s_and_b32 s68, s6, 1
    s_lshl1_add_u32 s67, s67, s68
    s_and_b32 s68, s4, 1
    s_lshl1_add_u32 s67, s67, s68
    s_lshl_b32 s67, s67, 2
    s_add_u32 s70, s67, 0xa90000
    s_lshr_b32 s67, s66, 3
    s_lshl2_add_u32 s67, s67, s4
    s_lshl_b32 s67, s67, 5
    s_and_b32 s68, s66, 7
    s_add_u32 s67, s67, s68
    s_lshl_b32 s67, s67, 2
    s_add_u32 s79, s67, 0xa98000
    s_mul_i32 s69, s4, 28672
    s_add_u32 s69, s69, 49152
    v_and_b32 v10, 31, v0
    v_lshlrev_b32 v11, 7, v10
    v_bfe_u32 v12, v10, 1, 3
    v_lshrrev_b32 v13, 5, v0
    v_xor_b32 v12, v12, v13
    v_lshl_add_u32 v248, v12, 4, v11
    v_add_u32 v248, s69, v248
    v_xor_b32 v249, 32, v248
    v_xor_b32 v250, 64, v248
    v_xor_b32 v251, 0x60, v248
    s_mov_b32 s72, 0xffff0000
    s_mov_b32 s74, 0x3f803f80
    v_mov_b32 v240, 0
    v_mov_b32 v241, 0
    v_mov_b32 v242, 0
    v_mov_b32 v243, 0
    v_mov_b32 v244, 0
    s_waitcnt lgkmcnt(0)
    s_mov_b32 s8, s36
    s_mov_b32 s9, s37
    s_mov_b32 s10, 0x1c0000
    s_mov_b32 s11, 0x20000
    s_mov_b32 s12, s46
    s_mov_b32 s13, s47
    s_mov_b32 s14, 0xe00
    s_mov_b32 s15, 0x20000
    s_add_u32 s20, s56, 0x0
    s_addc_u32 s21, s57, 0
    s_mov_b32 s22, 0xc00000
    s_mov_b32 s23, 0x20000
    s_mov_b32 s24, s52
    s_mov_b32 s25, s53
    s_mov_b32 s26, 0x1c0000
    s_mov_b32 s27, 0x20000
    s_mov_b32 s28, s54
    s_mov_b32 s29, s55
    s_mov_b32 s30, 0x100
    s_mov_b32 s31, 0x20000
    s_mov_b32 s32, s50
    s_mov_b32 s33, s51
    s_mov_b32 s34, 0x380
    s_mov_b32 s35, 0x20000
    s_cmp_lg_u32 s4, 3
    s_cbranch_scc1 Lms1
    v_and_b32 v10, 15, v0
    v_lshlrev_b32 v10, 7, v10
    buffer_load_dword v247, v10, s[32:35], 0 offen
Lms1:
    s_lshl_b32 s67, s4, 8
    s_add_u32 s67, s67, s2
    s_cmp_ge_u32 s67, 16
    s_cbranch_scc1 Lms5
    s_lshl_b32 s67, s2, 12
    s_add_u32 s67, s67, 0xa90000
    buffer_store_dwordx4 v[240:243], v1, s[20:23], s67 offen offset:0 sc1
    buffer_store_dwordx4 v[240:243], v1, s[20:23], s67 offen offset:1024 sc1
    buffer_store_dwordx4 v[240:243], v1, s[20:23], s67 offen offset:2048 sc1
    buffer_store_dwordx4 v[240:243], v1, s[20:23], s67 offen offset:3072 sc1
Lms5:
    s_cmp_lt_u32 s7, 4
    s_cbranch_scc1 Lms2
    s_cmp_lg_u32 s7, 7
    s_cbranch_scc1 Lms3
    v_mov_b32 v10, 1024
    ds_write_b32 v10, v240
    s_lshl2_add_u32 s67, s66, s4
    s_lshl_b32 s67, s67, 13
    s_add_u32 s67, s67, 0x980000
    s_add_u32 s68, s67, 4096
    s_branch Lms3
Lms2:
    s_cmp_lg_u32 s4, 1
    s_cbranch_scc1 Lms3
    s_and_b32 s67, s6, 1
    s_lshl_b32 s67, s67, 3
    v_add_u32 v10, s67, v0
    v_subrev_u32 v11, 56, v10
    v_min_u32 v10, v10, v11
    v_lshlrev_b32 v244, 3, v10
    s_mul_i32 s61, s6, 448
    buffer_load_dwordx2 v[244:245], v244, s[12:15], s61 offen
Lms3:
    s_cmp_ge_u32 s7, 4
    s_cselect_b32 s67, 56, 64
    v_lshrrev_b32 v12, 5, v0
    v_mul_u32_u24 v12, 8, v12
    v_bfe_u32 v13, v0, 2, 2
    v_add_u32 v12, v12, v13
    v_lshlrev_b32 v12, 7, v12
    v_bfe_u32 v13, v0, 4, 1
    v_lshlrev_b32 v13, 5, v13
    v_and_b32 v2, 3, v0
    v_lshl_add_u32 v2, v2, 3, v13
    v_bfe_u32 v13, v0, 3, 1
    v_lshlrev_b32 v13, 6, v13
    v_xor_b32 v2, v2, v13
    v_add_u32 v2, v2, v12
    v_lshrrev_b32 v12, 5, v0
    v_mul_u32_u24 v12, 8, v12
    v_bfe_u32 v13, v0, 2, 2
    v_add_u32 v12, v12, v13
    v_lshlrev_b32 v12, 7, v12
    v_bfe_u32 v13, v0, 4, 1
    v_lshlrev_b32 v13, 5, v13
    v_and_b32 v5, 3, v0
    v_lshl_add_u32 v5, v5, 3, v13
    v_add_u32 v5, s67, v5
    v_bfe_u32 v13, v0, 3, 1
    v_lshlrev_b32 v13, 6, v13
    v_xor_b32 v5, v5, v13
    v_add_u32 v5, v5, v12
    v_lshrrev_b32 v12, 5, v0
    v_mul_u32_u24 v12, 8, v12
    v_bfe_u32 v13, v0, 2, 2
    v_add_u32 v12, v12, v13
    v_lshlrev_b32 v12, 6, v12
    v_bfe_u32 v13, v0, 4, 1
    v_lshlrev_b32 v13, 5, v13
    v_and_b32 v8, 3, v0
    v_lshl_add_u32 v8, v8, 3, v13
    v_add_u32 v8, v8, v12
    v_add_u32 v3, 0x10000, v2
    v_add_u32 v4, 0x20000, v2
    v_add_u32 v6, 0x10000, v5
    v_add_u32 v7, 0x20000, v5
    v_add_u32 v9, 0x10000, v8
    v_add_u32 v10, 0x20000, v8
    v_lshrrev_b32 v11, 5, v0
    v_lshlrev_b32 v11, 4, v11
    s_lshr_b32 s67, s4, 1
    s_lshl1_add_u32 s67, s5, s67
    s_lshl3_add_u32 s67, s67, s6
    s_and_b32 s68, s4, 1
    s_lshl1_add_u32 s67, s67, s68
    s_lshl_b32 s36, s67, 10
    s_add_u32 s37, s36, 0x80000
    s_add_u32 s38, s37, 0x80000
    s_add_u32 s39, s38, 0x80000
    s_add_u32 s40, s39, 0x80000
    s_add_u32 s41, s40, 0x80000
    s_add_u32 s42, s41, 0x80000
    s_add_u32 s43, s42, 0x80000
    s_add_u32 s44, s43, 0x80000
    s_add_u32 s45, s44, 0x80000
    s_add_u32 s46, s45, 0x80000
    s_add_u32 s47, s46, 0x80000
    s_add_u32 s48, s47, 0x80000
    s_add_u32 s49, s48, 0x80000
    s_barrier
    ds_read_b128 v[128:131], v248 offset:0
    ds_read_b128 v[132:135], v249 offset:0
    ds_read_b128 v[136:139], v250 offset:0
    ds_read_b128 v[140:143], v251 offset:0
    s_waitcnt lgkmcnt(2)
    v_dot2c_f32_bf16 v240, s74, v128
    v_dot2c_f32_bf16 v242, v128, v128
    v_lshlrev_b32 v16, 16, v128
    v_and_b32 v17, s72, v128
    v_dot2c_f32_bf16 v241, s74, v129
    v_dot2c_f32_bf16 v243, v129, v129
    v_lshlrev_b32 v18, 16, v129
    v_and_b32 v19, s72, v129
    v_dot2c_f32_bf16 v240, s74, v130
    v_dot2c_f32_bf16 v242, v130, v130
    v_lshlrev_b32 v128, 16, v130
    v_and_b32 v129, s72, v130
    v_dot2c_f32_bf16 v241, s74, v131
    v_dot2c_f32_bf16 v243, v131, v131
    v_lshlrev_b32 v130, 16, v131
    v_and_b32 v131, s72, v131
    s_barrier
    v_dot2c_f32_bf16 v240, s74, v132
    v_dot2c_f32_bf16 v242, v132, v132
    v_lshlrev_b32 v20, 16, v132
    v_and_b32 v21, s72, v132
    v_dot2c_f32_bf16 v241, s74, v133
    v_dot2c_f32_bf16 v243, v133, v133
    ds_read_b128 v[144:147], v248 offset:4096
    v_lshlrev_b32 v22, 16, v133
    v_and_b32 v23, s72, v133
    v_dot2c_f32_bf16 v240, s74, v134
    v_dot2c_f32_bf16 v242, v134, v134
    v_lshlrev_b32 v132, 16, v134
    v_and_b32 v133, s72, v134
    ds_read_b128 v[148:151], v249 offset:4096
    v_dot2c_f32_bf16 v241, s74, v135
    v_dot2c_f32_bf16 v243, v135, v135
    v_lshlrev_b32 v134, 16, v135
    v_and_b32 v135, s72, v135
    s_waitcnt lgkmcnt(2)
    v_dot2c_f32_bf16 v240, s74, v136
    v_dot2c_f32_bf16 v242, v136, v136
    ds_read_b128 v[152:155], v250 offset:4096
    v_lshlrev_b32 v24, 16, v136
    v_and_b32 v25, s72, v136
    v_dot2c_f32_bf16 v241, s74, v137
    v_dot2c_f32_bf16 v243, v137, v137
    v_lshlrev_b32 v26, 16, v137
    v_and_b32 v27, s72, v137
    ds_read_b128 v[156:159], v251 offset:4096
    v_dot2c_f32_bf16 v240, s74, v138
    v_dot2c_f32_bf16 v242, v138, v138
    v_lshlrev_b32 v136, 16, v138
    v_and_b32 v137, s72, v138
    v_dot2c_f32_bf16 v241, s74, v139
    v_dot2c_f32_bf16 v243, v139, v139
    v_lshlrev_b32 v138, 16, v139
    v_and_b32 v139, s72, v139
    v_dot2c_f32_bf16 v240, s74, v140
    v_dot2c_f32_bf16 v242, v140, v140
    v_lshlrev_b32 v28, 16, v140
    v_and_b32 v29, s72, v140
    v_dot2c_f32_bf16 v241, s74, v141
    v_dot2c_f32_bf16 v243, v141, v141
    v_lshlrev_b32 v30, 16, v141
    v_and_b32 v31, s72, v141
    v_dot2c_f32_bf16 v240, s74, v142
    v_dot2c_f32_bf16 v242, v142, v142
    v_lshlrev_b32 v140, 16, v142
    v_and_b32 v141, s72, v142
    v_dot2c_f32_bf16 v241, s74, v143
    v_dot2c_f32_bf16 v243, v143, v143
    v_lshlrev_b32 v142, 16, v143
    v_and_b32 v143, s72, v143
    s_waitcnt lgkmcnt(2)
    v_dot2c_f32_bf16 v240, s74, v144
    v_dot2c_f32_bf16 v242, v144, v144
    v_lshlrev_b32 v32, 16, v144
    v_and_b32 v33, s72, v144
    v_dot2c_f32_bf16 v241, s74, v145
    v_dot2c_f32_bf16 v243, v145, v145
    v_lshlrev_b32 v34, 16, v145
    v_and_b32 v35, s72, v145
    v_dot2c_f32_bf16 v240, s74, v146
    v_dot2c_f32_bf16 v242, v146, v146
    v_lshlrev_b32 v144, 16, v146
    v_and_b32 v145, s72, v146
    v_dot2c_f32_bf16 v241, s74, v147
    v_dot2c_f32_bf16 v243, v147, v147
    v_lshlrev_b32 v146, 16, v147
    v_and_b32 v147, s72, v147
    s_barrier
    v_dot2c_f32_bf16 v240, s74, v148
    v_dot2c_f32_bf16 v242, v148, v148
    v_lshlrev_b32 v36, 16, v148
    v_and_b32 v37, s72, v148
    v_dot2c_f32_bf16 v241, s74, v149
    v_dot2c_f32_bf16 v243, v149, v149
    ds_read_b128 v[192:195], v248 offset:8192
    v_lshlrev_b32 v38, 16, v149
    v_and_b32 v39, s72, v149
    v_dot2c_f32_bf16 v240, s74, v150
    v_dot2c_f32_bf16 v242, v150, v150
    v_lshlrev_b32 v148, 16, v150
    v_and_b32 v149, s72, v150
    ds_read_b128 v[196:199], v249 offset:8192
    v_dot2c_f32_bf16 v241, s74, v151
    v_dot2c_f32_bf16 v243, v151, v151
    v_lshlrev_b32 v150, 16, v151
    v_and_b32 v151, s72, v151
    s_waitcnt lgkmcnt(2)
    v_dot2c_f32_bf16 v240, s74, v152
    v_dot2c_f32_bf16 v242, v152, v152
    ds_read_b128 v[200:203], v250 offset:8192
    v_lshlrev_b32 v40, 16, v152
    v_and_b32 v41, s72, v152
    v_dot2c_f32_bf16 v241, s74, v153
    v_dot2c_f32_bf16 v243, v153, v153
    v_lshlrev_b32 v42, 16, v153
    v_and_b32 v43, s72, v153
    ds_read_b128 v[204:207], v251 offset:8192
    v_dot2c_f32_bf16 v240, s74, v154
    v_dot2c_f32_bf16 v242, v154, v154
    v_lshlrev_b32 v152, 16, v154
    v_and_b32 v153, s72, v154
    v_dot2c_f32_bf16 v241, s74, v155
    v_dot2c_f32_bf16 v243, v155, v155
    v_lshlrev_b32 v154, 16, v155
    v_and_b32 v155, s72, v155
    v_dot2c_f32_bf16 v240, s74, v156
    v_dot2c_f32_bf16 v242, v156, v156
    v_lshlrev_b32 v44, 16, v156
    v_and_b32 v45, s72, v156
    v_dot2c_f32_bf16 v241, s74, v157
    v_dot2c_f32_bf16 v243, v157, v157
    v_lshlrev_b32 v46, 16, v157
    v_and_b32 v47, s72, v157
    v_dot2c_f32_bf16 v240, s74, v158
    v_dot2c_f32_bf16 v242, v158, v158
    v_lshlrev_b32 v156, 16, v158
    v_and_b32 v157, s72, v158
    v_dot2c_f32_bf16 v241, s74, v159
    v_dot2c_f32_bf16 v243, v159, v159
    v_lshlrev_b32 v158, 16, v159
    v_and_b32 v159, s72, v159
    s_waitcnt lgkmcnt(2)
    v_dot2c_f32_bf16 v240, s74, v192
    v_dot2c_f32_bf16 v242, v192, v192
    v_lshlrev_b32 v48, 16, v192
    v_and_b32 v49, s72, v192
    v_dot2c_f32_bf16 v241, s74, v193
    v_dot2c_f32_bf16 v243, v193, v193
    v_lshlrev_b32 v50, 16, v193
    v_and_b32 v51, s72, v193
    v_dot2c_f32_bf16 v240, s74, v194
    v_dot2c_f32_bf16 v242, v194, v194
    v_lshlrev_b32 v192, 16, v194
    v_and_b32 v193, s72, v194
    v_dot2c_f32_bf16 v241, s74, v195
    v_dot2c_f32_bf16 v243, v195, v195
    v_lshlrev_b32 v194, 16, v195
    v_and_b32 v195, s72, v195
    s_barrier
    v_dot2c_f32_bf16 v240, s74, v196
    v_dot2c_f32_bf16 v242, v196, v196
    v_lshlrev_b32 v52, 16, v196
    v_and_b32 v53, s72, v196
    v_dot2c_f32_bf16 v241, s74, v197
    v_dot2c_f32_bf16 v243, v197, v197
    ds_read_b128 v[208:211], v248 offset:12288
    v_lshlrev_b32 v54, 16, v197
    v_and_b32 v55, s72, v197
    v_dot2c_f32_bf16 v240, s74, v198
    v_dot2c_f32_bf16 v242, v198, v198
    v_lshlrev_b32 v196, 16, v198
    v_and_b32 v197, s72, v198
    ds_read_b128 v[212:215], v249 offset:12288
    v_dot2c_f32_bf16 v241, s74, v199
    v_dot2c_f32_bf16 v243, v199, v199
    v_lshlrev_b32 v198, 16, v199
    v_and_b32 v199, s72, v199
    s_waitcnt lgkmcnt(2)
    v_dot2c_f32_bf16 v240, s74, v200
    v_dot2c_f32_bf16 v242, v200, v200
    ds_read_b128 v[216:219], v250 offset:12288
    v_lshlrev_b32 v56, 16, v200
    v_and_b32 v57, s72, v200
    v_dot2c_f32_bf16 v241, s74, v201
    v_dot2c_f32_bf16 v243, v201, v201
    v_lshlrev_b32 v58, 16, v201
    v_and_b32 v59, s72, v201
    ds_read_b128 v[220:223], v251 offset:12288
    v_dot2c_f32_bf16 v240, s74, v202
    v_dot2c_f32_bf16 v242, v202, v202
    v_lshlrev_b32 v200, 16, v202
    v_and_b32 v201, s72, v202
    v_dot2c_f32_bf16 v241, s74, v203
    v_dot2c_f32_bf16 v243, v203, v203
    v_lshlrev_b32 v202, 16, v203
    v_and_b32 v203, s72, v203
    v_dot2c_f32_bf16 v240, s74, v204
    v_dot2c_f32_bf16 v242, v204, v204
    v_lshlrev_b32 v60, 16, v204
    v_and_b32 v61, s72, v204
    v_dot2c_f32_bf16 v241, s74, v205
    v_dot2c_f32_bf16 v243, v205, v205
    v_lshlrev_b32 v62, 16, v205
    v_and_b32 v63, s72, v205
    v_dot2c_f32_bf16 v240, s74, v206
    v_dot2c_f32_bf16 v242, v206, v206
    v_lshlrev_b32 v204, 16, v206
    v_and_b32 v205, s72, v206
    v_dot2c_f32_bf16 v241, s74, v207
    v_dot2c_f32_bf16 v243, v207, v207
    v_lshlrev_b32 v206, 16, v207
    v_and_b32 v207, s72, v207
    s_waitcnt lgkmcnt(2)
    v_dot2c_f32_bf16 v240, s74, v208
    v_dot2c_f32_bf16 v242, v208, v208
    v_dot2c_f32_bf16 v241, s74, v209
    v_dot2c_f32_bf16 v243, v209, v209
    v_dot2c_f32_bf16 v240, s74, v210
    v_dot2c_f32_bf16 v242, v210, v210
    v_dot2c_f32_bf16 v241, s74, v211
    v_dot2c_f32_bf16 v243, v211, v211
    s_barrier
    v_dot2c_f32_bf16 v240, s74, v212
    v_dot2c_f32_bf16 v242, v212, v212
    v_dot2c_f32_bf16 v241, s74, v213
    ds_read_b128 v[224:227], v248 offset:16384
    v_dot2c_f32_bf16 v243, v213, v213
    v_dot2c_f32_bf16 v240, s74, v214
    v_dot2c_f32_bf16 v242, v214, v214
    ds_read_b128 v[228:231], v249 offset:16384
    v_dot2c_f32_bf16 v241, s74, v215
    v_dot2c_f32_bf16 v243, v215, v215
    s_waitcnt lgkmcnt(2)
    v_dot2c_f32_bf16 v240, s74, v216
    ds_read_b128 v[232:235], v250 offset:16384
    v_dot2c_f32_bf16 v242, v216, v216
    v_dot2c_f32_bf16 v241, s74, v217
    v_dot2c_f32_bf16 v243, v217, v217
    ds_read_b128 v[236:239], v251 offset:16384
    v_dot2c_f32_bf16 v240, s74, v218
    v_dot2c_f32_bf16 v242, v218, v218
    v_dot2c_f32_bf16 v241, s74, v219
    v_dot2c_f32_bf16 v243, v219, v219
    v_dot2c_f32_bf16 v240, s74, v220
    v_dot2c_f32_bf16 v242, v220, v220
    v_dot2c_f32_bf16 v241, s74, v221
    v_dot2c_f32_bf16 v243, v221, v221
    v_dot2c_f32_bf16 v240, s74, v222
    v_dot2c_f32_bf16 v242, v222, v222
    v_dot2c_f32_bf16 v241, s74, v223
    v_dot2c_f32_bf16 v243, v223, v223
    s_waitcnt lgkmcnt(2)
    v_dot2c_f32_bf16 v240, s74, v224
    v_dot2c_f32_bf16 v242, v224, v224
    v_dot2c_f32_bf16 v241, s74, v225
    v_dot2c_f32_bf16 v243, v225, v225
    v_dot2c_f32_bf16 v240, s74, v226
    v_dot2c_f32_bf16 v242, v226, v226
    v_dot2c_f32_bf16 v241, s74, v227
    v_dot2c_f32_bf16 v243, v227, v227
    s_barrier
    v_dot2c_f32_bf16 v240, s74, v228
    v_dot2c_f32_bf16 v242, v228, v228
    v_dot2c_f32_bf16 v241, s74, v229
    ds_read_b128 v[160:163], v248 offset:20480
    v_dot2c_f32_bf16 v243, v229, v229
    v_dot2c_f32_bf16 v240, s74, v230
    v_dot2c_f32_bf16 v242, v230, v230
    ds_read_b128 v[164:167], v249 offset:20480
    v_dot2c_f32_bf16 v241, s74, v231
    v_dot2c_f32_bf16 v243, v231, v231
    s_waitcnt lgkmcnt(2)
    v_dot2c_f32_bf16 v240, s74, v232
    ds_read_b128 v[168:171], v250 offset:20480
    v_dot2c_f32_bf16 v242, v232, v232
    v_dot2c_f32_bf16 v241, s74, v233
    v_dot2c_f32_bf16 v243, v233, v233
    ds_read_b128 v[172:175], v251 offset:20480
    s_lshl2_add_u32 s67, s7, s4
    s_and_b32 s67, s67, 0x13
    s_cmp_lg_u32 s67, 1
    s_cbranch_scc1 Lms4
    s_mov_b32 s68, 0x3eeff558
    s_waitcnt vmcnt(0)
    v_lshlrev_b32 v12, 16, v244
    v_and_b32 v13, 0xffff0000, v244
    v_lshlrev_b32 v14, 16, v245
    v_and_b32 v15, 0xffff0000, v245
    v_mul_f32 v12, s68, v12
    v_mul_f32 v13, s68, v13
    v_mul_f32 v14, s68, v14
    v_mul_f32 v15, s68, v15
    ds_write_b128 v1, v[12:15]
Lms4:
    v_dot2c_f32_bf16 v240, s74, v234
    v_dot2c_f32_bf16 v242, v234, v234
    v_dot2c_f32_bf16 v241, s74, v235
    v_dot2c_f32_bf16 v243, v235, v235
    v_dot2c_f32_bf16 v240, s74, v236
    v_dot2c_f32_bf16 v242, v236, v236
    v_dot2c_f32_bf16 v241, s74, v237
    v_dot2c_f32_bf16 v243, v237, v237
    v_dot2c_f32_bf16 v240, s74, v238
    v_dot2c_f32_bf16 v242, v238, v238
    v_dot2c_f32_bf16 v241, s74, v239
    v_dot2c_f32_bf16 v243, v239, v239
    s_waitcnt lgkmcnt(2)
    v_dot2c_f32_bf16 v240, s74, v160
    v_dot2c_f32_bf16 v242, v160, v160
    v_dot2c_f32_bf16 v241, s74, v161
    v_dot2c_f32_bf16 v243, v161, v161
    v_dot2c_f32_bf16 v240, s74, v162
    v_dot2c_f32_bf16 v242, v162, v162
    v_dot2c_f32_bf16 v241, s74, v163
    v_dot2c_f32_bf16 v243, v163, v163
    s_barrier
    v_dot2c_f32_bf16 v240, s74, v164
    v_dot2c_f32_bf16 v242, v164, v164
    v_dot2c_f32_bf16 v241, s74, v165
    ds_read_b128 v[176:179], v248 offset:24576
    v_dot2c_f32_bf16 v243, v165, v165
    v_dot2c_f32_bf16 v240, s74, v166
    v_dot2c_f32_bf16 v242, v166, v166
    ds_read_b128 v[180:183], v249 offset:24576
    v_dot2c_f32_bf16 v241, s74, v167
    v_dot2c_f32_bf16 v243, v167, v167
    s_waitcnt lgkmcnt(2)
    v_dot2c_f32_bf16 v240, s74, v168
    ds_read_b128 v[184:187], v250 offset:24576
    v_dot2c_f32_bf16 v242, v168, v168
    v_dot2c_f32_bf16 v241, s74, v169
    v_dot2c_f32_bf16 v243, v169, v169
    ds_read_b128 v[188:191], v251 offset:24576
    v_dot2c_f32_bf16 v240, s74, v170
    v_dot2c_f32_bf16 v242, v170, v170
    v_dot2c_f32_bf16 v241, s74, v171
    v_dot2c_f32_bf16 v243, v171, v171
    v_dot2c_f32_bf16 v240, s74, v172
    v_dot2c_f32_bf16 v242, v172, v172
    v_dot2c_f32_bf16 v241, s74, v173
    v_dot2c_f32_bf16 v243, v173, v173
    v_dot2c_f32_bf16 v240, s74, v174
    v_dot2c_f32_bf16 v242, v174, v174
    v_dot2c_f32_bf16 v241, s74, v175
    v_dot2c_f32_bf16 v243, v175, v175
    s_waitcnt vmcnt(0) lgkmcnt(0)
    s_barrier
    v_dot2c_f32_bf16 v240, s74, v176
    v_dot2c_f32_bf16 v242, v176, v176
    v_dot2c_f32_bf16 v241, s74, v177
    v_dot2c_f32_bf16 v243, v177, v177
    v_dot2c_f32_bf16 v240, s74, v178
    v_dot2c_f32_bf16 v242, v178, v178
    v_dot2c_f32_bf16 v241, s74, v179
    v_dot2c_f32_bf16 v243, v179, v179
    s_sub_u32 s67, s2, 0
    s_and_b32 s67, s67, 0xff
    s_lshl_b32 s68, s4, 8
    s_add_u32 s67, s67, s68
    s_cmp_ge_u32 s67, 16
    s_cbranch_scc1 Lms6
    v_mov_b32 v12, 1
    s_mov_b64 exec, 1
    buffer_atomic_add v12, off, s[28:31], 0 sc1
    s_mov_b64 exec, -1
Lms6:
    v_dot2c_f32_bf16 v240, s74, v180
    v_dot2c_f32_bf16 v242, v180, v180
    v_dot2c_f32_bf16 v241, s74, v181
    v_dot2c_f32_bf16 v243, v181, v181
    v_dot2c_f32_bf16 v240, s74, v182
    v_dot2c_f32_bf16 v242, v182, v182
    v_dot2c_f32_bf16 v241, s74, v183
    v_dot2c_f32_bf16 v243, v183, v183
    v_dot2c_f32_bf16 v240, s74, v184
    v_dot2c_f32_bf16 v242, v184, v184
    v_dot2c_f32_bf16 v241, s74, v185
    v_dot2c_f32_bf16 v243, v185, v185
    v_dot2c_f32_bf16 v240, s74, v186
    v_dot2c_f32_bf16 v242, v186, v186
    v_dot2c_f32_bf16 v241, s74, v187
    v_dot2c_f32_bf16 v243, v187, v187
    v_dot2c_f32_bf16 v240, s74, v188
    v_dot2c_f32_bf16 v242, v188, v188
    v_dot2c_f32_bf16 v241, s74, v189
    v_dot2c_f32_bf16 v243, v189, v189
    v_dot2c_f32_bf16 v240, s74, v190
    v_dot2c_f32_bf16 v242, v190, v190
    v_dot2c_f32_bf16 v241, s74, v191
    v_dot2c_f32_bf16 v243, v191, v191
    s_cmp_ge_u32 s7, 4
    s_cselect_b32 s73, 1.0, 0x3eeff558
    s_mov_b32 s74, 0xffff0000
    v_add_f32 v240, v240, v241
    v_add_f32 v242, v242, v243
    v_mov_b32 v241, v240
    v_mov_b32 v243, v242
    s_nop 0
    v_permlane32_swap_b32 v240, v241
    v_permlane32_swap_b32 v242, v243
    v_add_f32 v240, v240, v241
    v_add_f32 v242, v242, v243
    v_mul_f32 v240, 0x3b124925, v240
    v_mul_f32 v242, 0x3b124925, v242
    v_fma_f32 v242, -v240, v240, v242
    v_max_f32 v242, 0, v242
    v_cvt_pk_bf16_f32 v241, v240, v242
    v_lshlrev_b32 v240, 16, v241
    v_and_b32 v242, 0xffff0000, v241
    v_add_f32 v242, 0x3727c5ac, v242
    v_cvt_pk_bf16_f32 v242, v242, v242
    v_lshlrev_b32 v242, 16, v242
    v_sqrt_f32 v242, v242
    s_nop 0
    v_cvt_pk_bf16_f32 v242, v242, v242
    v_lshlrev_b32 v242, 16, v242
    v_rcp_f32 v242, v242
    s_nop 0
    v_mul_f32 v242, s73, v242
    v_mul_f32 v240, -v240, v242
    v_pk_fma_f32 v[16:17], v[16:17], v[242:243], v[240:241] op_sel_hi:[1,0,0]
    v_pk_fma_f32 v[18:19], v[18:19], v[242:243], v[240:241] op_sel_hi:[1,0,0]
    v_cvt_pk_bf16_f32 v16, v16, v17
    v_pk_fma_f32 v[128:129], v[128:129], v[242:243], v[240:241] op_sel_hi:[1,0,0]
    v_cvt_pk_bf16_f32 v17, v18, v19
    v_pk_fma_f32 v[130:131], v[130:131], v[242:243], v[240:241] op_sel_hi:[1,0,0]
    v_cvt_pk_bf16_f32 v18, v128, v129
    v_pk_fma_f32 v[20:21], v[20:21], v[242:243], v[240:241] op_sel_hi:[1,0,0]
    v_cvt_pk_bf16_f32 v19, v130, v131
    v_pk_fma_f32 v[22:23], v[22:23], v[242:243], v[240:241] op_sel_hi:[1,0,0]
    v_cvt_pk_bf16_f32 v20, v20, v21
    v_pk_fma_f32 v[132:133], v[132:133], v[242:243], v[240:241] op_sel_hi:[1,0,0]
    v_cvt_pk_bf16_f32 v21, v22, v23
    v_pk_fma_f32 v[134:135], v[134:135], v[242:243], v[240:241] op_sel_hi:[1,0,0]
    v_cvt_pk_bf16_f32 v22, v132, v133
    v_pk_fma_f32 v[24:25], v[24:25], v[242:243], v[240:241] op_sel_hi:[1,0,0]
    v_cvt_pk_bf16_f32 v23, v134, v135
    v_pk_fma_f32 v[26:27], v[26:27], v[242:243], v[240:241] op_sel_hi:[1,0,0]
    v_cvt_pk_bf16_f32 v24, v24, v25
    v_pk_fma_f32 v[136:137], v[136:137], v[242:243], v[240:241] op_sel_hi:[1,0,0]
    v_cvt_pk_bf16_f32 v25, v26, v27
    v_pk_fma_f32 v[138:139], v[138:139], v[242:243], v[240:241] op_sel_hi:[1,0,0]
    v_cvt_pk_bf16_f32 v26, v136, v137
    v_pk_fma_f32 v[28:29], v[28:29], v[242:243], v[240:241] op_sel_hi:[1,0,0]
    v_cvt_pk_bf16_f32 v27, v138, v139
    v_pk_fma_f32 v[30:31], v[30:31], v[242:243], v[240:241] op_sel_hi:[1,0,0]
    v_cvt_pk_bf16_f32 v28, v28, v29
    v_pk_fma_f32 v[140:141], v[140:141], v[242:243], v[240:241] op_sel_hi:[1,0,0]
    v_cvt_pk_bf16_f32 v29, v30, v31
    v_pk_fma_f32 v[142:143], v[142:143], v[242:243], v[240:241] op_sel_hi:[1,0,0]
    v_cvt_pk_bf16_f32 v30, v140, v141
    v_pk_fma_f32 v[32:33], v[32:33], v[242:243], v[240:241] op_sel_hi:[1,0,0]
    v_cvt_pk_bf16_f32 v31, v142, v143
    v_pk_fma_f32 v[34:35], v[34:35], v[242:243], v[240:241] op_sel_hi:[1,0,0]
    v_cvt_pk_bf16_f32 v32, v32, v33
    v_pk_fma_f32 v[144:145], v[144:145], v[242:243], v[240:241] op_sel_hi:[1,0,0]
    v_cvt_pk_bf16_f32 v33, v34, v35
    v_pk_fma_f32 v[146:147], v[146:147], v[242:243], v[240:241] op_sel_hi:[1,0,0]
    v_cvt_pk_bf16_f32 v34, v144, v145
    v_pk_fma_f32 v[36:37], v[36:37], v[242:243], v[240:241] op_sel_hi:[1,0,0]
    v_cvt_pk_bf16_f32 v35, v146, v147
    v_pk_fma_f32 v[38:39], v[38:39], v[242:243], v[240:241] op_sel_hi:[1,0,0]
    v_cvt_pk_bf16_f32 v36, v36, v37
    v_pk_fma_f32 v[148:149], v[148:149], v[242:243], v[240:241] op_sel_hi:[1,0,0]
    v_cvt_pk_bf16_f32 v37, v38, v39
    v_pk_fma_f32 v[150:151], v[150:151], v[242:243], v[240:241] op_sel_hi:[1,0,0]
    v_cvt_pk_bf16_f32 v38, v148, v149
    v_pk_fma_f32 v[40:41], v[40:41], v[242:243], v[240:241] op_sel_hi:[1,0,0]
    v_cvt_pk_bf16_f32 v39, v150, v151
    v_pk_fma_f32 v[42:43], v[42:43], v[242:243], v[240:241] op_sel_hi:[1,0,0]
    v_cvt_pk_bf16_f32 v40, v40, v41
    v_pk_fma_f32 v[152:153], v[152:153], v[242:243], v[240:241] op_sel_hi:[1,0,0]
    v_cvt_pk_bf16_f32 v41, v42, v43
    v_pk_fma_f32 v[154:155], v[154:155], v[242:243], v[240:241] op_sel_hi:[1,0,0]
    v_cvt_pk_bf16_f32 v42, v152, v153
    v_pk_fma_f32 v[44:45], v[44:45], v[242:243], v[240:241] op_sel_hi:[1,0,0]
    v_cvt_pk_bf16_f32 v43, v154, v155
    v_pk_fma_f32 v[46:47], v[46:47], v[242:243], v[240:241] op_sel_hi:[1,0,0]
    v_cvt_pk_bf16_f32 v44, v44, v45
    v_pk_fma_f32 v[156:157], v[156:157], v[242:243], v[240:241] op_sel_hi:[1,0,0]
    v_cvt_pk_bf16_f32 v45, v46, v47
    v_pk_fma_f32 v[158:159], v[158:159], v[242:243], v[240:241] op_sel_hi:[1,0,0]
    v_cvt_pk_bf16_f32 v46, v156, v157
    v_pk_fma_f32 v[48:49], v[48:49], v[242:243], v[240:241] op_sel_hi:[1,0,0]
    v_cvt_pk_bf16_f32 v47, v158, v159
    v_pk_fma_f32 v[50:51], v[50:51], v[242:243], v[240:241] op_sel_hi:[1,0,0]
    v_cvt_pk_bf16_f32 v48, v48, v49
    s_cmp_ge_u32 s7, 4
    s_cbranch_scc1 L_MA
    s_mov_b32 s72, 0xc09d30fc
    ds_read_b128 v[128:131], v11 offset:0
    v_pk_fma_f32 v[192:193], v[192:193], v[242:243], v[240:241] op_sel_hi:[1,0,0]
    v_cvt_pk_bf16_f32 v49, v50, v51
    ds_read_b128 v[132:135], v11 offset:32
    v_pk_fma_f32 v[194:195], v[194:195], v[242:243], v[240:241] op_sel_hi:[1,0,0]
    v_cvt_pk_bf16_f32 v50, v192, v193
    ds_read_b128 v[136:139], v11 offset:64
    v_pk_fma_f32 v[52:53], v[52:53], v[242:243], v[240:241] op_sel_hi:[1,0,0]
    v_cvt_pk_bf16_f32 v51, v194, v195
    ds_read_b128 v[140:143], v11 offset:96
    v_pk_fma_f32 v[54:55], v[54:55], v[242:243], v[240:241] op_sel_hi:[1,0,0]
    v_cvt_pk_bf16_f32 v52, v52, v53
    ds_read_b128 v[144:147], v11 offset:128
    s_barrier
    ds_read_b64_tr_b16 v[192:193], v2 offset:8192
    ds_read_b64_tr_b16 v[194:195], v2 offset:8704
    v_pk_fma_f32 v[196:197], v[196:197], v[242:243], v[240:241] op_sel_hi:[1,0,0]
    v_cvt_pk_bf16_f32 v53, v54, v55
    ds_read_b128 v[148:151], v11 offset:160
    v_pk_fma_f32 v[198:199], v[198:199], v[242:243], v[240:241] op_sel_hi:[1,0,0]
    v_cvt_pk_bf16_f32 v54, v196, v197
    ds_read_b128 v[152:155], v11 offset:192
    v_pk_fma_f32 v[56:57], v[56:57], v[242:243], v[240:241] op_sel_hi:[1,0,0]
    v_cvt_pk_bf16_f32 v55, v198, v199
    ds_read_b128 v[156:159], v11 offset:224
    ds_read_b64_tr_b16 v[196:197], v5 offset:8192
    ds_read_b64_tr_b16 v[198:199], v5 offset:8704
    v_pk_fma_f32 v[58:59], v[58:59], v[242:243], v[240:241] op_sel_hi:[1,0,0]
    v_cvt_pk_bf16_f32 v56, v56, v57
    v_pk_fma_f32 v[200:201], v[200:201], v[242:243], v[240:241] op_sel_hi:[1,0,0]
    v_cvt_pk_bf16_f32 v57, v58, v59
    v_pk_fma_f32 v[202:203], v[202:203], v[242:243], v[240:241] op_sel_hi:[1,0,0]
    v_cvt_pk_bf16_f32 v58, v200, v201
    v_pk_fma_f32 v[60:61], v[60:61], v[242:243], v[240:241] op_sel_hi:[1,0,0]
    v_cvt_pk_bf16_f32 v59, v202, v203
    ds_read_b64_tr_b16 v[200:201], v2 offset:10240
    ds_read_b64_tr_b16 v[202:203], v2 offset:10752
    v_pk_fma_f32 v[62:63], v[62:63], v[242:243], v[240:241] op_sel_hi:[1,0,0]
    v_cvt_pk_bf16_f32 v60, v60, v61
    v_pk_fma_f32 v[204:205], v[204:205], v[242:243], v[240:241] op_sel_hi:[1,0,0]
    v_cvt_pk_bf16_f32 v61, v62, v63
    v_pk_fma_f32 v[206:207], v[206:207], v[242:243], v[240:241] op_sel_hi:[1,0,0]
    v_cvt_pk_bf16_f32 v62, v204, v205
    v_cvt_pk_bf16_f32 v63, v206, v207
    ds_read_b64_tr_b16 v[204:205], v5 offset:10240
    ds_read_b64_tr_b16 v[206:207], v5 offset:10752
    s_waitcnt lgkmcnt(4)
    v_mfma_f32_32x32x16_bf16 v[128:143], v[192:195], v[16:19], v[128:143]
    ds_read_b64_tr_b16 v[192:193], v2 offset:12288
    ds_read_b64_tr_b16 v[194:195], v2 offset:12800
    v_mfma_f32_32x32x16_bf16 v[144:159], v[196:199], v[16:19], v[144:159]
    ds_read_b64_tr_b16 v[196:197], v5 offset:12288
    ds_read_b64_tr_b16 v[198:199], v5 offset:12800
    s_waitcnt lgkmcnt(4)
    v_mfma_f32_32x32x16_bf16 v[128:143], v[200:203], v[20:23], v[128:143]
    ds_read_b64_tr_b16 v[200:201], v2 offset:14336
    ds_read_b64_tr_b16 v[202:203], v2 offset:14848
    v_mfma_f32_32x32x16_bf16 v[144:159], v[204:207], v[20:23], v[144:159]
    ds_read_b64_tr_b16 v[204:205], v5 offset:14336
    ds_read_b64_tr_b16 v[206:207], v5 offset:14848
    s_waitcnt lgkmcnt(4)
    v_mfma_f32_32x32x16_bf16 v[128:143], v[192:195], v[24:27], v[128:143]
    ds_read_b64_tr_b16 v[192:193], v2 offset:16384
    ds_read_b64_tr_b16 v[194:195], v2 offset:16896
    v_mfma_f32_32x32x16_bf16 v[144:159], v[196:199], v[24:27], v[144:159]
    ds_read_b64_tr_b16 v[196:197], v5 offset:16384
    ds_read_b64_tr_b16 v[198:199], v5 offset:16896
    s_waitcnt lgkmcnt(4)
    v_mfma_f32_32x32x16_bf16 v[128:143], v[200:203], v[28:31], v[128:143]
    ds_read_b64_tr_b16 v[200:201], v2 offset:18432
    ds_read_b64_tr_b16 v[202:203], v2 offset:18944
    v_mfma_f32_32x32x16_bf16 v[144:159], v[204:207], v[28:31], v[144:159]
    ds_read_b64_tr_b16 v[204:205], v5 offset:18432
    ds_read_b64_tr_b16 v[206:207], v5 offset:18944
    s_waitcnt lgkmcnt(4)
    v_mfma_f32_32x32x16_bf16 v[128:143], v[192:195], v[32:35], v[128:143]
    ds_read_b64_tr_b16 v[192:193], v2 offset:20480
    ds_read_b64_tr_b16 v[194:195], v2 offset:20992
    v_mfma_f32_32x32x16_bf16 v[144:159], v[196:199], v[32:35], v[144:159]
    ds_read_b64_tr_b16 v[196:197], v5 offset:20480
    ds_read_b64_tr_b16 v[198:199], v5 offset:20992
    s_waitcnt lgkmcnt(4)
    v_mfma_f32_32x32x16_bf16 v[128:143], v[200:203], v[36:39], v[128:143]
    ds_read_b64_tr_b16 v[200:201], v2 offset:22528
    ds_read_b64_tr_b16 v[202:203], v2 offset:23040
    v_mfma_f32_32x32x16_bf16 v[144:159], v[204:207], v[36:39], v[144:159]
    ds_read_b64_tr_b16 v[204:205], v5 offset:22528
    ds_read_b64_tr_b16 v[206:207], v5 offset:23040
    s_waitcnt lgkmcnt(4)
    v_mfma_f32_32x32x16_bf16 v[128:143], v[192:195], v[40:43], v[128:143]
    ds_read_b64_tr_b16 v[192:193], v2 offset:24576
    ds_read_b64_tr_b16 v[194:195], v2 offset:25088
    v_mfma_f32_32x32x16_bf16 v[144:159], v[196:199], v[40:43], v[144:159]
    ds_read_b64_tr_b16 v[196:197], v5 offset:24576
    ds_read_b64_tr_b16 v[198:199], v5 offset:25088
    s_waitcnt lgkmcnt(4)
    v_mfma_f32_32x32x16_bf16 v[128:143], v[200:203], v[44:47], v[128:143]
    ds_read_b64_tr_b16 v[200:201], v2 offset:26624
    ds_read_b64_tr_b16 v[202:203], v2 offset:27136
    v_mfma_f32_32x32x16_bf16 v[144:159], v[204:207], v[44:47], v[144:159]
    ds_read_b64_tr_b16 v[204:205], v5 offset:26624
    ds_read_b64_tr_b16 v[206:207], v5 offset:27136
    s_waitcnt lgkmcnt(4)
    v_mfma_f32_32x32x16_bf16 v[128:143], v[192:195], v[48:51], v[128:143]
    ds_read_b64_tr_b16 v[192:193], v2 offset:28672
    ds_read_b64_tr_b16 v[194:195], v2 offset:29184
    v_mfma_f32_32x32x16_bf16 v[144:159], v[196:199], v[48:51], v[144:159]
    ds_read_b64_tr_b16 v[196:197], v5 offset:28672
    ds_read_b64_tr_b16 v[198:199], v5 offset:29184
    s_waitcnt lgkmcnt(4)
    v_mfma_f32_32x32x16_bf16 v[128:143], v[200:203], v[52:55], v[128:143]
    ds_read_b64_tr_b16 v[200:201], v2 offset:30720
    ds_read_b64_tr_b16 v[202:203], v2 offset:31232
    v_mfma_f32_32x32x16_bf16 v[144:159], v[204:207], v[52:55], v[144:159]
    ds_read_b64_tr_b16 v[204:205], v5 offset:30720
    ds_read_b64_tr_b16 v[206:207], v5 offset:31232
    v_lshlrev_b32 v64, 16, v208
    v_and_b32 v65, s74, v208
    v_lshlrev_b32 v66, 16, v209
    v_and_b32 v67, s74, v209
    v_lshlrev_b32 v208, 16, v210
    v_and_b32 v209, s74, v210
    v_lshlrev_b32 v210, 16, v211
    v_and_b32 v211, s74, v211
    v_lshlrev_b32 v68, 16, v212
    v_and_b32 v69, s74, v212
    v_lshlrev_b32 v70, 16, v213
    v_and_b32 v71, s74, v213
    v_lshlrev_b32 v212, 16, v214
    v_and_b32 v213, s74, v214
    v_lshlrev_b32 v214, 16, v215
    v_and_b32 v215, s74, v215
    v_lshlrev_b32 v72, 16, v216
    v_and_b32 v73, s74, v216
    v_lshlrev_b32 v74, 16, v217
    v_and_b32 v75, s74, v217
    v_lshlrev_b32 v216, 16, v218
    v_and_b32 v217, s74, v218
    v_lshlrev_b32 v218, 16, v219
    v_and_b32 v219, s74, v219
    v_lshlrev_b32 v76, 16, v220
    v_and_b32 v77, s74, v220
    v_lshlrev_b32 v78, 16, v221
    v_and_b32 v79, s74, v221
    v_lshlrev_b32 v220, 16, v222
    v_and_b32 v221, s74, v222
    v_lshlrev_b32 v222, 16, v223
    v_and_b32 v223, s74, v223
    v_lshlrev_b32 v80, 16, v224
    v_and_b32 v81, s74, v224
    v_lshlrev_b32 v82, 16, v225
    v_and_b32 v83, s74, v225
    v_lshlrev_b32 v224, 16, v226
    v_and_b32 v225, s74, v226
    v_lshlrev_b32 v226, 16, v227
    v_and_b32 v227, s74, v227
    v_lshlrev_b32 v84, 16, v228
    v_and_b32 v85, s74, v228
    v_lshlrev_b32 v86, 16, v229
    v_and_b32 v87, s74, v229
    v_lshlrev_b32 v228, 16, v230
    v_and_b32 v229, s74, v230
    v_lshlrev_b32 v230, 16, v231
    v_and_b32 v231, s74, v231
    v_lshlrev_b32 v88, 16, v232
    v_and_b32 v89, s74, v232
    v_lshlrev_b32 v90, 16, v233
    v_and_b32 v91, s74, v233
    v_lshlrev_b32 v232, 16, v234
    v_and_b32 v233, s74, v234
    v_lshlrev_b32 v234, 16, v235
    v_and_b32 v235, s74, v235
    v_lshlrev_b32 v92, 16, v236
    v_and_b32 v93, s74, v236
    v_lshlrev_b32 v94, 16, v237
    v_and_b32 v95, s74, v237
    v_lshlrev_b32 v236, 16, v238
    v_and_b32 v237, s74, v238
    v_lshlrev_b32 v238, 16, v239
    v_and_b32 v239, s74, v239
    v_pk_fma_f32 v[64:65], v[64:65], v[242:243], v[240:241] op_sel_hi:[1,0,0]
    v_pk_fma_f32 v[66:67], v[66:67], v[242:243], v[240:241] op_sel_hi:[1,0,0]
    v_cvt_pk_bf16_f32 v64, v64, v65
    v_pk_fma_f32 v[208:209], v[208:209], v[242:243], v[240:241] op_sel_hi:[1,0,0]
    v_cvt_pk_bf16_f32 v65, v66, v67
    v_pk_fma_f32 v[210:211], v[210:211], v[242:243], v[240:241] op_sel_hi:[1,0,0]
    v_cvt_pk_bf16_f32 v66, v208, v209
    v_pk_fma_f32 v[68:69], v[68:69], v[242:243], v[240:241] op_sel_hi:[1,0,0]
    v_cvt_pk_bf16_f32 v67, v210, v211
    v_pk_fma_f32 v[70:71], v[70:71], v[242:243], v[240:241] op_sel_hi:[1,0,0]
    v_cvt_pk_bf16_f32 v68, v68, v69
    v_pk_fma_f32 v[212:213], v[212:213], v[242:243], v[240:241] op_sel_hi:[1,0,0]
    v_cvt_pk_bf16_f32 v69, v70, v71
    v_pk_fma_f32 v[214:215], v[214:215], v[242:243], v[240:241] op_sel_hi:[1,0,0]
    v_cvt_pk_bf16_f32 v70, v212, v213
    v_pk_fma_f32 v[72:73], v[72:73], v[242:243], v[240:241] op_sel_hi:[1,0,0]
    v_cvt_pk_bf16_f32 v71, v214, v215
    v_pk_fma_f32 v[74:75], v[74:75], v[242:243], v[240:241] op_sel_hi:[1,0,0]
    v_cvt_pk_bf16_f32 v72, v72, v73
    v_pk_fma_f32 v[216:217], v[216:217], v[242:243], v[240:241] op_sel_hi:[1,0,0]
    v_cvt_pk_bf16_f32 v73, v74, v75
    v_pk_fma_f32 v[218:219], v[218:219], v[242:243], v[240:241] op_sel_hi:[1,0,0]
    v_cvt_pk_bf16_f32 v74, v216, v217
    v_pk_fma_f32 v[76:77], v[76:77], v[242:243], v[240:241] op_sel_hi:[1,0,0]
    v_cvt_pk_bf16_f32 v75, v218, v219
    v_pk_fma_f32 v[78:79], v[78:79], v[242:243], v[240:241] op_sel_hi:[1,0,0]
    v_cvt_pk_bf16_f32 v76, v76, v77
    v_pk_fma_f32 v[220:221], v[220:221], v[242:243], v[240:241] op_sel_hi:[1,0,0]
    v_cvt_pk_bf16_f32 v77, v78, v79
    v_pk_fma_f32 v[222:223], v[222:223], v[242:243], v[240:241] op_sel_hi:[1,0,0]
    v_cvt_pk_bf16_f32 v78, v220, v221
    v_pk_fma_f32 v[80:81], v[80:81], v[242:243], v[240:241] op_sel_hi:[1,0,0]
    v_cvt_pk_bf16_f32 v79, v222, v223
    v_pk_fma_f32 v[82:83], v[82:83], v[242:243], v[240:241] op_sel_hi:[1,0,0]
    v_cvt_pk_bf16_f32 v80, v80, v81
    v_pk_fma_f32 v[224:225], v[224:225], v[242:243], v[240:241] op_sel_hi:[1,0,0]
    v_cvt_pk_bf16_f32 v81, v82, v83
    v_pk_fma_f32 v[226:227], v[226:227], v[242:243], v[240:241] op_sel_hi:[1,0,0]
    v_cvt_pk_bf16_f32 v82, v224, v225
    v_pk_fma_f32 v[84:85], v[84:85], v[242:243], v[240:241] op_sel_hi:[1,0,0]
    v_cvt_pk_bf16_f32 v83, v226, v227
    v_pk_fma_f32 v[86:87], v[86:87], v[242:243], v[240:241] op_sel_hi:[1,0,0]
    v_cvt_pk_bf16_f32 v84, v84, v85
    v_pk_fma_f32 v[228:229], v[228:229], v[242:243], v[240:241] op_sel_hi:[1,0,0]
    v_cvt_pk_bf16_f32 v85, v86, v87
    v_pk_fma_f32 v[230:231], v[230:231], v[242:243], v[240:241] op_sel_hi:[1,0,0]
    v_cvt_pk_bf16_f32 v86, v228, v229
    v_pk_fma_f32 v[88:89], v[88:89], v[242:243], v[240:241] op_sel_hi:[1,0,0]
    v_cvt_pk_bf16_f32 v87, v230, v231
    v_pk_fma_f32 v[90:91], v[90:91], v[242:243], v[240:241] op_sel_hi:[1,0,0]
    v_cvt_pk_bf16_f32 v88, v88, v89
    v_pk_fma_f32 v[232:233], v[232:233], v[242:243], v[240:241] op_sel_hi:[1,0,0]
    v_cvt_pk_bf16_f32 v89, v90, v91
    v_pk_fma_f32 v[234:235], v[234:235], v[242:243], v[240:241] op_sel_hi:[1,0,0]
    v_cvt_pk_bf16_f32 v90, v232, v233
    v_pk_fma_f32 v[92:93], v[92:93], v[242:243], v[240:241] op_sel_hi:[1,0,0]
    v_cvt_pk_bf16_f32 v91, v234, v235
    v_pk_fma_f32 v[94:95], v[94:95], v[242:243], v[240:241] op_sel_hi:[1,0,0]
    v_cvt_pk_bf16_f32 v92, v92, v93
    v_pk_fma_f32 v[236:237], v[236:237], v[242:243], v[240:241] op_sel_hi:[1,0,0]
    v_cvt_pk_bf16_f32 v93, v94, v95
    v_pk_fma_f32 v[238:239], v[238:239], v[242:243], v[240:241] op_sel_hi:[1,0,0]
    v_cvt_pk_bf16_f32 v94, v236, v237
    v_cvt_pk_bf16_f32 v95, v238, v239
    s_waitcnt lgkmcnt(4)
    v_mfma_f32_32x32x16_bf16 v[128:143], v[192:195], v[56:59], v[128:143]
    s_barrier
    ds_read_b64_tr_b16 v[192:193], v2 offset:32768
    ds_read_b64_tr_b16 v[194:195], v2 offset:33280
    v_mfma_f32_32x32x16_bf16 v[144:159], v[196:199], v[56:59], v[144:159]
    ds_read_b64_tr_b16 v[196:197], v5 offset:32768
    ds_read_b64_tr_b16 v[198:199], v5 offset:33280
    s_waitcnt lgkmcnt(4)
    v_mfma_f32_32x32x16_bf16 v[128:143], v[200:203], v[60:63], v[128:143]
    ds_read_b64_tr_b16 v[200:201], v2 offset:34816
    ds_read_b64_tr_b16 v[202:203], v2 offset:35328
    v_mfma_f32_32x32x16_bf16 v[144:159], v[204:207], v[60:63], v[144:159]
    ds_read_b64_tr_b16 v[204:205], v5 offset:34816
    ds_read_b64_tr_b16 v[206:207], v5 offset:35328
    s_waitcnt lgkmcnt(0)
    v_mfma_f32_32x32x16_bf16 v[128:143], v[192:195], v[64:67], v[128:143]
    ds_read_b64_tr_b16 v[192:193], v2 offset:36864
    ds_read_b64_tr_b16 v[194:195], v2 offset:37376
    v_mfma_f32_32x32x16_bf16 v[144:159], v[196:199], v[64:67], v[144:159]
    ds_read_b64_tr_b16 v[196:197], v5 offset:36864
    ds_read_b64_tr_b16 v[198:199], v5 offset:37376
    s_waitcnt lgkmcnt(0)
    v_mfma_f32_32x32x16_bf16 v[128:143], v[200:203], v[68:71], v[128:143]
    ds_read_b64_tr_b16 v[200:201], v2 offset:38912
    ds_read_b64_tr_b16 v[202:203], v2 offset:39424
    v_mfma_f32_32x32x16_bf16 v[144:159], v[204:207], v[68:71], v[144:159]
    ds_read_b64_tr_b16 v[204:205], v5 offset:38912
    ds_read_b64_tr_b16 v[206:207], v5 offset:39424
    s_waitcnt lgkmcnt(0)
    v_mfma_f32_32x32x16_bf16 v[128:143], v[192:195], v[72:75], v[128:143]
    ds_read_b64_tr_b16 v[192:193], v2 offset:40960
    ds_read_b64_tr_b16 v[194:195], v2 offset:41472
    v_mfma_f32_32x32x16_bf16 v[144:159], v[196:199], v[72:75], v[144:159]
    ds_read_b64_tr_b16 v[196:197], v5 offset:40960
    ds_read_b64_tr_b16 v[198:199], v5 offset:41472
    s_waitcnt lgkmcnt(0)
    v_mfma_f32_32x32x16_bf16 v[128:143], v[200:203], v[76:79], v[128:143]
    ds_read_b64_tr_b16 v[200:201], v2 offset:43008
    ds_read_b64_tr_b16 v[202:203], v2 offset:43520
    v_mfma_f32_32x32x16_bf16 v[144:159], v[204:207], v[76:79], v[144:159]
    ds_read_b64_tr_b16 v[204:205], v5 offset:43008
    ds_read_b64_tr_b16 v[206:207], v5 offset:43520
    s_waitcnt lgkmcnt(0)
    v_mfma_f32_32x32x16_bf16 v[128:143], v[192:195], v[80:83], v[128:143]
    ds_read_b64_tr_b16 v[192:193], v2 offset:45056
    ds_read_b64_tr_b16 v[194:195], v2 offset:45568
    v_mfma_f32_32x32x16_bf16 v[144:159], v[196:199], v[80:83], v[144:159]
    ds_read_b64_tr_b16 v[196:197], v5 offset:45056
    ds_read_b64_tr_b16 v[198:199], v5 offset:45568
    s_waitcnt lgkmcnt(0)
    v_mfma_f32_32x32x16_bf16 v[128:143], v[200:203], v[84:87], v[128:143]
    ds_read_b64_tr_b16 v[200:201], v2 offset:47104
    ds_read_b64_tr_b16 v[202:203], v2 offset:47616
    v_mfma_f32_32x32x16_bf16 v[144:159], v[204:207], v[84:87], v[144:159]
    ds_read_b64_tr_b16 v[204:205], v5 offset:47104
    ds_read_b64_tr_b16 v[206:207], v5 offset:47616
    v_lshlrev_b32 v96, 16, v160
    v_and_b32 v97, s74, v160
    v_lshlrev_b32 v98, 16, v161
    v_and_b32 v99, s74, v161
    v_lshlrev_b32 v160, 16, v162
    v_and_b32 v161, s74, v162
    v_lshlrev_b32 v162, 16, v163
    v_and_b32 v163, s74, v163
    v_lshlrev_b32 v100, 16, v164
    v_and_b32 v101, s74, v164
    v_lshlrev_b32 v102, 16, v165
    v_and_b32 v103, s74, v165
    v_lshlrev_b32 v164, 16, v166
    v_and_b32 v165, s74, v166
    v_lshlrev_b32 v166, 16, v167
    v_and_b32 v167, s74, v167
    v_lshlrev_b32 v104, 16, v168
    v_and_b32 v105, s74, v168
    v_lshlrev_b32 v106, 16, v169
    v_and_b32 v107, s74, v169
    v_lshlrev_b32 v168, 16, v170
    v_and_b32 v169, s74, v170
    v_lshlrev_b32 v170, 16, v171
    v_and_b32 v171, s74, v171
    v_lshlrev_b32 v108, 16, v172
    v_and_b32 v109, s74, v172
    v_lshlrev_b32 v110, 16, v173
    v_and_b32 v111, s74, v173
    v_lshlrev_b32 v172, 16, v174
    v_and_b32 v173, s74, v174
    v_lshlrev_b32 v174, 16, v175
    v_and_b32 v175, s74, v175
    v_pk_fma_f32 v[96:97], v[96:97], v[242:243], v[240:241] op_sel_hi:[1,0,0]
    v_pk_fma_f32 v[98:99], v[98:99], v[242:243], v[240:241] op_sel_hi:[1,0,0]
    v_cvt_pk_bf16_f32 v96, v96, v97
    v_pk_fma_f32 v[160:161], v[160:161], v[242:243], v[240:241] op_sel_hi:[1,0,0]
    v_cvt_pk_bf16_f32 v97, v98, v99
    v_pk_fma_f32 v[162:163], v[162:163], v[242:243], v[240:241] op_sel_hi:[1,0,0]
    v_cvt_pk_bf16_f32 v98, v160, v161
    v_pk_fma_f32 v[100:101], v[100:101], v[242:243], v[240:241] op_sel_hi:[1,0,0]
    v_cvt_pk_bf16_f32 v99, v162, v163
    v_pk_fma_f32 v[102:103], v[102:103], v[242:243], v[240:241] op_sel_hi:[1,0,0]
    v_cvt_pk_bf16_f32 v100, v100, v101
    v_pk_fma_f32 v[164:165], v[164:165], v[242:243], v[240:241] op_sel_hi:[1,0,0]
    v_cvt_pk_bf16_f32 v101, v102, v103
    v_pk_fma_f32 v[166:167], v[166:167], v[242:243], v[240:241] op_sel_hi:[1,0,0]
    v_cvt_pk_bf16_f32 v102, v164, v165
    v_pk_fma_f32 v[104:105], v[104:105], v[242:243], v[240:241] op_sel_hi:[1,0,0]
    v_cvt_pk_bf16_f32 v103, v166, v167
    v_pk_fma_f32 v[106:107], v[106:107], v[242:243], v[240:241] op_sel_hi:[1,0,0]
    v_cvt_pk_bf16_f32 v104, v104, v105
    v_pk_fma_f32 v[168:169], v[168:169], v[242:243], v[240:241] op_sel_hi:[1,0,0]
    v_cvt_pk_bf16_f32 v105, v106, v107
    v_pk_fma_f32 v[170:171], v[170:171], v[242:243], v[240:241] op_sel_hi:[1,0,0]
    v_cvt_pk_bf16_f32 v106, v168, v169
    v_pk_fma_f32 v[108:109], v[108:109], v[242:243], v[240:241] op_sel_hi:[1,0,0]
    v_cvt_pk_bf16_f32 v107, v170, v171
    v_pk_fma_f32 v[110:111], v[110:111], v[242:243], v[240:241] op_sel_hi:[1,0,0]
    v_cvt_pk_bf16_f32 v108, v108, v109
    v_pk_fma_f32 v[172:173], v[172:173], v[242:243], v[240:241] op_sel_hi:[1,0,0]
    v_cvt_pk_bf16_f32 v109, v110, v111
    v_pk_fma_f32 v[174:175], v[174:175], v[242:243], v[240:241] op_sel_hi:[1,0,0]
    v_cvt_pk_bf16_f32 v110, v172, v173
    v_cvt_pk_bf16_f32 v111, v174, v175
    s_waitcnt lgkmcnt(0)
    v_mfma_f32_32x32x16_bf16 v[128:143], v[192:195], v[88:91], v[128:143]
    ds_read_b64_tr_b16 v[192:193], v2 offset:49152
    ds_read_b64_tr_b16 v[194:195], v2 offset:49664
    v_mfma_f32_32x32x16_bf16 v[144:159], v[196:199], v[88:91], v[144:159]
    ds_read_b64_tr_b16 v[196:197], v5 offset:49152
    ds_read_b64_tr_b16 v[198:199], v5 offset:49664
    s_waitcnt lgkmcnt(0)
    v_mfma_f32_32x32x16_bf16 v[128:143], v[200:203], v[92:95], v[128:143]
    ds_read_b64_tr_b16 v[200:201], v2 offset:51200
    ds_read_b64_tr_b16 v[202:203], v2 offset:51712
    v_mfma_f32_32x32x16_bf16 v[144:159], v[204:207], v[92:95], v[144:159]
    ds_read_b64_tr_b16 v[204:205], v5 offset:51200
    ds_read_b64_tr_b16 v[206:207], v5 offset:51712
    s_waitcnt lgkmcnt(0)
    v_mfma_f32_32x32x16_bf16 v[128:143], v[192:195], v[96:99], v[128:143]
    ds_read_b64_tr_b16 v[192:193], v2 offset:53248
    ds_read_b64_tr_b16 v[194:195], v2 offset:53760
    v_mfma_f32_32x32x16_bf16 v[144:159], v[196:199], v[96:99], v[144:159]
    ds_read_b64_tr_b16 v[196:197], v5 offset:53248
    ds_read_b64_tr_b16 v[198:199], v5 offset:53760
    s_waitcnt lgkmcnt(0)
    v_mfma_f32_32x32x16_bf16 v[128:143], v[200:203], v[100:103], v[128:143]
    ds_read_b64_tr_b16 v[200:201], v2 offset:55296
    ds_read_b64_tr_b16 v[202:203], v2 offset:55808
    v_mfma_f32_32x32x16_bf16 v[144:159], v[204:207], v[100:103], v[144:159]
    ds_read_b64_tr_b16 v[204:205], v5 offset:55296
    ds_read_b64_tr_b16 v[206:207], v5 offset:55808
    v_lshlrev_b32 v112, 16, v176
    v_and_b32 v113, s74, v176
    v_lshlrev_b32 v114, 16, v177
    v_and_b32 v115, s74, v177
    v_lshlrev_b32 v176, 16, v178
    v_and_b32 v177, s74, v178
    v_lshlrev_b32 v178, 16, v179
    v_and_b32 v179, s74, v179
    v_lshlrev_b32 v116, 16, v180
    v_and_b32 v117, s74, v180
    v_lshlrev_b32 v118, 16, v181
    v_and_b32 v119, s74, v181
    v_lshlrev_b32 v180, 16, v182
    v_and_b32 v181, s74, v182
    v_lshlrev_b32 v182, 16, v183
    v_and_b32 v183, s74, v183
    v_lshlrev_b32 v120, 16, v184
    v_and_b32 v121, s74, v184
    v_lshlrev_b32 v122, 16, v185
    v_and_b32 v123, s74, v185
    v_lshlrev_b32 v184, 16, v186
    v_and_b32 v185, s74, v186
    v_lshlrev_b32 v186, 16, v187
    v_and_b32 v187, s74, v187
    v_lshlrev_b32 v124, 16, v188
    v_and_b32 v125, s74, v188
    v_lshlrev_b32 v126, 16, v189
    v_and_b32 v127, s74, v189
    v_lshlrev_b32 v188, 16, v190
    v_and_b32 v189, s74, v190
    v_lshlrev_b32 v190, 16, v191
    v_and_b32 v191, s74, v191
    v_pk_fma_f32 v[112:113], v[112:113], v[242:243], v[240:241] op_sel_hi:[1,0,0]
    v_pk_fma_f32 v[114:115], v[114:115], v[242:243], v[240:241] op_sel_hi:[1,0,0]
    v_cvt_pk_bf16_f32 v112, v112, v113
    v_pk_fma_f32 v[176:177], v[176:177], v[242:243], v[240:241] op_sel_hi:[1,0,0]
    v_cvt_pk_bf16_f32 v113, v114, v115
    v_pk_fma_f32 v[178:179], v[178:179], v[242:243], v[240:241] op_sel_hi:[1,0,0]
    v_cvt_pk_bf16_f32 v114, v176, v177
    v_pk_fma_f32 v[116:117], v[116:117], v[242:243], v[240:241] op_sel_hi:[1,0,0]
    v_cvt_pk_bf16_f32 v115, v178, v179
    v_pk_fma_f32 v[118:119], v[118:119], v[242:243], v[240:241] op_sel_hi:[1,0,0]
    v_cvt_pk_bf16_f32 v116, v116, v117
    v_pk_fma_f32 v[180:181], v[180:181], v[242:243], v[240:241] op_sel_hi:[1,0,0]
    v_cvt_pk_bf16_f32 v117, v118, v119
    v_pk_fma_f32 v[182:183], v[182:183], v[242:243], v[240:241] op_sel_hi:[1,0,0]
    v_cvt_pk_bf16_f32 v118, v180, v181
    v_pk_fma_f32 v[120:121], v[120:121], v[242:243], v[240:241] op_sel_hi:[1,0,0]
    v_cvt_pk_bf16_f32 v119, v182, v183
    v_pk_fma_f32 v[122:123], v[122:123], v[242:243], v[240:241] op_sel_hi:[1,0,0]
    v_cvt_pk_bf16_f32 v120, v120, v121
    v_pk_fma_f32 v[184:185], v[184:185], v[242:243], v[240:241] op_sel_hi:[1,0,0]
    v_cvt_pk_bf16_f32 v121, v122, v123
    v_pk_fma_f32 v[186:187], v[186:187], v[242:243], v[240:241] op_sel_hi:[1,0,0]
    v_cvt_pk_bf16_f32 v122, v184, v185
    v_pk_fma_f32 v[124:125], v[124:125], v[242:243], v[240:241] op_sel_hi:[1,0,0]
    v_cvt_pk_bf16_f32 v123, v186, v187
    v_pk_fma_f32 v[126:127], v[126:127], v[242:243], v[240:241] op_sel_hi:[1,0,0]
    v_cvt_pk_bf16_f32 v124, v124, v125
    v_pk_fma_f32 v[188:189], v[188:189], v[242:243], v[240:241] op_sel_hi:[1,0,0]
    v_cvt_pk_bf16_f32 v125, v126, v127
    v_pk_fma_f32 v[190:191], v[190:191], v[242:243], v[240:241] op_sel_hi:[1,0,0]
    v_cvt_pk_bf16_f32 v126, v188, v189
    v_cvt_pk_bf16_f32 v127, v190, v191
    s_waitcnt lgkmcnt(0)
    v_mfma_f32_32x32x16_bf16 v[128:143], v[192:195], v[104:107], v[128:143]
    s_barrier
    ds_read_b64_tr_b16 v[192:193], v2 offset:57344
    ds_read_b64_tr_b16 v[194:195], v2 offset:57856
    v_mfma_f32_32x32x16_bf16 v[144:159], v[196:199], v[104:107], v[144:159]
    ds_read_b64_tr_b16 v[196:197], v5 offset:57344
    ds_read_b64_tr_b16 v[198:199], v5 offset:57856
    s_waitcnt lgkmcnt(0)
    v_mfma_f32_32x32x16_bf16 v[128:143], v[200:203], v[108:111], v[128:143]
    ds_read_b64_tr_b16 v[200:201], v2 offset:59392
    ds_read_b64_tr_b16 v[202:203], v2 offset:59904
    v_mfma_f32_32x32x16_bf16 v[144:159], v[204:207], v[108:111], v[144:159]
    ds_read_b64_tr_b16 v[204:205], v5 offset:59392
    ds_read_b64_tr_b16 v[206:207], v5 offset:59904
    s_waitcnt lgkmcnt(0)
    v_mfma_f32_32x32x16_bf16 v[128:143], v[192:195], v[112:115], v[128:143]
    ds_read_b64_tr_b16 v[192:193], v2 offset:61440
    ds_read_b64_tr_b16 v[194:195], v2 offset:61952
    ds_read_b128 v[160:163], v11 offset:256
    ds_read_b128 v[164:167], v11 offset:288
    v_mfma_f32_32x32x16_bf16 v[144:159], v[196:199], v[112:115], v[144:159]
    ds_read_b64_tr_b16 v[196:197], v5 offset:61440
    ds_read_b64_tr_b16 v[198:199], v5 offset:61952
    ds_read_b128 v[168:171], v11 offset:320
    ds_read_b128 v[172:175], v11 offset:352
    s_waitcnt lgkmcnt(2)
    v_mfma_f32_32x32x16_bf16 v[128:143], v[200:203], v[116:119], v[128:143]
    ds_read_b64_tr_b16 v[200:201], v2 offset:63488
    ds_read_b64_tr_b16 v[202:203], v2 offset:64000
    ds_read_b128 v[176:179], v11 offset:384
    ds_read_b128 v[180:183], v11 offset:416
    v_mfma_f32_32x32x16_bf16 v[144:159], v[204:207], v[116:119], v[144:159]
    ds_read_b64_tr_b16 v[204:205], v5 offset:63488
    ds_read_b64_tr_b16 v[206:207], v5 offset:64000
    ds_read_b128 v[184:187], v11 offset:448
    ds_read_b128 v[188:191], v11 offset:480
    s_waitcnt lgkmcnt(2)
    v_mfma_f32_32x32x16_bf16 v[128:143], v[192:195], v[120:123], v[128:143]
    ds_read_b64_tr_b16 v[192:193], v3 offset:0
    ds_read_b64_tr_b16 v[194:195], v3 offset:512
    v_mfma_f32_32x32x16_bf16 v[144:159], v[196:199], v[120:123], v[144:159]
    ds_read_b64_tr_b16 v[196:197], v6 offset:0
    ds_read_b64_tr_b16 v[198:199], v6 offset:512
    s_waitcnt lgkmcnt(0)
    v_mfma_f32_32x32x16_bf16 v[128:143], v[200:203], v[124:127], v[128:143]
    ds_read_b64_tr_b16 v[200:201], v3 offset:2048
    ds_read_b64_tr_b16 v[202:203], v3 offset:2560
    v_mfma_f32_32x32x16_bf16 v[144:159], v[204:207], v[124:127], v[144:159]
    ds_read_b64_tr_b16 v[204:205], v6 offset:2048
    ds_read_b64_tr_b16 v[206:207], v6 offset:2560
    v_mfma_f32_32x32x16_bf16 v[160:175], v[192:195], v[16:19], v[160:175]
    ds_read_b64_tr_b16 v[192:193], v3 offset:4096
    ds_read_b64_tr_b16 v[194:195], v3 offset:4608
    v_mfma_f32_32x32x16_bf16 v[176:191], v[196:199], v[16:19], v[176:191]
    ds_read_b64_tr_b16 v[196:197], v6 offset:4096
    ds_read_b64_tr_b16 v[198:199], v6 offset:4608
    s_waitcnt lgkmcnt(4)
    v_mfma_f32_32x32x16_bf16 v[160:175], v[200:203], v[20:23], v[160:175]
    v_fma_f32 v216, -v128, v128, s72
    v_fma_f32 v217, -v129, v129, s72
    v_fma_f32 v218, -v130, v130, s72
    v_fma_f32 v219, -v131, v131, s72
    v_mul_f32 v216, v128, v216
    v_mul_f32 v217, v129, v217
    v_mul_f32 v218, v130, v218
    v_mul_f32 v219, v131, v219
    v_mfma_f32_32x32x16_bf16 v[176:191], v[204:207], v[20:23], v[176:191]
    ds_read_b64_tr_b16 v[200:201], v3 offset:6144
    ds_read_b64_tr_b16 v[202:203], v3 offset:6656
    ds_read_b64_tr_b16 v[204:205], v6 offset:6144
    ds_read_b64_tr_b16 v[206:207], v6 offset:6656
    v_exp_f32 v216, v216
    v_exp_f32 v217, v217
    s_waitcnt lgkmcnt(4)
    v_mfma_f32_32x32x16_bf16 v[160:175], v[192:195], v[24:27], v[160:175]
    v_exp_f32 v218, v218
    v_exp_f32 v219, v219
    v_add_f32 v216, 1.0, v216
    v_add_f32 v217, 1.0, v217
    v_add_f32 v218, 1.0, v218
    v_mfma_f32_32x32x16_bf16 v[176:191], v[196:199], v[24:27], v[176:191]
    ds_read_b64_tr_b16 v[192:193], v3 offset:8192
    ds_read_b64_tr_b16 v[194:195], v3 offset:8704
    ds_read_b64_tr_b16 v[196:197], v6 offset:8192
    ds_read_b64_tr_b16 v[198:199], v6 offset:8704
    v_add_f32 v219, 1.0, v219
    v_rcp_f32 v216, v216
    s_waitcnt lgkmcnt(4)
    v_mfma_f32_32x32x16_bf16 v[160:175], v[200:203], v[28:31], v[160:175]
    v_rcp_f32 v217, v217
    v_rcp_f32 v218, v218
    v_rcp_f32 v219, v219
    v_mul_f32 v216, v128, v216
    v_mul_f32 v217, v129, v217
    v_mfma_f32_32x32x16_bf16 v[176:191], v[204:207], v[28:31], v[176:191]
    ds_read_b64_tr_b16 v[200:201], v3 offset:10240
    ds_read_b64_tr_b16 v[202:203], v3 offset:10752
    ds_read_b64_tr_b16 v[204:205], v6 offset:10240
    ds_read_b64_tr_b16 v[206:207], v6 offset:10752
    v_mul_f32 v218, v130, v218
    v_mul_f32 v219, v131, v219
    v_cvt_pk_bf16_f32 v224, v216, v217
    v_cvt_pk_bf16_f32 v225, v218, v219
    s_waitcnt lgkmcnt(4)
    v_mfma_f32_32x32x16_bf16 v[160:175], v[192:195], v[32:35], v[160:175]
    v_fma_f32 v216, -v132, v132, s72
    v_fma_f32 v217, -v133, v133, s72
    v_fma_f32 v218, -v134, v134, s72
    v_fma_f32 v219, -v135, v135, s72
    v_mul_f32 v216, v132, v216
    v_mul_f32 v217, v133, v217
    v_mul_f32 v218, v134, v218
    v_mfma_f32_32x32x16_bf16 v[176:191], v[196:199], v[32:35], v[176:191]
    ds_read_b64_tr_b16 v[192:193], v3 offset:12288
    ds_read_b64_tr_b16 v[194:195], v3 offset:12800
    ds_read_b64_tr_b16 v[196:197], v6 offset:12288
    ds_read_b64_tr_b16 v[198:199], v6 offset:12800
    ds_read_b128 v[128:131], v11 offset:512
    v_mul_f32 v219, v135, v219
    v_exp_f32 v216, v216
    s_waitcnt lgkmcnt(5)
    v_mfma_f32_32x32x16_bf16 v[160:175], v[200:203], v[36:39], v[160:175]
    v_exp_f32 v217, v217
    v_exp_f32 v218, v218
    v_exp_f32 v219, v219
    v_add_f32 v216, 1.0, v216
    v_add_f32 v217, 1.0, v217
    v_add_f32 v218, 1.0, v218
    v_mfma_f32_32x32x16_bf16 v[176:191], v[204:207], v[36:39], v[176:191]
    ds_read_b64_tr_b16 v[200:201], v3 offset:14336
    ds_read_b64_tr_b16 v[202:203], v3 offset:14848
    ds_read_b64_tr_b16 v[204:205], v6 offset:14336
    ds_read_b64_tr_b16 v[206:207], v6 offset:14848
    v_add_f32 v219, 1.0, v219
    v_rcp_f32 v216, v216
    s_waitcnt lgkmcnt(5)
    v_mfma_f32_32x32x16_bf16 v[160:175], v[192:195], v[40:43], v[160:175]
    v_rcp_f32 v217, v217
    v_rcp_f32 v218, v218
    v_rcp_f32 v219, v219
    v_mul_f32 v216, v132, v216
    v_mul_f32 v217, v133, v217
    v_mfma_f32_32x32x16_bf16 v[176:191], v[196:199], v[40:43], v[176:191]
    ds_read_b64_tr_b16 v[192:193], v3 offset:16384
    ds_read_b64_tr_b16 v[194:195], v3 offset:16896
    ds_read_b64_tr_b16 v[196:197], v6 offset:16384
    ds_read_b64_tr_b16 v[198:199], v6 offset:16896
    v_mul_f32 v218, v134, v218
    v_mul_f32 v219, v135, v219
    v_cvt_pk_bf16_f32 v226, v216, v217
    s_waitcnt lgkmcnt(4)
    v_mfma_f32_32x32x16_bf16 v[160:175], v[200:203], v[44:47], v[160:175]
    v_cvt_pk_bf16_f32 v227, v218, v219
    buffer_store_dwordx4 v[224:227], v1, s[20:23], s36 offen sc1
    v_fma_f32 v216, -v136, v136, s72
    v_fma_f32 v217, -v137, v137, s72
    v_fma_f32 v218, -v138, v138, s72
    v_fma_f32 v219, -v139, v139, s72
    v_mul_f32 v216, v136, v216
    v_mfma_f32_32x32x16_bf16 v[176:191], v[204:207], v[44:47], v[176:191]
    ds_read_b64_tr_b16 v[200:201], v3 offset:18432
    ds_read_b64_tr_b16 v[202:203], v3 offset:18944
    ds_read_b64_tr_b16 v[204:205], v6 offset:18432
    ds_read_b64_tr_b16 v[206:207], v6 offset:18944
    ds_read_b128 v[132:135], v11 offset:544
    v_mul_f32 v217, v137, v217
    v_mul_f32 v218, v138, v218
    v_mul_f32 v219, v139, v219
    s_waitcnt lgkmcnt(5)
    v_mfma_f32_32x32x16_bf16 v[160:175], v[192:195], v[48:51], v[160:175]
    v_exp_f32 v216, v216
    v_exp_f32 v217, v217
    v_exp_f32 v218, v218
    v_exp_f32 v219, v219
    v_mfma_f32_32x32x16_bf16 v[176:191], v[196:199], v[48:51], v[176:191]
    ds_read_b64_tr_b16 v[192:193], v3 offset:20480
    ds_read_b64_tr_b16 v[194:195], v3 offset:20992
    ds_read_b64_tr_b16 v[196:197], v6 offset:20480
    ds_read_b64_tr_b16 v[198:199], v6 offset:20992
    v_add_f32 v216, 1.0, v216
    v_add_f32 v217, 1.0, v217
    v_add_f32 v218, 1.0, v218
    v_add_f32 v219, 1.0, v219
    s_waitcnt lgkmcnt(5)
    v_mfma_f32_32x32x16_bf16 v[160:175], v[200:203], v[52:55], v[160:175]
    v_rcp_f32 v216, v216
    v_rcp_f32 v217, v217
    v_rcp_f32 v218, v218
    v_rcp_f32 v219, v219
    v_mfma_f32_32x32x16_bf16 v[176:191], v[204:207], v[52:55], v[176:191]
    ds_read_b64_tr_b16 v[200:201], v3 offset:22528
    ds_read_b64_tr_b16 v[202:203], v3 offset:23040
    ds_read_b64_tr_b16 v[204:205], v6 offset:22528
    ds_read_b64_tr_b16 v[206:207], v6 offset:23040
    v_mul_f32 v216, v136, v216
    v_mul_f32 v217, v137, v217
    v_mul_f32 v218, v138, v218
    s_waitcnt lgkmcnt(4)
    v_mfma_f32_32x32x16_bf16 v[160:175], v[192:195], v[56:59], v[160:175]
    v_mul_f32 v219, v139, v219
    v_cvt_pk_bf16_f32 v228, v216, v217
    v_cvt_pk_bf16_f32 v229, v218, v219
    v_fma_f32 v216, -v140, v140, s72
    v_fma_f32 v217, -v141, v141, s72
    v_fma_f32 v218, -v142, v142, s72
    v_fma_f32 v219, -v143, v143, s72
    v_mul_f32 v216, v140, v216
    v_mfma_f32_32x32x16_bf16 v[176:191], v[196:199], v[56:59], v[176:191]
    s_barrier
    ds_read_b64_tr_b16 v[192:193], v3 offset:24576
    ds_read_b64_tr_b16 v[194:195], v3 offset:25088
    ds_read_b64_tr_b16 v[196:197], v6 offset:24576
    ds_read_b64_tr_b16 v[198:199], v6 offset:25088
    ds_read_b128 v[136:139], v11 offset:576
    v_mul_f32 v217, v141, v217
    v_mul_f32 v218, v142, v218
    v_mul_f32 v219, v143, v219
    s_waitcnt lgkmcnt(5)
    v_mfma_f32_32x32x16_bf16 v[160:175], v[200:203], v[60:63], v[160:175]
    v_exp_f32 v216, v216
    v_exp_f32 v217, v217
    v_exp_f32 v218, v218
    v_exp_f32 v219, v219
    v_mfma_f32_32x32x16_bf16 v[176:191], v[204:207], v[60:63], v[176:191]
    ds_read_b64_tr_b16 v[200:201], v3 offset:26624
    ds_read_b64_tr_b16 v[202:203], v3 offset:27136
    ds_read_b64_tr_b16 v[204:205], v6 offset:26624
    ds_read_b64_tr_b16 v[206:207], v6 offset:27136
    v_add_f32 v216, 1.0, v216
    v_add_f32 v217, 1.0, v217
    v_add_f32 v218, 1.0, v218
    s_waitcnt lgkmcnt(5)
    v_mfma_f32_32x32x16_bf16 v[160:175], v[192:195], v[64:67], v[160:175]
    v_add_f32 v219, 1.0, v219
    v_rcp_f32 v216, v216
    v_rcp_f32 v217, v217
    v_rcp_f32 v218, v218
    v_rcp_f32 v219, v219
    v_mfma_f32_32x32x16_bf16 v[176:191], v[196:199], v[64:67], v[176:191]
    ds_read_b64_tr_b16 v[192:193], v3 offset:28672
    ds_read_b64_tr_b16 v[194:195], v3 offset:29184
    ds_read_b64_tr_b16 v[196:197], v6 offset:28672
    ds_read_b64_tr_b16 v[198:199], v6 offset:29184
    v_mul_f32 v216, v140, v216
    v_mul_f32 v217, v141, v217
    s_waitcnt lgkmcnt(4)
    v_mfma_f32_32x32x16_bf16 v[160:175], v[200:203], v[68:71], v[160:175]
    v_mul_f32 v218, v142, v218
    v_mul_f32 v219, v143, v219
    v_cvt_pk_bf16_f32 v230, v216, v217
    v_cvt_pk_bf16_f32 v231, v218, v219
    buffer_store_dwordx4 v[228:231], v1, s[20:23], s37 offen sc1
    v_fma_f32 v216, -v144, v144, s72
    v_fma_f32 v217, -v145, v145, s72
    v_mfma_f32_32x32x16_bf16 v[176:191], v[204:207], v[68:71], v[176:191]
    ds_read_b64_tr_b16 v[200:201], v3 offset:30720
    ds_read_b64_tr_b16 v[202:203], v3 offset:31232
    ds_read_b64_tr_b16 v[204:205], v6 offset:30720
    ds_read_b64_tr_b16 v[206:207], v6 offset:31232
    ds_read_b128 v[140:143], v11 offset:608
    v_fma_f32 v218, -v146, v146, s72
    v_fma_f32 v219, -v147, v147, s72
    v_mul_f32 v216, v144, v216
    v_mul_f32 v217, v145, v217
    s_waitcnt lgkmcnt(5)
    v_mfma_f32_32x32x16_bf16 v[160:175], v[192:195], v[72:75], v[160:175]
    v_mul_f32 v218, v146, v218
    v_mul_f32 v219, v147, v219
    v_exp_f32 v216, v216
    v_exp_f32 v217, v217
    v_exp_f32 v218, v218
    v_mfma_f32_32x32x16_bf16 v[176:191], v[196:199], v[72:75], v[176:191]
    ds_read_b64_tr_b16 v[192:193], v3 offset:32768
    ds_read_b64_tr_b16 v[194:195], v3 offset:33280
    ds_read_b64_tr_b16 v[196:197], v6 offset:32768
    ds_read_b64_tr_b16 v[198:199], v6 offset:33280
    v_exp_f32 v219, v219
    v_add_f32 v216, 1.0, v216
    s_waitcnt lgkmcnt(5)
    v_mfma_f32_32x32x16_bf16 v[160:175], v[200:203], v[76:79], v[160:175]
    v_add_f32 v217, 1.0, v217
    v_add_f32 v218, 1.0, v218
    v_add_f32 v219, 1.0, v219
    v_rcp_f32 v216, v216
    v_rcp_f32 v217, v217
    v_mfma_f32_32x32x16_bf16 v[176:191], v[204:207], v[76:79], v[176:191]
    ds_read_b64_tr_b16 v[200:201], v3 offset:34816
    ds_read_b64_tr_b16 v[202:203], v3 offset:35328
    ds_read_b64_tr_b16 v[204:205], v6 offset:34816
    ds_read_b64_tr_b16 v[206:207], v6 offset:35328
    v_rcp_f32 v218, v218
    v_rcp_f32 v219, v219
    s_waitcnt lgkmcnt(4)
    v_mfma_f32_32x32x16_bf16 v[160:175], v[192:195], v[80:83], v[160:175]
    v_mul_f32 v216, v144, v216
    v_mul_f32 v217, v145, v217
    v_mul_f32 v218, v146, v218
    v_mul_f32 v219, v147, v219
    v_cvt_pk_bf16_f32 v232, v216, v217
    v_cvt_pk_bf16_f32 v233, v218, v219
    v_fma_f32 v216, -v148, v148, s72
    v_fma_f32 v217, -v149, v149, s72
    v_mfma_f32_32x32x16_bf16 v[176:191], v[196:199], v[80:83], v[176:191]
    ds_read_b64_tr_b16 v[192:193], v3 offset:36864
    ds_read_b64_tr_b16 v[194:195], v3 offset:37376
    ds_read_b64_tr_b16 v[196:197], v6 offset:36864
    ds_read_b64_tr_b16 v[198:199], v6 offset:37376
    ds_read_b128 v[144:147], v11 offset:640
    v_fma_f32 v218, -v150, v150, s72
    v_fma_f32 v219, -v151, v151, s72
    v_mul_f32 v216, v148, v216
    s_waitcnt lgkmcnt(5)
    v_mfma_f32_32x32x16_bf16 v[160:175], v[200:203], v[84:87], v[160:175]
    v_mul_f32 v217, v149, v217
    v_mul_f32 v218, v150, v218
    v_mul_f32 v219, v151, v219
    v_exp_f32 v216, v216
    v_exp_f32 v217, v217
    v_exp_f32 v218, v218
    v_mfma_f32_32x32x16_bf16 v[176:191], v[204:207], v[84:87], v[176:191]
    ds_read_b64_tr_b16 v[200:201], v3 offset:38912
    ds_read_b64_tr_b16 v[202:203], v3 offset:39424
    ds_read_b64_tr_b16 v[204:205], v6 offset:38912
    ds_read_b64_tr_b16 v[206:207], v6 offset:39424
    v_exp_f32 v219, v219
    s_waitcnt lgkmcnt(5)
    v_mfma_f32_32x32x16_bf16 v[160:175], v[192:195], v[88:91], v[160:175]
    v_add_f32 v216, 1.0, v216
    v_add_f32 v217, 1.0, v217
    v_add_f32 v218, 1.0, v218
    v_add_f32 v219, 1.0, v219
    v_rcp_f32 v216, v216
    v_rcp_f32 v217, v217
    v_mfma_f32_32x32x16_bf16 v[176:191], v[196:199], v[88:91], v[176:191]
    ds_read_b64_tr_b16 v[192:193], v3 offset:40960
    ds_read_b64_tr_b16 v[194:195], v3 offset:41472
    ds_read_b64_tr_b16 v[196:197], v6 offset:40960
    ds_read_b64_tr_b16 v[198:199], v6 offset:41472
    v_rcp_f32 v218, v218
    v_rcp_f32 v219, v219
    s_waitcnt lgkmcnt(4)
    v_mfma_f32_32x32x16_bf16 v[160:175], v[200:203], v[92:95], v[160:175]
    v_mul_f32 v216, v148, v216
    v_mul_f32 v217, v149, v217
    v_mul_f32 v218, v150, v218
    v_mul_f32 v219, v151, v219
    v_cvt_pk_bf16_f32 v234, v216, v217
    v_cvt_pk_bf16_f32 v235, v218, v219
    buffer_store_dwordx4 v[232:235], v1, s[20:23], s38 offen sc1
    v_mfma_f32_32x32x16_bf16 v[176:191], v[204:207], v[92:95], v[176:191]
    ds_read_b64_tr_b16 v[200:201], v3 offset:43008
    ds_read_b64_tr_b16 v[202:203], v3 offset:43520
    ds_read_b64_tr_b16 v[204:205], v6 offset:43008
    ds_read_b64_tr_b16 v[206:207], v6 offset:43520
    ds_read_b128 v[148:151], v11 offset:672
    v_fma_f32 v216, -v152, v152, s72
    v_fma_f32 v217, -v153, v153, s72
    v_fma_f32 v218, -v154, v154, s72
    s_waitcnt lgkmcnt(5)
    v_mfma_f32_32x32x16_bf16 v[160:175], v[192:195], v[96:99], v[160:175]
    v_fma_f32 v219, -v155, v155, s72
    v_mul_f32 v216, v152, v216
    v_mul_f32 v217, v153, v217
    v_mul_f32 v218, v154, v218
    v_mul_f32 v219, v155, v219
    v_exp_f32 v216, v216
    v_mfma_f32_32x32x16_bf16 v[176:191], v[196:199], v[96:99], v[176:191]
    ds_read_b64_tr_b16 v[192:193], v3 offset:45056
    ds_read_b64_tr_b16 v[194:195], v3 offset:45568
    ds_read_b64_tr_b16 v[196:197], v6 offset:45056
    ds_read_b64_tr_b16 v[198:199], v6 offset:45568
    v_exp_f32 v217, v217
    v_exp_f32 v218, v218
    s_waitcnt lgkmcnt(5)
    v_mfma_f32_32x32x16_bf16 v[160:175], v[200:203], v[100:103], v[160:175]
    v_exp_f32 v219, v219
    v_add_f32 v216, 1.0, v216
    v_add_f32 v217, 1.0, v217
    v_add_f32 v218, 1.0, v218
    v_add_f32 v219, 1.0, v219
    v_rcp_f32 v216, v216
    v_mfma_f32_32x32x16_bf16 v[176:191], v[204:207], v[100:103], v[176:191]
    ds_read_b64_tr_b16 v[200:201], v3 offset:47104
    ds_read_b64_tr_b16 v[202:203], v3 offset:47616
    ds_read_b64_tr_b16 v[204:205], v6 offset:47104
    ds_read_b64_tr_b16 v[206:207], v6 offset:47616
    v_rcp_f32 v217, v217
    v_rcp_f32 v218, v218
    s_waitcnt lgkmcnt(4)
    v_mfma_f32_32x32x16_bf16 v[160:175], v[192:195], v[104:107], v[160:175]
    v_rcp_f32 v219, v219
    v_mul_f32 v216, v152, v216
    v_mul_f32 v217, v153, v217
    v_mul_f32 v218, v154, v218
    v_mul_f32 v219, v155, v219
    v_cvt_pk_bf16_f32 v236, v216, v217
    v_mfma_f32_32x32x16_bf16 v[176:191], v[196:199], v[104:107], v[176:191]
    ds_read_b64_tr_b16 v[192:193], v3 offset:49152
    ds_read_b64_tr_b16 v[194:195], v3 offset:49664
    ds_read_b64_tr_b16 v[196:197], v6 offset:49152
    ds_read_b64_tr_b16 v[198:199], v6 offset:49664
    v_cvt_pk_bf16_f32 v237, v218, v219
    v_fma_f32 v216, -v156, v156, s72
    v_fma_f32 v217, -v157, v157, s72
    s_waitcnt lgkmcnt(4)
    v_mfma_f32_32x32x16_bf16 v[160:175], v[200:203], v[108:111], v[160:175]
    v_fma_f32 v218, -v158, v158, s72
    v_fma_f32 v219, -v159, v159, s72
    v_mul_f32 v216, v156, v216
    v_mul_f32 v217, v157, v217
    v_mul_f32 v218, v158, v218
    v_mul_f32 v219, v159, v219
    v_exp_f32 v216, v216
    v_mfma_f32_32x32x16_bf16 v[176:191], v[204:207], v[108:111], v[176:191]
    ds_read_b64_tr_b16 v[200:201], v3 offset:51200
    ds_read_b64_tr_b16 v[202:203], v3 offset:51712
    ds_read_b64_tr_b16 v[204:205], v6 offset:51200
    ds_read_b64_tr_b16 v[206:207], v6 offset:51712
    ds_read_b128 v[152:155], v11 offset:704
    v_exp_f32 v217, v217
    v_exp_f32 v218, v218
    s_waitcnt lgkmcnt(5)
    v_mfma_f32_32x32x16_bf16 v[160:175], v[192:195], v[112:115], v[160:175]
    v_exp_f32 v219, v219
    v_add_f32 v216, 1.0, v216
    v_add_f32 v217, 1.0, v217
    v_add_f32 v218, 1.0, v218
    v_add_f32 v219, 1.0, v219
    v_rcp_f32 v216, v216
    v_mfma_f32_32x32x16_bf16 v[176:191], v[196:199], v[112:115], v[176:191]
    ds_read_b64_tr_b16 v[192:193], v3 offset:53248
    ds_read_b64_tr_b16 v[194:195], v3 offset:53760
    ds_read_b64_tr_b16 v[196:197], v6 offset:53248
    ds_read_b64_tr_b16 v[198:199], v6 offset:53760
    v_rcp_f32 v217, v217
    s_waitcnt lgkmcnt(5)
    v_mfma_f32_32x32x16_bf16 v[160:175], v[200:203], v[116:119], v[160:175]
    v_rcp_f32 v218, v218
    v_rcp_f32 v219, v219
    v_mul_f32 v216, v156, v216
    v_mul_f32 v217, v157, v217
    v_mul_f32 v218, v158, v218
    v_mul_f32 v219, v159, v219
    v_cvt_pk_bf16_f32 v238, v216, v217
    v_mfma_f32_32x32x16_bf16 v[176:191], v[204:207], v[116:119], v[176:191]
    ds_read_b64_tr_b16 v[200:201], v3 offset:55296
    ds_read_b64_tr_b16 v[202:203], v3 offset:55808
    ds_read_b64_tr_b16 v[204:205], v6 offset:55296
    ds_read_b64_tr_b16 v[206:207], v6 offset:55808
    v_cvt_pk_bf16_f32 v239, v218, v219
    buffer_store_dwordx4 v[236:239], v1, s[20:23], s39 offen sc1
    s_waitcnt lgkmcnt(4)
    v_mfma_f32_32x32x16_bf16 v[160:175], v[192:195], v[120:123], v[160:175]
    s_barrier
    ds_read_b64_tr_b16 v[192:193], v2 offset:24576
    ds_read_b64_tr_b16 v[194:195], v2 offset:25088
    v_mfma_f32_32x32x16_bf16 v[176:191], v[196:199], v[120:123], v[176:191]
    ds_read_b64_tr_b16 v[196:197], v5 offset:24576
    ds_read_b64_tr_b16 v[198:199], v5 offset:25088
    ds_read_b128 v[156:159], v11 offset:736
    s_waitcnt lgkmcnt(5)
    v_mfma_f32_32x32x16_bf16 v[160:175], v[200:203], v[124:127], v[160:175]
    ds_read_b64_tr_b16 v[200:201], v2 offset:26624
    ds_read_b64_tr_b16 v[202:203], v2 offset:27136
    v_mfma_f32_32x32x16_bf16 v[176:191], v[204:207], v[124:127], v[176:191]
    ds_read_b64_tr_b16 v[204:205], v5 offset:26624
    ds_read_b64_tr_b16 v[206:207], v5 offset:27136
    s_waitcnt lgkmcnt(4)
    v_mfma_f32_32x32x16_bf16 v[128:143], v[192:195], v[16:19], v[128:143]
    ds_read_b64_tr_b16 v[192:193], v2 offset:28672
    ds_read_b64_tr_b16 v[194:195], v2 offset:29184
    v_mfma_f32_32x32x16_bf16 v[144:159], v[196:199], v[16:19], v[144:159]
    ds_read_b64_tr_b16 v[196:197], v5 offset:28672
    ds_read_b64_tr_b16 v[198:199], v5 offset:29184
    s_waitcnt lgkmcnt(4)
    v_mfma_f32_32x32x16_bf16 v[128:143], v[200:203], v[20:23], v[128:143]
    v_fma_f32 v216, -v160, v160, s72
    v_fma_f32 v217, -v161, v161, s72
    v_fma_f32 v218, -v162, v162, s72
    v_fma_f32 v219, -v163, v163, s72
    v_mul_f32 v216, v160, v216
    v_mul_f32 v217, v161, v217
    v_mul_f32 v218, v162, v218
    v_mfma_f32_32x32x16_bf16 v[144:159], v[204:207], v[20:23], v[144:159]
    ds_read_b64_tr_b16 v[200:201], v2 offset:30720
    ds_read_b64_tr_b16 v[202:203], v2 offset:31232
    ds_read_b64_tr_b16 v[204:205], v5 offset:30720
    ds_read_b64_tr_b16 v[206:207], v5 offset:31232
    v_mul_f32 v219, v163, v219
    v_exp_f32 v216, v216
    s_waitcnt lgkmcnt(4)
    v_mfma_f32_32x32x16_bf16 v[128:143], v[192:195], v[24:27], v[128:143]
    v_exp_f32 v217, v217
    v_exp_f32 v218, v218
    v_exp_f32 v219, v219
    v_add_f32 v216, 1.0, v216
    v_add_f32 v217, 1.0, v217
    v_mfma_f32_32x32x16_bf16 v[144:159], v[196:199], v[24:27], v[144:159]
    ds_read_b64_tr_b16 v[192:193], v2 offset:32768
    ds_read_b64_tr_b16 v[194:195], v2 offset:33280
    ds_read_b64_tr_b16 v[196:197], v5 offset:32768
    ds_read_b64_tr_b16 v[198:199], v5 offset:33280
    v_add_f32 v218, 1.0, v218
    v_add_f32 v219, 1.0, v219
    s_waitcnt lgkmcnt(4)
    v_mfma_f32_32x32x16_bf16 v[128:143], v[200:203], v[28:31], v[128:143]
    v_rcp_f32 v216, v216
    v_rcp_f32 v217, v217
    v_rcp_f32 v218, v218
    v_rcp_f32 v219, v219
    v_mfma_f32_32x32x16_bf16 v[144:159], v[204:207], v[28:31], v[144:159]
    ds_read_b64_tr_b16 v[200:201], v2 offset:34816
    ds_read_b64_tr_b16 v[202:203], v2 offset:35328
    ds_read_b64_tr_b16 v[204:205], v5 offset:34816
    ds_read_b64_tr_b16 v[206:207], v5 offset:35328
    v_mul_f32 v216, v160, v216
    v_mul_f32 v217, v161, v217
    v_mul_f32 v218, v162, v218
    s_waitcnt lgkmcnt(4)
    v_mfma_f32_32x32x16_bf16 v[128:143], v[192:195], v[32:35], v[128:143]
    v_mul_f32 v219, v163, v219
    v_cvt_pk_bf16_f32 v224, v216, v217
    v_cvt_pk_bf16_f32 v225, v218, v219
    v_fma_f32 v216, -v164, v164, s72
    v_fma_f32 v217, -v165, v165, s72
    v_fma_f32 v218, -v166, v166, s72
    v_fma_f32 v219, -v167, v167, s72
    v_mfma_f32_32x32x16_bf16 v[144:159], v[196:199], v[32:35], v[144:159]
    ds_read_b64_tr_b16 v[192:193], v2 offset:36864
    ds_read_b64_tr_b16 v[194:195], v2 offset:37376
    ds_read_b64_tr_b16 v[196:197], v5 offset:36864
    ds_read_b64_tr_b16 v[198:199], v5 offset:37376
    ds_read_b128 v[160:163], v11 offset:768
    v_mul_f32 v216, v164, v216
    v_mul_f32 v217, v165, v217
    v_mul_f32 v218, v166, v218
    s_waitcnt lgkmcnt(5)
    v_mfma_f32_32x32x16_bf16 v[128:143], v[200:203], v[36:39], v[128:143]
    v_mul_f32 v219, v167, v219
    v_exp_f32 v216, v216
    v_exp_f32 v217, v217
    v_exp_f32 v218, v218
    v_mfma_f32_32x32x16_bf16 v[144:159], v[204:207], v[36:39], v[144:159]
    ds_read_b64_tr_b16 v[200:201], v2 offset:38912
    ds_read_b64_tr_b16 v[202:203], v2 offset:39424
    ds_read_b64_tr_b16 v[204:205], v5 offset:38912
    ds_read_b64_tr_b16 v[206:207], v5 offset:39424
    v_exp_f32 v219, v219
    v_add_f32 v216, 1.0, v216
    v_add_f32 v217, 1.0, v217
    s_waitcnt lgkmcnt(5)
    v_mfma_f32_32x32x16_bf16 v[128:143], v[192:195], v[40:43], v[128:143]
    v_add_f32 v218, 1.0, v218
    v_add_f32 v219, 1.0, v219
    v_rcp_f32 v216, v216
    v_rcp_f32 v217, v217
    v_rcp_f32 v218, v218
    v_mfma_f32_32x32x16_bf16 v[144:159], v[196:199], v[40:43], v[144:159]
    ds_read_b64_tr_b16 v[192:193], v2 offset:40960
    ds_read_b64_tr_b16 v[194:195], v2 offset:41472
    ds_read_b64_tr_b16 v[196:197], v5 offset:40960
    ds_read_b64_tr_b16 v[198:199], v5 offset:41472
    v_rcp_f32 v219, v219
    s_waitcnt lgkmcnt(4)
    v_mfma_f32_32x32x16_bf16 v[128:143], v[200:203], v[44:47], v[128:143]
    v_mul_f32 v216, v164, v216
    v_mul_f32 v217, v165, v217
    v_mul_f32 v218, v166, v218
    v_mul_f32 v219, v167, v219
    v_cvt_pk_bf16_f32 v226, v216, v217
    v_cvt_pk_bf16_f32 v227, v218, v219
    buffer_store_dwordx4 v[224:227], v1, s[20:23], s40 offen sc1
    v_mfma_f32_32x32x16_bf16 v[144:159], v[204:207], v[44:47], v[144:159]
    ds_read_b64_tr_b16 v[200:201], v2 offset:43008
    ds_read_b64_tr_b16 v[202:203], v2 offset:43520
    ds_read_b64_tr_b16 v[204:205], v5 offset:43008
    ds_read_b64_tr_b16 v[206:207], v5 offset:43520
    ds_read_b128 v[164:167], v11 offset:800
    v_fma_f32 v216, -v168, v168, s72
    v_fma_f32 v217, -v169, v169, s72
    v_fma_f32 v218, -v170, v170, s72
    s_waitcnt lgkmcnt(5)
    v_mfma_f32_32x32x16_bf16 v[128:143], v[192:195], v[48:51], v[128:143]
    v_fma_f32 v219, -v171, v171, s72
    v_mul_f32 v216, v168, v216
    v_mul_f32 v217, v169, v217
    v_mul_f32 v218, v170, v218
    v_mul_f32 v219, v171, v219
    v_exp_f32 v216, v216
    v_mfma_f32_32x32x16_bf16 v[144:159], v[196:199], v[48:51], v[144:159]
    ds_read_b64_tr_b16 v[192:193], v2 offset:45056
    ds_read_b64_tr_b16 v[194:195], v2 offset:45568
    ds_read_b64_tr_b16 v[196:197], v5 offset:45056
    ds_read_b64_tr_b16 v[198:199], v5 offset:45568
    v_exp_f32 v217, v217
    s_waitcnt lgkmcnt(5)
    v_mfma_f32_32x32x16_bf16 v[128:143], v[200:203], v[52:55], v[128:143]
    v_exp_f32 v218, v218
    v_exp_f32 v219, v219
    v_add_f32 v216, 1.0, v216
    v_add_f32 v217, 1.0, v217
    v_add_f32 v218, 1.0, v218
    v_add_f32 v219, 1.0, v219
    v_mfma_f32_32x32x16_bf16 v[144:159], v[204:207], v[52:55], v[144:159]
    ds_read_b64_tr_b16 v[200:201], v2 offset:47104
    ds_read_b64_tr_b16 v[202:203], v2 offset:47616
    ds_read_b64_tr_b16 v[204:205], v5 offset:47104
    ds_read_b64_tr_b16 v[206:207], v5 offset:47616
    v_rcp_f32 v216, v216
    v_rcp_f32 v217, v217
    s_waitcnt lgkmcnt(4)
    v_mfma_f32_32x32x16_bf16 v[128:143], v[192:195], v[56:59], v[128:143]
    v_rcp_f32 v218, v218
    v_rcp_f32 v219, v219
    v_mul_f32 v216, v168, v216
    v_mul_f32 v217, v169, v217
    v_mul_f32 v218, v170, v218
    v_mfma_f32_32x32x16_bf16 v[144:159], v[196:199], v[56:59], v[144:159]
    ds_read_b64_tr_b16 v[192:193], v3 offset:57344
    ds_read_b64_tr_b16 v[194:195], v3 offset:57856
    ds_read_b64_tr_b16 v[196:197], v6 offset:57344
    ds_read_b64_tr_b16 v[198:199], v6 offset:57856
    v_mul_f32 v219, v171, v219
    v_cvt_pk_bf16_f32 v228, v216, v217
    v_cvt_pk_bf16_f32 v229, v218, v219
    s_waitcnt vmcnt(1)
    v_mov_b32 v12, 1
    s_mov_b64 exec, 1
    buffer_store_dword v12, off, s[20:23], s70 sc1
    s_mov_b64 exec, -1
    s_waitcnt lgkmcnt(4)
    v_mfma_f32_32x32x16_bf16 v[128:143], v[200:203], v[60:63], v[128:143]
    v_fma_f32 v216, -v172, v172, s72
    v_fma_f32 v217, -v173, v173, s72
    v_fma_f32 v218, -v174, v174, s72
    v_fma_f32 v219, -v175, v175, s72
    v_mul_f32 v216, v172, v216
    v_mul_f32 v217, v173, v217
    v_mul_f32 v218, v174, v218
    v_mfma_f32_32x32x16_bf16 v[144:159], v[204:207], v[60:63], v[144:159]
    ds_read_b64_tr_b16 v[200:201], v3 offset:59392
    ds_read_b64_tr_b16 v[202:203], v3 offset:59904
    ds_read_b64_tr_b16 v[204:205], v6 offset:59392
    ds_read_b64_tr_b16 v[206:207], v6 offset:59904
    ds_read_b128 v[168:171], v11 offset:832
    v_mul_f32 v219, v175, v219
    v_exp_f32 v216, v216
    s_waitcnt lgkmcnt(5)
    v_mfma_f32_32x32x16_bf16 v[128:143], v[192:195], v[64:67], v[128:143]
    v_exp_f32 v217, v217
    v_exp_f32 v218, v218
    v_exp_f32 v219, v219
    v_add_f32 v216, 1.0, v216
    v_mfma_f32_32x32x16_bf16 v[144:159], v[196:199], v[64:67], v[144:159]
    ds_read_b64_tr_b16 v[192:193], v3 offset:61440
    ds_read_b64_tr_b16 v[194:195], v3 offset:61952
    ds_read_b64_tr_b16 v[196:197], v6 offset:61440
    ds_read_b64_tr_b16 v[198:199], v6 offset:61952
    v_add_f32 v217, 1.0, v217
    v_add_f32 v218, 1.0, v218
    v_add_f32 v219, 1.0, v219
    s_waitcnt lgkmcnt(5)
    v_mfma_f32_32x32x16_bf16 v[128:143], v[200:203], v[68:71], v[128:143]
    v_rcp_f32 v216, v216
    v_rcp_f32 v217, v217
    v_rcp_f32 v218, v218
    v_rcp_f32 v219, v219
    v_mfma_f32_32x32x16_bf16 v[144:159], v[204:207], v[68:71], v[144:159]
    ds_read_b64_tr_b16 v[200:201], v3 offset:63488
    ds_read_b64_tr_b16 v[202:203], v3 offset:64000
    ds_read_b64_tr_b16 v[204:205], v6 offset:63488
    ds_read_b64_tr_b16 v[206:207], v6 offset:64000
    v_mul_f32 v216, v172, v216
    v_mul_f32 v217, v173, v217
    v_mul_f32 v218, v174, v218
    s_waitcnt lgkmcnt(4)
    v_mfma_f32_32x32x16_bf16 v[128:143], v[192:195], v[72:75], v[128:143]
    v_mul_f32 v219, v175, v219
    v_cvt_pk_bf16_f32 v230, v216, v217
    v_cvt_pk_bf16_f32 v231, v218, v219
    buffer_store_dwordx4 v[228:231], v1, s[20:23], s41 offen sc1
    v_fma_f32 v216, -v176, v176, s72
    v_fma_f32 v217, -v177, v177, s72
    v_mfma_f32_32x32x16_bf16 v[144:159], v[196:199], v[72:75], v[144:159]
    s_barrier
    ds_read_b64_tr_b16 v[192:193], v2 offset:49152
    ds_read_b64_tr_b16 v[194:195], v2 offset:49664
    ds_read_b64_tr_b16 v[196:197], v5 offset:49152
    ds_read_b64_tr_b16 v[198:199], v5 offset:49664
    ds_read_b128 v[172:175], v11 offset:864
    v_fma_f32 v218, -v178, v178, s72
    v_fma_f32 v219, -v179, v179, s72
    v_mul_f32 v216, v176, v216
    s_waitcnt lgkmcnt(5)
    v_mfma_f32_32x32x16_bf16 v[128:143], v[200:203], v[76:79], v[128:143]
    v_mul_f32 v217, v177, v217
    v_mul_f32 v218, v178, v218
    v_mul_f32 v219, v179, v219
    v_exp_f32 v216, v216
    v_exp_f32 v217, v217
    v_mfma_f32_32x32x16_bf16 v[144:159], v[204:207], v[76:79], v[144:159]
    ds_read_b64_tr_b16 v[200:201], v2 offset:51200
    ds_read_b64_tr_b16 v[202:203], v2 offset:51712
    ds_read_b64_tr_b16 v[204:205], v5 offset:51200
    ds_read_b64_tr_b16 v[206:207], v5 offset:51712
    v_exp_f32 v218, v218
    v_exp_f32 v219, v219
    s_waitcnt lgkmcnt(5)
    v_mfma_f32_32x32x16_bf16 v[128:143], v[192:195], v[80:83], v[128:143]
    v_add_f32 v216, 1.0, v216
    v_add_f32 v217, 1.0, v217
    v_add_f32 v218, 1.0, v218
    v_add_f32 v219, 1.0, v219
    v_rcp_f32 v216, v216
    v_mfma_f32_32x32x16_bf16 v[144:159], v[196:199], v[80:83], v[144:159]
    ds_read_b64_tr_b16 v[192:193], v2 offset:53248
    ds_read_b64_tr_b16 v[194:195], v2 offset:53760
    ds_read_b64_tr_b16 v[196:197], v5 offset:53248
    ds_read_b64_tr_b16 v[198:199], v5 offset:53760
    v_rcp_f32 v217, v217
    v_rcp_f32 v218, v218
    s_waitcnt lgkmcnt(4)
    v_mfma_f32_32x32x16_bf16 v[128:143], v[200:203], v[84:87], v[128:143]
    v_rcp_f32 v219, v219
    v_mul_f32 v216, v176, v216
    v_mul_f32 v217, v177, v217
    v_mul_f32 v218, v178, v218
    v_mul_f32 v219, v179, v219
    v_cvt_pk_bf16_f32 v232, v216, v217
    v_mfma_f32_32x32x16_bf16 v[144:159], v[204:207], v[84:87], v[144:159]
    ds_read_b64_tr_b16 v[200:201], v2 offset:55296
    ds_read_b64_tr_b16 v[202:203], v2 offset:55808
    ds_read_b64_tr_b16 v[204:205], v5 offset:55296
    ds_read_b64_tr_b16 v[206:207], v5 offset:55808
    v_cvt_pk_bf16_f32 v233, v218, v219
    v_fma_f32 v216, -v180, v180, s72
    v_fma_f32 v217, -v181, v181, s72
    s_waitcnt lgkmcnt(4)
    v_mfma_f32_32x32x16_bf16 v[128:143], v[192:195], v[88:91], v[128:143]
    v_fma_f32 v218, -v182, v182, s72
    v_fma_f32 v219, -v183, v183, s72
    v_mul_f32 v216, v180, v216
    v_mul_f32 v217, v181, v217
    v_mul_f32 v218, v182, v218
    v_mul_f32 v219, v183, v219
    v_exp_f32 v216, v216
    v_mfma_f32_32x32x16_bf16 v[144:159], v[196:199], v[88:91], v[144:159]
    ds_read_b64_tr_b16 v[192:193], v2 offset:57344
    ds_read_b64_tr_b16 v[194:195], v2 offset:57856
    ds_read_b64_tr_b16 v[196:197], v5 offset:57344
    ds_read_b64_tr_b16 v[198:199], v5 offset:57856
    v_exp_f32 v217, v217
    s_waitcnt lgkmcnt(4)
    v_mfma_f32_32x32x16_bf16 v[128:143], v[200:203], v[92:95], v[128:143]
    v_exp_f32 v218, v218
    v_exp_f32 v219, v219
    v_add_f32 v216, 1.0, v216
    v_add_f32 v217, 1.0, v217
    v_add_f32 v218, 1.0, v218
    v_add_f32 v219, 1.0, v219
    v_mfma_f32_32x32x16_bf16 v[144:159], v[204:207], v[92:95], v[144:159]
    ds_read_b64_tr_b16 v[200:201], v2 offset:59392
    ds_read_b64_tr_b16 v[202:203], v2 offset:59904
    ds_read_b64_tr_b16 v[204:205], v5 offset:59392
    ds_read_b64_tr_b16 v[206:207], v5 offset:59904
    v_rcp_f32 v216, v216
    v_rcp_f32 v217, v217
    s_waitcnt lgkmcnt(4)
    v_mfma_f32_32x32x16_bf16 v[128:143], v[192:195], v[96:99], v[128:143]
    v_rcp_f32 v218, v218
    v_rcp_f32 v219, v219
    v_mul_f32 v216, v180, v216
    v_mul_f32 v217, v181, v217
    v_mfma_f32_32x32x16_bf16 v[144:159], v[196:199], v[96:99], v[144:159]
    ds_read_b64_tr_b16 v[192:193], v2 offset:61440
    ds_read_b64_tr_b16 v[194:195], v2 offset:61952
    ds_read_b64_tr_b16 v[196:197], v5 offset:61440
    ds_read_b64_tr_b16 v[198:199], v5 offset:61952
    v_mul_f32 v218, v182, v218
    v_mul_f32 v219, v183, v219
    v_cvt_pk_bf16_f32 v234, v216, v217
    s_waitcnt lgkmcnt(4)
    v_mfma_f32_32x32x16_bf16 v[128:143], v[200:203], v[100:103], v[128:143]
    v_cvt_pk_bf16_f32 v235, v218, v219
    buffer_store_dwordx4 v[232:235], v1, s[20:23], s42 offen sc1
    v_fma_f32 v216, -v184, v184, s72
    v_fma_f32 v217, -v185, v185, s72
    v_fma_f32 v218, -v186, v186, s72
    v_fma_f32 v219, -v187, v187, s72
    v_mul_f32 v216, v184, v216
    v_mfma_f32_32x32x16_bf16 v[144:159], v[204:207], v[100:103], v[144:159]
    ds_read_b64_tr_b16 v[200:201], v2 offset:63488
    ds_read_b64_tr_b16 v[202:203], v2 offset:64000
    ds_read_b64_tr_b16 v[204:205], v5 offset:63488
    ds_read_b64_tr_b16 v[206:207], v5 offset:64000
    v_mul_f32 v217, v185, v217
    v_mul_f32 v218, v186, v218
    v_mul_f32 v219, v187, v219
    s_waitcnt lgkmcnt(4)
    v_mfma_f32_32x32x16_bf16 v[128:143], v[192:195], v[104:107], v[128:143]
    v_exp_f32 v216, v216
    v_exp_f32 v217, v217
    v_exp_f32 v218, v218
    v_exp_f32 v219, v219
    v_mfma_f32_32x32x16_bf16 v[144:159], v[196:199], v[104:107], v[144:159]
    ds_read_b64_tr_b16 v[192:193], v3 offset:0
    ds_read_b64_tr_b16 v[194:195], v3 offset:512
    ds_read_b64_tr_b16 v[196:197], v6 offset:0
    ds_read_b64_tr_b16 v[198:199], v6 offset:512
    v_add_f32 v216, 1.0, v216
    v_add_f32 v217, 1.0, v217
    s_waitcnt lgkmcnt(4)
    v_mfma_f32_32x32x16_bf16 v[128:143], v[200:203], v[108:111], v[128:143]
    v_add_f32 v218, 1.0, v218
    v_add_f32 v219, 1.0, v219
    v_rcp_f32 v216, v216
    v_rcp_f32 v217, v217
    v_rcp_f32 v218, v218
    v_mfma_f32_32x32x16_bf16 v[144:159], v[204:207], v[108:111], v[144:159]
    ds_read_b64_tr_b16 v[200:201], v3 offset:2048
    ds_read_b64_tr_b16 v[202:203], v3 offset:2560
    ds_read_b64_tr_b16 v[204:205], v6 offset:2048
    ds_read_b64_tr_b16 v[206:207], v6 offset:2560
    v_rcp_f32 v219, v219
    v_mul_f32 v216, v184, v216
    s_waitcnt lgkmcnt(4)
    v_mfma_f32_32x32x16_bf16 v[128:143], v[192:195], v[112:115], v[128:143]
    v_mul_f32 v217, v185, v217
    v_mul_f32 v218, v186, v218
    v_mul_f32 v219, v187, v219
    v_cvt_pk_bf16_f32 v236, v216, v217
    v_cvt_pk_bf16_f32 v237, v218, v219
    v_fma_f32 v216, -v188, v188, s72
    v_fma_f32 v217, -v189, v189, s72
    v_mfma_f32_32x32x16_bf16 v[144:159], v[196:199], v[112:115], v[144:159]
    ds_read_b64_tr_b16 v[192:193], v3 offset:4096
    ds_read_b64_tr_b16 v[194:195], v3 offset:4608
    ds_read_b64_tr_b16 v[196:197], v6 offset:4096
    ds_read_b64_tr_b16 v[198:199], v6 offset:4608
    v_fma_f32 v218, -v190, v190, s72
    v_fma_f32 v219, -v191, v191, s72
    v_mul_f32 v216, v188, v216
    s_waitcnt lgkmcnt(4)
    v_mfma_f32_32x32x16_bf16 v[128:143], v[200:203], v[116:119], v[128:143]
    v_mul_f32 v217, v189, v217
    v_mul_f32 v218, v190, v218
    v_mul_f32 v219, v191, v219
    v_exp_f32 v216, v216
    v_exp_f32 v217, v217
    v_mfma_f32_32x32x16_bf16 v[144:159], v[204:207], v[116:119], v[144:159]
    ds_read_b64_tr_b16 v[200:201], v3 offset:6144
    ds_read_b64_tr_b16 v[202:203], v3 offset:6656
    ds_read_b64_tr_b16 v[204:205], v6 offset:6144
    ds_read_b64_tr_b16 v[206:207], v6 offset:6656
    v_exp_f32 v218, v218
    v_exp_f32 v219, v219
    s_waitcnt lgkmcnt(4)
    v_mfma_f32_32x32x16_bf16 v[128:143], v[192:195], v[120:123], v[128:143]
    v_add_f32 v216, 1.0, v216
    v_add_f32 v217, 1.0, v217
    v_add_f32 v218, 1.0, v218
    v_add_f32 v219, 1.0, v219
    v_rcp_f32 v216, v216
    v_mfma_f32_32x32x16_bf16 v[144:159], v[196:199], v[120:123], v[144:159]
    s_barrier
    ds_read_b64_tr_b16 v[192:193], v9 offset:16384
    ds_read_b64_tr_b16 v[194:195], v9 offset:16640
    ds_read_b64_tr_b16 v[196:197], v9 offset:18432
    ds_read_b64_tr_b16 v[198:199], v9 offset:18688
    v_rcp_f32 v217, v217
    v_rcp_f32 v218, v218
    s_waitcnt lgkmcnt(4)
    v_mfma_f32_32x32x16_bf16 v[128:143], v[200:203], v[124:127], v[128:143]
    v_rcp_f32 v219, v219
    v_mul_f32 v216, v188, v216
    v_mul_f32 v217, v189, v217
    v_mul_f32 v218, v190, v218
    v_mul_f32 v219, v191, v219
    v_cvt_pk_bf16_f32 v238, v216, v217
    v_mfma_f32_32x32x16_bf16 v[144:159], v[204:207], v[124:127], v[144:159]
    ds_read_b64_tr_b16 v[200:201], v9 offset:20480
    ds_read_b64_tr_b16 v[202:203], v9 offset:20736
    ds_read_b64_tr_b16 v[204:205], v9 offset:22528
    ds_read_b64_tr_b16 v[206:207], v9 offset:22784
    v_cvt_pk_bf16_f32 v239, v218, v219
    buffer_store_dwordx4 v[236:239], v1, s[20:23], s43 offen sc1
    s_waitcnt lgkmcnt(4)
    v_mfma_f32_32x32x16_bf16 v[160:175], v[192:195], v[16:19], v[160:175]
    ds_read_b64_tr_b16 v[192:193], v9 offset:17408
    ds_read_b64_tr_b16 v[194:195], v9 offset:17664
    v_mfma_f32_32x32x16_bf16 v[160:175], v[196:199], v[20:23], v[160:175]
    ds_read_b64_tr_b16 v[196:197], v9 offset:19456
    ds_read_b64_tr_b16 v[198:199], v9 offset:19712
    s_waitcnt lgkmcnt(4)
    v_mfma_f32_32x32x16_bf16 v[160:175], v[200:203], v[24:27], v[160:175]
    v_fma_f32 v216, -v128, v128, s72
    v_fma_f32 v217, -v129, v129, s72
    v_fma_f32 v218, -v130, v130, s72
    v_fma_f32 v219, -v131, v131, s72
    v_mul_f32 v216, v128, v216
    v_mul_f32 v217, v129, v217
    v_mul_f32 v218, v130, v218
    v_mul_f32 v219, v131, v219
    v_mfma_f32_32x32x16_bf16 v[160:175], v[204:207], v[28:31], v[160:175]
    ds_read_b64_tr_b16 v[200:201], v9 offset:21504
    ds_read_b64_tr_b16 v[202:203], v9 offset:21760
    ds_read_b64_tr_b16 v[204:205], v9 offset:23552
    ds_read_b64_tr_b16 v[206:207], v9 offset:23808
    v_exp_f32 v216, v216
    s_waitcnt lgkmcnt(4)
    v_mfma_f32_32x32x16_bf16 v[160:175], v[192:195], v[32:35], v[160:175]
    v_exp_f32 v217, v217
    v_exp_f32 v218, v218
    v_exp_f32 v219, v219
    v_add_f32 v216, 1.0, v216
    v_add_f32 v217, 1.0, v217
    v_mfma_f32_32x32x16_bf16 v[160:175], v[196:199], v[36:39], v[160:175]
    ds_read_b64_tr_b16 v[192:193], v9 offset:24576
    ds_read_b64_tr_b16 v[194:195], v9 offset:24832
    ds_read_b64_tr_b16 v[196:197], v9 offset:26624
    ds_read_b64_tr_b16 v[198:199], v9 offset:26880
    v_add_f32 v218, 1.0, v218
    v_add_f32 v219, 1.0, v219
    v_rcp_f32 v216, v216
    s_waitcnt lgkmcnt(4)
    v_mfma_f32_32x32x16_bf16 v[160:175], v[200:203], v[40:43], v[160:175]
    v_rcp_f32 v217, v217
    v_rcp_f32 v218, v218
    v_rcp_f32 v219, v219
    v_mul_f32 v216, v128, v216
    v_mfma_f32_32x32x16_bf16 v[160:175], v[204:207], v[44:47], v[160:175]
    ds_read_b64_tr_b16 v[200:201], v9 offset:28672
    ds_read_b64_tr_b16 v[202:203], v9 offset:28928
    ds_read_b64_tr_b16 v[204:205], v9 offset:30720
    ds_read_b64_tr_b16 v[206:207], v9 offset:30976
    v_mul_f32 v217, v129, v217
    v_mul_f32 v218, v130, v218
    v_mul_f32 v219, v131, v219
    s_waitcnt lgkmcnt(4)
    v_mfma_f32_32x32x16_bf16 v[160:175], v[192:195], v[48:51], v[160:175]
    v_cvt_pk_bf16_f32 v224, v216, v217
    v_cvt_pk_bf16_f32 v225, v218, v219
    v_fma_f32 v216, -v132, v132, s72
    v_fma_f32 v217, -v133, v133, s72
    v_fma_f32 v218, -v134, v134, s72
    v_fma_f32 v219, -v135, v135, s72
    v_mul_f32 v216, v132, v216
    v_mul_f32 v217, v133, v217
    v_mfma_f32_32x32x16_bf16 v[160:175], v[196:199], v[52:55], v[160:175]
    ds_read_b64_tr_b16 v[192:193], v9 offset:25600
    ds_read_b64_tr_b16 v[194:195], v9 offset:25856
    ds_read_b64_tr_b16 v[196:197], v9 offset:27648
    ds_read_b64_tr_b16 v[198:199], v9 offset:27904
    v_mul_f32 v218, v134, v218
    v_mul_f32 v219, v135, v219
    v_exp_f32 v216, v216
    s_waitcnt lgkmcnt(4)
    v_mfma_f32_32x32x16_bf16 v[160:175], v[200:203], v[56:59], v[160:175]
    v_exp_f32 v217, v217
    v_exp_f32 v218, v218
    v_exp_f32 v219, v219
    v_add_f32 v216, 1.0, v216
    v_mfma_f32_32x32x16_bf16 v[160:175], v[204:207], v[60:63], v[160:175]
    ds_read_b64_tr_b16 v[200:201], v9 offset:29696
    ds_read_b64_tr_b16 v[202:203], v9 offset:29952
    ds_read_b64_tr_b16 v[204:205], v9 offset:31744
    ds_read_b64_tr_b16 v[206:207], v9 offset:32000
    v_add_f32 v217, 1.0, v217
    v_add_f32 v218, 1.0, v218
    v_add_f32 v219, 1.0, v219
    s_waitcnt lgkmcnt(4)
    v_mfma_f32_32x32x16_bf16 v[160:175], v[192:195], v[64:67], v[160:175]
    v_rcp_f32 v216, v216
    v_rcp_f32 v217, v217
    v_rcp_f32 v218, v218
    v_rcp_f32 v219, v219
    v_mfma_f32_32x32x16_bf16 v[160:175], v[196:199], v[68:71], v[160:175]
    ds_read_b64_tr_b16 v[192:193], v9 offset:49152
    ds_read_b64_tr_b16 v[194:195], v9 offset:49408
    ds_read_b64_tr_b16 v[196:197], v9 offset:51200
    ds_read_b64_tr_b16 v[198:199], v9 offset:51456
    v_mul_f32 v216, v132, v216
    v_mul_f32 v217, v133, v217
    v_mul_f32 v218, v134, v218
    s_waitcnt lgkmcnt(4)
    v_mfma_f32_32x32x16_bf16 v[160:175], v[200:203], v[72:75], v[160:175]
    v_mul_f32 v219, v135, v219
    v_cvt_pk_bf16_f32 v226, v216, v217
    v_cvt_pk_bf16_f32 v227, v218, v219
    buffer_store_dwordx4 v[224:227], v1, s[20:23], s44 offen sc1
    v_fma_f32 v216, -v136, v136, s72
    v_fma_f32 v217, -v137, v137, s72
    v_mfma_f32_32x32x16_bf16 v[160:175], v[204:207], v[76:79], v[160:175]
    ds_read_b64_tr_b16 v[200:201], v9 offset:53248
    ds_read_b64_tr_b16 v[202:203], v9 offset:53504
    ds_read_b64_tr_b16 v[204:205], v9 offset:55296
    ds_read_b64_tr_b16 v[206:207], v9 offset:55552
    v_fma_f32 v218, -v138, v138, s72
    v_fma_f32 v219, -v139, v139, s72
    v_mul_f32 v216, v136, v216
    s_waitcnt lgkmcnt(4)
    v_mfma_f32_32x32x16_bf16 v[160:175], v[192:195], v[80:83], v[160:175]
    v_mul_f32 v217, v137, v217
    v_mul_f32 v218, v138, v218
    v_mul_f32 v219, v139, v219
    v_exp_f32 v216, v216
    v_exp_f32 v217, v217
    v_mfma_f32_32x32x16_bf16 v[160:175], v[196:199], v[84:87], v[160:175]
    ds_read_b64_tr_b16 v[192:193], v9 offset:50176
    ds_read_b64_tr_b16 v[194:195], v9 offset:50432
    ds_read_b64_tr_b16 v[196:197], v9 offset:52224
    ds_read_b64_tr_b16 v[198:199], v9 offset:52480
    v_exp_f32 v218, v218
    v_exp_f32 v219, v219
    s_waitcnt lgkmcnt(4)
    v_mfma_f32_32x32x16_bf16 v[160:175], v[200:203], v[88:91], v[160:175]
    v_add_f32 v216, 1.0, v216
    v_add_f32 v217, 1.0, v217
    v_add_f32 v218, 1.0, v218
    v_add_f32 v219, 1.0, v219
    v_rcp_f32 v216, v216
    v_rcp_f32 v217, v217
    v_mfma_f32_32x32x16_bf16 v[160:175], v[204:207], v[92:95], v[160:175]
    ds_read_b64_tr_b16 v[200:201], v9 offset:54272
    ds_read_b64_tr_b16 v[202:203], v9 offset:54528
    ds_read_b64_tr_b16 v[204:205], v9 offset:56320
    ds_read_b64_tr_b16 v[206:207], v9 offset:56576
    v_rcp_f32 v218, v218
    s_waitcnt lgkmcnt(4)
    v_mfma_f32_32x32x16_bf16 v[160:175], v[192:195], v[96:99], v[160:175]
    v_rcp_f32 v219, v219
    v_mul_f32 v216, v136, v216
    v_mul_f32 v217, v137, v217
    v_mul_f32 v218, v138, v218
    v_mul_f32 v219, v139, v219
    v_cvt_pk_bf16_f32 v228, v216, v217
    v_cvt_pk_bf16_f32 v229, v218, v219
    v_mfma_f32_32x32x16_bf16 v[160:175], v[196:199], v[100:103], v[160:175]
    ds_read_b64_tr_b16 v[192:193], v8 offset:24576
    ds_read_b64_tr_b16 v[194:195], v8 offset:24832
    ds_read_b64_tr_b16 v[196:197], v8 offset:26624
    ds_read_b64_tr_b16 v[198:199], v8 offset:26880
    v_fma_f32 v216, -v140, v140, s72
    v_fma_f32 v217, -v141, v141, s72
    v_fma_f32 v218, -v142, v142, s72
    v_fma_f32 v219, -v143, v143, s72
    s_waitcnt lgkmcnt(4)
    v_mfma_f32_32x32x16_bf16 v[160:175], v[200:203], v[104:107], v[160:175]
    v_mul_f32 v216, v140, v216
    v_mul_f32 v217, v141, v217
    v_mul_f32 v218, v142, v218
    v_mul_f32 v219, v143, v219
    v_exp_f32 v216, v216
    v_exp_f32 v217, v217
    v_mfma_f32_32x32x16_bf16 v[160:175], v[204:207], v[108:111], v[160:175]
    ds_read_b64_tr_b16 v[200:201], v8 offset:28672
    ds_read_b64_tr_b16 v[202:203], v8 offset:28928
    ds_read_b64_tr_b16 v[204:205], v8 offset:30720
    ds_read_b64_tr_b16 v[206:207], v8 offset:30976
    v_exp_f32 v218, v218
    s_waitcnt lgkmcnt(4)
    v_mfma_f32_32x32x16_bf16 v[160:175], v[192:195], v[112:115], v[160:175]
    v_exp_f32 v219, v219
    v_add_f32 v216, 1.0, v216
    v_add_f32 v217, 1.0, v217
    v_add_f32 v218, 1.0, v218
    v_add_f32 v219, 1.0, v219
    v_rcp_f32 v216, v216
    v_mfma_f32_32x32x16_bf16 v[160:175], v[196:199], v[116:119], v[160:175]
    v_rcp_f32 v217, v217
    v_rcp_f32 v218, v218
    s_waitcnt vmcnt(1)
    v_mov_b32 v12, 2
    s_mov_b64 exec, 1
    buffer_store_dword v12, off, s[20:23], s70 sc1
    s_mov_b64 exec, -1
    s_waitcnt lgkmcnt(0)
    v_mfma_f32_32x32x16_bf16 v[160:175], v[200:203], v[120:123], v[160:175]
    v_rcp_f32 v219, v219
    v_mul_f32 v216, v140, v216
    v_mul_f32 v217, v141, v217
    v_mul_f32 v218, v142, v218
    v_mul_f32 v219, v143, v219
    v_cvt_pk_bf16_f32 v230, v216, v217
    v_mfma_f32_32x32x16_bf16 v[160:175], v[204:207], v[124:127], v[160:175]
    v_cvt_pk_bf16_f32 v231, v218, v219
    buffer_store_dwordx4 v[228:231], v1, s[20:23], s45 offen sc1
    v_fma_f32 v216, -v144, v144, s72
    v_fma_f32 v217, -v145, v145, s72
    v_fma_f32 v218, -v146, v146, s72
    v_fma_f32 v219, -v147, v147, s72
    v_mul_f32 v216, v144, v216
    v_mul_f32 v217, v145, v217
    v_mul_f32 v218, v146, v218
    v_mul_f32 v219, v147, v219
    v_exp_f32 v216, v216
    v_exp_f32 v217, v217
    v_exp_f32 v218, v218
    v_exp_f32 v219, v219
    v_add_f32 v216, 1.0, v216
    v_add_f32 v217, 1.0, v217
    v_add_f32 v218, 1.0, v218
    v_add_f32 v219, 1.0, v219
    v_rcp_f32 v216, v216
    v_rcp_f32 v217, v217
    v_rcp_f32 v218, v218
    v_rcp_f32 v219, v219
    v_mul_f32 v216, v144, v216
    v_mul_f32 v217, v145, v217
    v_mul_f32 v218, v146, v218
    v_mul_f32 v219, v147, v219
    v_cvt_pk_bf16_f32 v232, v216, v217
    v_cvt_pk_bf16_f32 v233, v218, v219
    v_fma_f32 v216, -v148, v148, s72
    v_fma_f32 v217, -v149, v149, s72
    v_fma_f32 v218, -v150, v150, s72
    v_fma_f32 v219, -v151, v151, s72
    v_mul_f32 v216, v148, v216
    v_mul_f32 v217, v149, v217
    v_mul_f32 v218, v150, v218
    v_mul_f32 v219, v151, v219
    v_exp_f32 v216, v216
    v_exp_f32 v217, v217
    v_exp_f32 v218, v218
    v_exp_f32 v219, v219
    v_add_f32 v216, 1.0, v216
    v_add_f32 v217, 1.0, v217
    v_add_f32 v218, 1.0, v218
    v_add_f32 v219, 1.0, v219
    v_rcp_f32 v216, v216
    v_rcp_f32 v217, v217
    v_rcp_f32 v218, v218
    v_rcp_f32 v219, v219
    v_mul_f32 v216, v148, v216
    v_mul_f32 v217, v149, v217
    v_mul_f32 v218, v150, v218
    v_mul_f32 v219, v151, v219
    v_cvt_pk_bf16_f32 v234, v216, v217
    v_cvt_pk_bf16_f32 v235, v218, v219
    buffer_store_dwordx4 v[232:235], v1, s[20:23], s46 offen sc1
    v_fma_f32 v216, -v152, v152, s72
    v_fma_f32 v217, -v153, v153, s72
    v_fma_f32 v218, -v154, v154, s72
    v_fma_f32 v219, -v155, v155, s72
    v_mul_f32 v216, v152, v216
    v_mul_f32 v217, v153, v217
    v_mul_f32 v218, v154, v218
    v_mul_f32 v219, v155, v219
    v_exp_f32 v216, v216
    v_exp_f32 v217, v217
    v_exp_f32 v218, v218
    v_exp_f32 v219, v219
    v_add_f32 v216, 1.0, v216
    v_add_f32 v217, 1.0, v217
    v_add_f32 v218, 1.0, v218
    v_add_f32 v219, 1.0, v219
    v_rcp_f32 v216, v216
    v_rcp_f32 v217, v217
    v_rcp_f32 v218, v218
    v_rcp_f32 v219, v219
    v_mul_f32 v216, v152, v216
    v_mul_f32 v217, v153, v217
    v_mul_f32 v218, v154, v218
    v_mul_f32 v219, v155, v219
    v_cvt_pk_bf16_f32 v236, v216, v217
    v_cvt_pk_bf16_f32 v237, v218, v219
    v_fma_f32 v216, -v156, v156, s72
    v_fma_f32 v217, -v157, v157, s72
    v_fma_f32 v218, -v158, v158, s72
    v_fma_f32 v219, -v159, v159, s72
    v_mul_f32 v216, v156, v216
    v_mul_f32 v217, v157, v217
    v_mul_f32 v218, v158, v218
    v_mul_f32 v219, v159, v219
    v_exp_f32 v216, v216
    v_exp_f32 v217, v217
    v_exp_f32 v218, v218
    v_exp_f32 v219, v219
    v_add_f32 v216, 1.0, v216
    v_add_f32 v217, 1.0, v217
    v_add_f32 v218, 1.0, v218
    v_add_f32 v219, 1.0, v219
    v_rcp_f32 v216, v216
    v_rcp_f32 v217, v217
    v_rcp_f32 v218, v218
    v_rcp_f32 v219, v219
    v_mul_f32 v216, v156, v216
    v_mul_f32 v217, v157, v217
    v_mul_f32 v218, v158, v218
    v_mul_f32 v219, v159, v219
    v_cvt_pk_bf16_f32 v238, v216, v217
    v_cvt_pk_bf16_f32 v239, v218, v219
    buffer_store_dwordx4 v[236:239], v1, s[20:23], s47 offen sc1
    s_waitcnt vmcnt(2)
    v_mov_b32 v12, 3
    s_mov_b64 exec, 1
    buffer_store_dword v12, off, s[20:23], s70 sc1
    s_mov_b64 exec, -1
    v_fma_f32 v216, -v160, v160, s72
    v_fma_f32 v217, -v161, v161, s72
    v_fma_f32 v218, -v162, v162, s72
    v_fma_f32 v219, -v163, v163, s72
    v_mul_f32 v216, v160, v216
    v_mul_f32 v217, v161, v217
    v_mul_f32 v218, v162, v218
    v_mul_f32 v219, v163, v219
    v_exp_f32 v216, v216
    v_exp_f32 v217, v217
    v_exp_f32 v218, v218
    v_exp_f32 v219, v219
    v_add_f32 v216, 1.0, v216
    v_add_f32 v217, 1.0, v217
    v_add_f32 v218, 1.0, v218
    v_add_f32 v219, 1.0, v219
    v_rcp_f32 v216, v216
    v_rcp_f32 v217, v217
    v_rcp_f32 v218, v218
    v_rcp_f32 v219, v219
    v_mul_f32 v216, v160, v216
    v_mul_f32 v217, v161, v217
    v_mul_f32 v218, v162, v218
    v_mul_f32 v219, v163, v219
    v_cvt_pk_bf16_f32 v224, v216, v217
    v_cvt_pk_bf16_f32 v225, v218, v219
    v_fma_f32 v216, -v164, v164, s72
    v_fma_f32 v217, -v165, v165, s72
    v_fma_f32 v218, -v166, v166, s72
    v_fma_f32 v219, -v167, v167, s72
    v_mul_f32 v216, v164, v216
    v_mul_f32 v217, v165, v217
    v_mul_f32 v218, v166, v218
    v_mul_f32 v219, v167, v219
    v_exp_f32 v216, v216
    v_exp_f32 v217, v217
    v_exp_f32 v218, v218
    v_exp_f32 v219, v219
    v_add_f32 v216, 1.0, v216
    v_add_f32 v217, 1.0, v217
    v_add_f32 v218, 1.0, v218
    v_add_f32 v219, 1.0, v219
    v_rcp_f32 v216, v216
    v_rcp_f32 v217, v217
    v_rcp_f32 v218, v218
    v_rcp_f32 v219, v219
    v_mul_f32 v216, v164, v216
    v_mul_f32 v217, v165, v217
    v_mul_f32 v218, v166, v218
    v_mul_f32 v219, v167, v219
    v_cvt_pk_bf16_f32 v226, v216, v217
    v_cvt_pk_bf16_f32 v227, v218, v219
    buffer_store_dwordx4 v[224:227], v1, s[20:23], s48 offen sc1
    v_fma_f32 v216, -v168, v168, s72
    v_fma_f32 v217, -v169, v169, s72
    v_fma_f32 v218, -v170, v170, s72
    v_fma_f32 v219, -v171, v171, s72
    v_mul_f32 v216, v168, v216
    v_mul_f32 v217, v169, v217
    v_mul_f32 v218, v170, v218
    v_mul_f32 v219, v171, v219
    v_exp_f32 v216, v216
    v_exp_f32 v217, v217
    v_exp_f32 v218, v218
    v_exp_f32 v219, v219
    v_add_f32 v216, 1.0, v216
    v_add_f32 v217, 1.0, v217
    v_add_f32 v218, 1.0, v218
    v_add_f32 v219, 1.0, v219
    v_rcp_f32 v216, v216
    v_rcp_f32 v217, v217
    v_rcp_f32 v218, v218
    v_rcp_f32 v219, v219
    v_mul_f32 v216, v168, v216
    v_mul_f32 v217, v169, v217
    v_mul_f32 v218, v170, v218
    v_mul_f32 v219, v171, v219
    v_cvt_pk_bf16_f32 v228, v216, v217
    v_cvt_pk_bf16_f32 v229, v218, v219
    v_fma_f32 v216, -v172, v172, s72
    v_fma_f32 v217, -v173, v173, s72
    v_fma_f32 v218, -v174, v174, s72
    v_fma_f32 v219, -v175, v175, s72
    v_mul_f32 v216, v172, v216
    v_mul_f32 v217, v173, v217
    v_mul_f32 v218, v174, v218
    v_mul_f32 v219, v175, v219
    v_exp_f32 v216, v216
    v_exp_f32 v217, v217
    v_exp_f32 v218, v218
    v_exp_f32 v219, v219
    v_add_f32 v216, 1.0, v216
    v_add_f32 v217, 1.0, v217
    v_add_f32 v218, 1.0, v218
    v_add_f32 v219, 1.0, v219
    v_rcp_f32 v216, v216
    v_rcp_f32 v217, v217
    v_rcp_f32 v218, v218
    v_rcp_f32 v219, v219
    v_mul_f32 v216, v172, v216
    v_mul_f32 v217, v173, v217
    v_mul_f32 v218, v174, v218
    v_mul_f32 v219, v175, v219
    v_cvt_pk_bf16_f32 v230, v216, v217
    v_cvt_pk_bf16_f32 v231, v218, v219
    buffer_store_dwordx4 v[228:231], v1, s[20:23], s49 offen sc1
    s_waitcnt vmcnt(3)
    v_mov_b32 v12, 4
    s_mov_b64 exec, 1
    buffer_store_dword v12, off, s[20:23], s70 sc1
    s_mov_b64 exec, -1
    s_waitcnt vmcnt(1)
    v_mov_b32 v12, 5
    s_mov_b64 exec, 1
    buffer_store_dword v12, off, s[20:23], s70 sc1
    s_mov_b64 exec, -1
    s_branch L_fin
L_MA:
    s_mov_b32 exec_lo, 0x88880000
    s_mov_b32 exec_hi, 0x88880000
    v_mov_b32 v2, 0x28000
    v_mov_b32 v3, 0x28000
    v_mov_b32 v4, 0x28000
    v_mov_b32 v5, 0x28000
    v_mov_b32 v6, 0x28000
    v_mov_b32 v7, 0x28000
    s_mov_b64 exec, -1
    v_add_u32 v8, s75, v1
    v_add_u32 v8, 131072, v8
    s_mov_b32 s73, 0x358637bd
    v_mov_b32 v144, s73
    v_mov_b32 v145, s73
    v_mov_b32 v146, s73
    v_mov_b32 v147, s73
    v_mov_b32 v148, s73
    v_mov_b32 v149, s73
    v_mov_b32 v150, s73
    v_mov_b32 v151, s73
    v_mov_b32 v152, s73
    v_mov_b32 v153, s73
    v_mov_b32 v154, s73
    v_mov_b32 v155, s73
    v_mov_b32 v156, s73
    v_mov_b32 v157, s73
    v_mov_b32 v158, s73
    v_mov_b32 v159, s73
    s_lshl_b32 s37, s6, 11
    s_add_u32 s37, s37, 0xa94000
    v_pk_fma_f32 v[192:193], v[192:193], v[242:243], v[240:241] op_sel_hi:[1,0,0]
    v_cvt_pk_bf16_f32 v49, v50, v51
    v_pk_fma_f32 v[194:195], v[194:195], v[242:243], v[240:241] op_sel_hi:[1,0,0]
    v_cvt_pk_bf16_f32 v50, v192, v193
    v_pk_fma_f32 v[52:53], v[52:53], v[242:243], v[240:241] op_sel_hi:[1,0,0]
    v_cvt_pk_bf16_f32 v51, v194, v195
    v_pk_fma_f32 v[54:55], v[54:55], v[242:243], v[240:241] op_sel_hi:[1,0,0]
    v_cvt_pk_bf16_f32 v52, v52, v53
    s_barrier
    ds_read_b64_tr_b16 v[192:193], v2 offset:8192
    ds_read_b64_tr_b16 v[194:195], v2 offset:8704
    v_pk_fma_f32 v[196:197], v[196:197], v[242:243], v[240:241] op_sel_hi:[1,0,0]
    v_cvt_pk_bf16_f32 v53, v54, v55
    v_pk_fma_f32 v[198:199], v[198:199], v[242:243], v[240:241] op_sel_hi:[1,0,0]
    v_cvt_pk_bf16_f32 v54, v196, v197
    v_pk_fma_f32 v[56:57], v[56:57], v[242:243], v[240:241] op_sel_hi:[1,0,0]
    v_cvt_pk_bf16_f32 v55, v198, v199
    ds_read_b64_tr_b16 v[196:197], v5 offset:8192
    ds_read_b64_tr_b16 v[198:199], v5 offset:8704
    v_pk_fma_f32 v[58:59], v[58:59], v[242:243], v[240:241] op_sel_hi:[1,0,0]
    v_cvt_pk_bf16_f32 v56, v56, v57
    v_pk_fma_f32 v[200:201], v[200:201], v[242:243], v[240:241] op_sel_hi:[1,0,0]
    v_cvt_pk_bf16_f32 v57, v58, v59
    v_pk_fma_f32 v[202:203], v[202:203], v[242:243], v[240:241] op_sel_hi:[1,0,0]
    v_cvt_pk_bf16_f32 v58, v200, v201
    v_pk_fma_f32 v[60:61], v[60:61], v[242:243], v[240:241] op_sel_hi:[1,0,0]
    v_cvt_pk_bf16_f32 v59, v202, v203
    ds_read_b64_tr_b16 v[200:201], v2 offset:10240
    ds_read_b64_tr_b16 v[202:203], v2 offset:10752
    v_pk_fma_f32 v[62:63], v[62:63], v[242:243], v[240:241] op_sel_hi:[1,0,0]
    v_cvt_pk_bf16_f32 v60, v60, v61
    v_pk_fma_f32 v[204:205], v[204:205], v[242:243], v[240:241] op_sel_hi:[1,0,0]
    v_cvt_pk_bf16_f32 v61, v62, v63
    v_pk_fma_f32 v[206:207], v[206:207], v[242:243], v[240:241] op_sel_hi:[1,0,0]
    v_cvt_pk_bf16_f32 v62, v204, v205
    v_cvt_pk_bf16_f32 v63, v206, v207
    ds_read_b64_tr_b16 v[204:205], v5 offset:10240
    ds_read_b64_tr_b16 v[206:207], v5 offset:10752
    s_waitcnt lgkmcnt(4)
    v_mfma_f32_32x32x16_bf16 v[128:143], v[16:19], v[192:195], v[144:159]
    ds_read_b64_tr_b16 v[192:193], v2 offset:12288
    ds_read_b64_tr_b16 v[194:195], v2 offset:12800
    v_mfma_f32_32x32x16_bf16 v[144:159], v[16:19], v[196:199], v[144:159]
    ds_read_b64_tr_b16 v[196:197], v5 offset:12288
    ds_read_b64_tr_b16 v[198:199], v5 offset:12800
    s_waitcnt lgkmcnt(4)
    v_mfma_f32_32x32x16_bf16 v[128:143], v[20:23], v[200:203], v[128:143]
    ds_read_b64_tr_b16 v[200:201], v2 offset:14336
    ds_read_b64_tr_b16 v[202:203], v2 offset:14848
    v_mfma_f32_32x32x16_bf16 v[144:159], v[20:23], v[204:207], v[144:159]
    ds_read_b64_tr_b16 v[204:205], v5 offset:14336
    ds_read_b64_tr_b16 v[206:207], v5 offset:14848
    s_waitcnt lgkmcnt(4)
    v_mfma_f32_32x32x16_bf16 v[128:143], v[24:27], v[192:195], v[128:143]
    ds_read_b64_tr_b16 v[192:193], v2 offset:16384
    ds_read_b64_tr_b16 v[194:195], v2 offset:16896
    v_mfma_f32_32x32x16_bf16 v[144:159], v[24:27], v[196:199], v[144:159]
    ds_read_b64_tr_b16 v[196:197], v5 offset:16384
    ds_read_b64_tr_b16 v[198:199], v5 offset:16896
    s_waitcnt lgkmcnt(4)
    v_mfma_f32_32x32x16_bf16 v[128:143], v[28:31], v[200:203], v[128:143]
    ds_read_b64_tr_b16 v[200:201], v2 offset:18432
    ds_read_b64_tr_b16 v[202:203], v2 offset:18944
    v_mfma_f32_32x32x16_bf16 v[144:159], v[28:31], v[204:207], v[144:159]
    ds_read_b64_tr_b16 v[204:205], v5 offset:18432
    ds_read_b64_tr_b16 v[206:207], v5 offset:18944
    s_waitcnt lgkmcnt(4)
    v_mfma_f32_32x32x16_bf16 v[128:143], v[32:35], v[192:195], v[128:143]
    ds_read_b64_tr_b16 v[192:193], v2 offset:20480
    ds_read_b64_tr_b16 v[194:195], v2 offset:20992
    v_mfma_f32_32x32x16_bf16 v[144:159], v[32:35], v[196:199], v[144:159]
    ds_read_b64_tr_b16 v[196:197], v5 offset:20480
    ds_read_b64_tr_b16 v[198:199], v5 offset:20992
    s_waitcnt lgkmcnt(4)
    v_mfma_f32_32x32x16_bf16 v[128:143], v[36:39], v[200:203], v[128:143]
    ds_read_b64_tr_b16 v[200:201], v2 offset:22528
    ds_read_b64_tr_b16 v[202:203], v2 offset:23040
    v_mfma_f32_32x32x16_bf16 v[144:159], v[36:39], v[204:207], v[144:159]
    ds_read_b64_tr_b16 v[204:205], v5 offset:22528
    ds_read_b64_tr_b16 v[206:207], v5 offset:23040
    s_waitcnt lgkmcnt(4)
    v_mfma_f32_32x32x16_bf16 v[128:143], v[40:43], v[192:195], v[128:143]
    ds_read_b64_tr_b16 v[192:193], v2 offset:24576
    ds_read_b64_tr_b16 v[194:195], v2 offset:25088
    v_mfma_f32_32x32x16_bf16 v[144:159], v[40:43], v[196:199], v[144:159]
    ds_read_b64_tr_b16 v[196:197], v5 offset:24576
    ds_read_b64_tr_b16 v[198:199], v5 offset:25088
    s_waitcnt lgkmcnt(4)
    v_mfma_f32_32x32x16_bf16 v[128:143], v[44:47], v[200:203], v[128:143]
    ds_read_b64_tr_b16 v[200:201], v2 offset:26624
    ds_read_b64_tr_b16 v[202:203], v2 offset:27136
    v_mfma_f32_32x32x16_bf16 v[144:159], v[44:47], v[204:207], v[144:159]
    ds_read_b64_tr_b16 v[204:205], v5 offset:26624
    ds_read_b64_tr_b16 v[206:207], v5 offset:27136
    s_waitcnt lgkmcnt(4)
    v_mfma_f32_32x32x16_bf16 v[128:143], v[48:51], v[192:195], v[128:143]
    ds_read_b64_tr_b16 v[192:193], v2 offset:28672
    ds_read_b64_tr_b16 v[194:195], v2 offset:29184
    v_mfma_f32_32x32x16_bf16 v[144:159], v[48:51], v[196:199], v[144:159]
    ds_read_b64_tr_b16 v[196:197], v5 offset:28672
    ds_read_b64_tr_b16 v[198:199], v5 offset:29184
    s_waitcnt lgkmcnt(4)
    v_mfma_f32_32x32x16_bf16 v[128:143], v[52:55], v[200:203], v[128:143]
    ds_read_b64_tr_b16 v[200:201], v2 offset:30720
    ds_read_b64_tr_b16 v[202:203], v2 offset:31232
    v_mfma_f32_32x32x16_bf16 v[144:159], v[52:55], v[204:207], v[144:159]
    ds_read_b64_tr_b16 v[204:205], v5 offset:30720
    ds_read_b64_tr_b16 v[206:207], v5 offset:31232
    v_lshlrev_b32 v64, 16, v208
    v_and_b32 v65, s74, v208
    v_lshlrev_b32 v66, 16, v209
    v_and_b32 v67, s74, v209
    v_lshlrev_b32 v208, 16, v210
    v_and_b32 v209, s74, v210
    v_lshlrev_b32 v210, 16, v211
    v_and_b32 v211, s74, v211
    v_lshlrev_b32 v68, 16, v212
    v_and_b32 v69, s74, v212
    v_lshlrev_b32 v70, 16, v213
    v_and_b32 v71, s74, v213
    v_lshlrev_b32 v212, 16, v214
    v_and_b32 v213, s74, v214
    v_lshlrev_b32 v214, 16, v215
    v_and_b32 v215, s74, v215
    v_lshlrev_b32 v72, 16, v216
    v_and_b32 v73, s74, v216
    v_lshlrev_b32 v74, 16, v217
    v_and_b32 v75, s74, v217
    v_lshlrev_b32 v216, 16, v218
    v_and_b32 v217, s74, v218
    v_lshlrev_b32 v218, 16, v219
    v_and_b32 v219, s74, v219
    v_lshlrev_b32 v76, 16, v220
    v_and_b32 v77, s74, v220
    v_lshlrev_b32 v78, 16, v221
    v_and_b32 v79, s74, v221
    v_lshlrev_b32 v220, 16, v222
    v_and_b32 v221, s74, v222
    v_lshlrev_b32 v222, 16, v223
    v_and_b32 v223, s74, v223
    v_lshlrev_b32 v80, 16, v224
    v_and_b32 v81, s74, v224
    v_lshlrev_b32 v82, 16, v225
    v_and_b32 v83, s74, v225
    v_lshlrev_b32 v224, 16, v226
    v_and_b32 v225, s74, v226
    v_lshlrev_b32 v226, 16, v227
    v_and_b32 v227, s74, v227
    v_lshlrev_b32 v84, 16, v228
    v_and_b32 v85, s74, v228
    v_lshlrev_b32 v86, 16, v229
    v_and_b32 v87, s74, v229
    v_lshlrev_b32 v228, 16, v230
    v_and_b32 v229, s74, v230
    v_lshlrev_b32 v230, 16, v231
    v_and_b32 v231, s74, v231
    v_lshlrev_b32 v88, 16, v232
    v_and_b32 v89, s74, v232
    v_lshlrev_b32 v90, 16, v233
    v_and_b32 v91, s74, v233
    v_lshlrev_b32 v232, 16, v234
    v_and_b32 v233, s74, v234
    v_lshlrev_b32 v234, 16, v235
    v_and_b32 v235, s74, v235
    v_lshlrev_b32 v92, 16, v236
    v_and_b32 v93, s74, v236
    v_lshlrev_b32 v94, 16, v237
    v_and_b32 v95, s74, v237
    v_lshlrev_b32 v236, 16, v238
    v_and_b32 v237, s74, v238
    v_lshlrev_b32 v238, 16, v239
    v_and_b32 v239, s74, v239
    v_pk_fma_f32 v[64:65], v[64:65], v[242:243], v[240:241] op_sel_hi:[1,0,0]
    v_pk_fma_f32 v[66:67], v[66:67], v[242:243], v[240:241] op_sel_hi:[1,0,0]
    v_cvt_pk_bf16_f32 v64, v64, v65
    v_pk_fma_f32 v[208:209], v[208:209], v[242:243], v[240:241] op_sel_hi:[1,0,0]
    v_cvt_pk_bf16_f32 v65, v66, v67
    v_pk_fma_f32 v[210:211], v[210:211], v[242:243], v[240:241] op_sel_hi:[1,0,0]
    v_cvt_pk_bf16_f32 v66, v208, v209
    v_pk_fma_f32 v[68:69], v[68:69], v[242:243], v[240:241] op_sel_hi:[1,0,0]
    v_cvt_pk_bf16_f32 v67, v210, v211
    v_pk_fma_f32 v[70:71], v[70:71], v[242:243], v[240:241] op_sel_hi:[1,0,0]
    v_cvt_pk_bf16_f32 v68, v68, v69
    v_pk_fma_f32 v[212:213], v[212:213], v[242:243], v[240:241] op_sel_hi:[1,0,0]
    v_cvt_pk_bf16_f32 v69, v70, v71
    v_pk_fma_f32 v[214:215], v[214:215], v[242:243], v[240:241] op_sel_hi:[1,0,0]
    v_cvt_pk_bf16_f32 v70, v212, v213
    v_pk_fma_f32 v[72:73], v[72:73], v[242:243], v[240:241] op_sel_hi:[1,0,0]
    v_cvt_pk_bf16_f32 v71, v214, v215
    v_pk_fma_f32 v[74:75], v[74:75], v[242:243], v[240:241] op_sel_hi:[1,0,0]
    v_cvt_pk_bf16_f32 v72, v72, v73
    v_pk_fma_f32 v[216:217], v[216:217], v[242:243], v[240:241] op_sel_hi:[1,0,0]
    v_cvt_pk_bf16_f32 v73, v74, v75
    v_pk_fma_f32 v[218:219], v[218:219], v[242:243], v[240:241] op_sel_hi:[1,0,0]
    v_cvt_pk_bf16_f32 v74, v216, v217
    v_pk_fma_f32 v[76:77], v[76:77], v[242:243], v[240:241] op_sel_hi:[1,0,0]
    v_cvt_pk_bf16_f32 v75, v218, v219
    v_pk_fma_f32 v[78:79], v[78:79], v[242:243], v[240:241] op_sel_hi:[1,0,0]
    v_cvt_pk_bf16_f32 v76, v76, v77
    v_pk_fma_f32 v[220:221], v[220:221], v[242:243], v[240:241] op_sel_hi:[1,0,0]
    v_cvt_pk_bf16_f32 v77, v78, v79
    v_pk_fma_f32 v[222:223], v[222:223], v[242:243], v[240:241] op_sel_hi:[1,0,0]
    v_cvt_pk_bf16_f32 v78, v220, v221
    v_pk_fma_f32 v[80:81], v[80:81], v[242:243], v[240:241] op_sel_hi:[1,0,0]
    v_cvt_pk_bf16_f32 v79, v222, v223
    v_pk_fma_f32 v[82:83], v[82:83], v[242:243], v[240:241] op_sel_hi:[1,0,0]
    v_cvt_pk_bf16_f32 v80, v80, v81
    v_pk_fma_f32 v[224:225], v[224:225], v[242:243], v[240:241] op_sel_hi:[1,0,0]
    v_cvt_pk_bf16_f32 v81, v82, v83
    v_pk_fma_f32 v[226:227], v[226:227], v[242:243], v[240:241] op_sel_hi:[1,0,0]
    v_cvt_pk_bf16_f32 v82, v224, v225
    v_pk_fma_f32 v[84:85], v[84:85], v[242:243], v[240:241] op_sel_hi:[1,0,0]
    v_cvt_pk_bf16_f32 v83, v226, v227
    v_pk_fma_f32 v[86:87], v[86:87], v[242:243], v[240:241] op_sel_hi:[1,0,0]
    v_cvt_pk_bf16_f32 v84, v84, v85
    v_pk_fma_f32 v[228:229], v[228:229], v[242:243], v[240:241] op_sel_hi:[1,0,0]
    v_cvt_pk_bf16_f32 v85, v86, v87
    v_pk_fma_f32 v[230:231], v[230:231], v[242:243], v[240:241] op_sel_hi:[1,0,0]
    v_cvt_pk_bf16_f32 v86, v228, v229
    v_pk_fma_f32 v[88:89], v[88:89], v[242:243], v[240:241] op_sel_hi:[1,0,0]
    v_cvt_pk_bf16_f32 v87, v230, v231
    v_pk_fma_f32 v[90:91], v[90:91], v[242:243], v[240:241] op_sel_hi:[1,0,0]
    v_cvt_pk_bf16_f32 v88, v88, v89
    v_pk_fma_f32 v[232:233], v[232:233], v[242:243], v[240:241] op_sel_hi:[1,0,0]
    v_cvt_pk_bf16_f32 v89, v90, v91
    v_pk_fma_f32 v[234:235], v[234:235], v[242:243], v[240:241] op_sel_hi:[1,0,0]
    v_cvt_pk_bf16_f32 v90, v232, v233
    v_pk_fma_f32 v[92:93], v[92:93], v[242:243], v[240:241] op_sel_hi:[1,0,0]
    v_cvt_pk_bf16_f32 v91, v234, v235
    v_pk_fma_f32 v[94:95], v[94:95], v[242:243], v[240:241] op_sel_hi:[1,0,0]
    v_cvt_pk_bf16_f32 v92, v92, v93
    v_pk_fma_f32 v[236:237], v[236:237], v[242:243], v[240:241] op_sel_hi:[1,0,0]
    v_cvt_pk_bf16_f32 v93, v94, v95
    v_pk_fma_f32 v[238:239], v[238:239], v[242:243], v[240:241] op_sel_hi:[1,0,0]
    v_cvt_pk_bf16_f32 v94, v236, v237
    v_cvt_pk_bf16_f32 v95, v238, v239
    s_waitcnt lgkmcnt(4)
    v_mfma_f32_32x32x16_bf16 v[128:143], v[56:59], v[192:195], v[128:143]
    s_barrier
    ds_read_b64_tr_b16 v[192:193], v2 offset:32768
    ds_read_b64_tr_b16 v[194:195], v2 offset:33280
    v_mfma_f32_32x32x16_bf16 v[144:159], v[56:59], v[196:199], v[144:159]
    ds_read_b64_tr_b16 v[196:197], v5 offset:32768
    ds_read_b64_tr_b16 v[198:199], v5 offset:33280
    s_waitcnt lgkmcnt(4)
    v_mfma_f32_32x32x16_bf16 v[128:143], v[60:63], v[200:203], v[128:143]
    ds_read_b64_tr_b16 v[200:201], v2 offset:34816
    ds_read_b64_tr_b16 v[202:203], v2 offset:35328
    v_mfma_f32_32x32x16_bf16 v[144:159], v[60:63], v[204:207], v[144:159]
    ds_read_b64_tr_b16 v[204:205], v5 offset:34816
    ds_read_b64_tr_b16 v[206:207], v5 offset:35328
    s_waitcnt lgkmcnt(0)
    v_mfma_f32_32x32x16_bf16 v[128:143], v[64:67], v[192:195], v[128:143]
    ds_read_b64_tr_b16 v[192:193], v2 offset:36864
    ds_read_b64_tr_b16 v[194:195], v2 offset:37376
    v_mfma_f32_32x32x16_bf16 v[144:159], v[64:67], v[196:199], v[144:159]
    ds_read_b64_tr_b16 v[196:197], v5 offset:36864
    ds_read_b64_tr_b16 v[198:199], v5 offset:37376
    s_waitcnt lgkmcnt(0)
    v_mfma_f32_32x32x16_bf16 v[128:143], v[68:71], v[200:203], v[128:143]
    ds_read_b64_tr_b16 v[200:201], v2 offset:38912
    ds_read_b64_tr_b16 v[202:203], v2 offset:39424
    v_mfma_f32_32x32x16_bf16 v[144:159], v[68:71], v[204:207], v[144:159]
    ds_read_b64_tr_b16 v[204:205], v5 offset:38912
    ds_read_b64_tr_b16 v[206:207], v5 offset:39424
    s_waitcnt lgkmcnt(0)
    v_mfma_f32_32x32x16_bf16 v[128:143], v[72:75], v[192:195], v[128:143]
    ds_read_b64_tr_b16 v[192:193], v2 offset:40960
    ds_read_b64_tr_b16 v[194:195], v2 offset:41472
    v_mfma_f32_32x32x16_bf16 v[144:159], v[72:75], v[196:199], v[144:159]
    ds_read_b64_tr_b16 v[196:197], v5 offset:40960
    ds_read_b64_tr_b16 v[198:199], v5 offset:41472
    s_waitcnt lgkmcnt(0)
    v_mfma_f32_32x32x16_bf16 v[128:143], v[76:79], v[200:203], v[128:143]
    ds_read_b64_tr_b16 v[200:201], v2 offset:43008
    ds_read_b64_tr_b16 v[202:203], v2 offset:43520
    v_mfma_f32_32x32x16_bf16 v[144:159], v[76:79], v[204:207], v[144:159]
    ds_read_b64_tr_b16 v[204:205], v5 offset:43008
    ds_read_b64_tr_b16 v[206:207], v5 offset:43520
    s_waitcnt lgkmcnt(0)
    v_mfma_f32_32x32x16_bf16 v[128:143], v[80:83], v[192:195], v[128:143]
    ds_read_b64_tr_b16 v[192:193], v2 offset:45056
    ds_read_b64_tr_b16 v[194:195], v2 offset:45568
    v_mfma_f32_32x32x16_bf16 v[144:159], v[80:83], v[196:199], v[144:159]
    ds_read_b64_tr_b16 v[196:197], v5 offset:45056
    ds_read_b64_tr_b16 v[198:199], v5 offset:45568
    s_waitcnt lgkmcnt(0)
    v_mfma_f32_32x32x16_bf16 v[128:143], v[84:87], v[200:203], v[128:143]
    ds_read_b64_tr_b16 v[200:201], v2 offset:47104
    ds_read_b64_tr_b16 v[202:203], v2 offset:47616
    v_mfma_f32_32x32x16_bf16 v[144:159], v[84:87], v[204:207], v[144:159]
    ds_read_b64_tr_b16 v[204:205], v5 offset:47104
    ds_read_b64_tr_b16 v[206:207], v5 offset:47616
    v_lshlrev_b32 v96, 16, v160
    v_and_b32 v97, s74, v160
    v_lshlrev_b32 v98, 16, v161
    v_and_b32 v99, s74, v161
    v_lshlrev_b32 v160, 16, v162
    v_and_b32 v161, s74, v162
    v_lshlrev_b32 v162, 16, v163
    v_and_b32 v163, s74, v163
    v_lshlrev_b32 v100, 16, v164
    v_and_b32 v101, s74, v164
    v_lshlrev_b32 v102, 16, v165
    v_and_b32 v103, s74, v165
    v_lshlrev_b32 v164, 16, v166
    v_and_b32 v165, s74, v166
    v_lshlrev_b32 v166, 16, v167
    v_and_b32 v167, s74, v167
    v_lshlrev_b32 v104, 16, v168
    v_and_b32 v105, s74, v168
    v_lshlrev_b32 v106, 16, v169
    v_and_b32 v107, s74, v169
    v_lshlrev_b32 v168, 16, v170
    v_and_b32 v169, s74, v170
    v_lshlrev_b32 v170, 16, v171
    v_and_b32 v171, s74, v171
    v_lshlrev_b32 v108, 16, v172
    v_and_b32 v109, s74, v172
    v_lshlrev_b32 v110, 16, v173
    v_and_b32 v111, s74, v173
    v_lshlrev_b32 v172, 16, v174
    v_and_b32 v173, s74, v174
    v_lshlrev_b32 v174, 16, v175
    v_and_b32 v175, s74, v175
    v_pk_fma_f32 v[96:97], v[96:97], v[242:243], v[240:241] op_sel_hi:[1,0,0]
    v_pk_fma_f32 v[98:99], v[98:99], v[242:243], v[240:241] op_sel_hi:[1,0,0]
    v_cvt_pk_bf16_f32 v96, v96, v97
    v_pk_fma_f32 v[160:161], v[160:161], v[242:243], v[240:241] op_sel_hi:[1,0,0]
    v_cvt_pk_bf16_f32 v97, v98, v99
    v_pk_fma_f32 v[162:163], v[162:163], v[242:243], v[240:241] op_sel_hi:[1,0,0]
    v_cvt_pk_bf16_f32 v98, v160, v161
    v_pk_fma_f32 v[100:101], v[100:101], v[242:243], v[240:241] op_sel_hi:[1,0,0]
    v_cvt_pk_bf16_f32 v99, v162, v163
    v_pk_fma_f32 v[102:103], v[102:103], v[242:243], v[240:241] op_sel_hi:[1,0,0]
    v_cvt_pk_bf16_f32 v100, v100, v101
    v_pk_fma_f32 v[164:165], v[164:165], v[242:243], v[240:241] op_sel_hi:[1,0,0]
    v_cvt_pk_bf16_f32 v101, v102, v103
    v_pk_fma_f32 v[166:167], v[166:167], v[242:243], v[240:241] op_sel_hi:[1,0,0]
    v_cvt_pk_bf16_f32 v102, v164, v165
    v_pk_fma_f32 v[104:105], v[104:105], v[242:243], v[240:241] op_sel_hi:[1,0,0]
    v_cvt_pk_bf16_f32 v103, v166, v167
    v_pk_fma_f32 v[106:107], v[106:107], v[242:243], v[240:241] op_sel_hi:[1,0,0]
    v_cvt_pk_bf16_f32 v104, v104, v105
    v_pk_fma_f32 v[168:169], v[168:169], v[242:243], v[240:241] op_sel_hi:[1,0,0]
    v_cvt_pk_bf16_f32 v105, v106, v107
    v_pk_fma_f32 v[170:171], v[170:171], v[242:243], v[240:241] op_sel_hi:[1,0,0]
    v_cvt_pk_bf16_f32 v106, v168, v169
    v_pk_fma_f32 v[108:109], v[108:109], v[242:243], v[240:241] op_sel_hi:[1,0,0]
    v_cvt_pk_bf16_f32 v107, v170, v171
    v_pk_fma_f32 v[110:111], v[110:111], v[242:243], v[240:241] op_sel_hi:[1,0,0]
    v_cvt_pk_bf16_f32 v108, v108, v109
    v_pk_fma_f32 v[172:173], v[172:173], v[242:243], v[240:241] op_sel_hi:[1,0,0]
    v_cvt_pk_bf16_f32 v109, v110, v111
    v_pk_fma_f32 v[174:175], v[174:175], v[242:243], v[240:241] op_sel_hi:[1,0,0]
    v_cvt_pk_bf16_f32 v110, v172, v173
    v_cvt_pk_bf16_f32 v111, v174, v175
    s_waitcnt lgkmcnt(0)
    v_mfma_f32_32x32x16_bf16 v[128:143], v[88:91], v[192:195], v[128:143]
    ds_read_b64_tr_b16 v[192:193], v2 offset:49152
    ds_read_b64_tr_b16 v[194:195], v2 offset:49664
    v_mfma_f32_32x32x16_bf16 v[144:159], v[88:91], v[196:199], v[144:159]
    ds_read_b64_tr_b16 v[196:197], v5 offset:49152
    ds_read_b64_tr_b16 v[198:199], v5 offset:49664
    s_waitcnt lgkmcnt(0)
    v_mfma_f32_32x32x16_bf16 v[128:143], v[92:95], v[200:203], v[128:143]
    ds_read_b64_tr_b16 v[200:201], v2 offset:51200
    ds_read_b64_tr_b16 v[202:203], v2 offset:51712
    v_mfma_f32_32x32x16_bf16 v[144:159], v[92:95], v[204:207], v[144:159]
    ds_read_b64_tr_b16 v[204:205], v5 offset:51200
    ds_read_b64_tr_b16 v[206:207], v5 offset:51712
    s_waitcnt lgkmcnt(0)
    v_mfma_f32_32x32x16_bf16 v[128:143], v[96:99], v[192:195], v[128:143]
    ds_read_b64_tr_b16 v[192:193], v2 offset:53248
    ds_read_b64_tr_b16 v[194:195], v2 offset:53760
    v_mfma_f32_32x32x16_bf16 v[144:159], v[96:99], v[196:199], v[144:159]
    ds_read_b64_tr_b16 v[196:197], v5 offset:53248
    ds_read_b64_tr_b16 v[198:199], v5 offset:53760
    s_waitcnt lgkmcnt(0)
    v_mfma_f32_32x32x16_bf16 v[128:143], v[100:103], v[200:203], v[128:143]
    ds_read_b64_tr_b16 v[200:201], v2 offset:55296
    ds_read_b64_tr_b16 v[202:203], v2 offset:55808
    v_mfma_f32_32x32x16_bf16 v[144:159], v[100:103], v[204:207], v[144:159]
    ds_read_b64_tr_b16 v[204:205], v5 offset:55296
    ds_read_b64_tr_b16 v[206:207], v5 offset:55808
    v_lshlrev_b32 v112, 16, v176
    v_and_b32 v113, s74, v176
    v_lshlrev_b32 v114, 16, v177
    v_and_b32 v115, s74, v177
    v_lshlrev_b32 v176, 16, v178
    v_and_b32 v177, s74, v178
    v_lshlrev_b32 v178, 16, v179
    v_and_b32 v179, s74, v179
    v_lshlrev_b32 v116, 16, v180
    v_and_b32 v117, s74, v180
    v_lshlrev_b32 v118, 16, v181
    v_and_b32 v119, s74, v181
    v_lshlrev_b32 v180, 16, v182
    v_and_b32 v181, s74, v182
    v_lshlrev_b32 v182, 16, v183
    v_and_b32 v183, s74, v183
    v_lshlrev_b32 v120, 16, v184
    v_and_b32 v121, s74, v184
    v_lshlrev_b32 v122, 16, v185
    v_and_b32 v123, s74, v185
    v_lshlrev_b32 v184, 16, v186
    v_and_b32 v185, s74, v186
    v_lshlrev_b32 v186, 16, v187
    v_and_b32 v187, s74, v187
    v_lshlrev_b32 v124, 16, v188
    v_and_b32 v125, s74, v188
    v_lshlrev_b32 v126, 16, v189
    v_and_b32 v127, s74, v189
    v_lshlrev_b32 v188, 16, v190
    v_and_b32 v189, s74, v190
    v_lshlrev_b32 v190, 16, v191
    v_and_b32 v191, s74, v191
    v_pk_fma_f32 v[112:113], v[112:113], v[242:243], v[240:241] op_sel_hi:[1,0,0]
    v_pk_fma_f32 v[114:115], v[114:115], v[242:243], v[240:241] op_sel_hi:[1,0,0]
    v_cvt_pk_bf16_f32 v112, v112, v113
    v_pk_fma_f32 v[176:177], v[176:177], v[242:243], v[240:241] op_sel_hi:[1,0,0]
    v_cvt_pk_bf16_f32 v113, v114, v115
    v_pk_fma_f32 v[178:179], v[178:179], v[242:243], v[240:241] op_sel_hi:[1,0,0]
    v_cvt_pk_bf16_f32 v114, v176, v177
    v_pk_fma_f32 v[116:117], v[116:117], v[242:243], v[240:241] op_sel_hi:[1,0,0]
    v_cvt_pk_bf16_f32 v115, v178, v179
    v_pk_fma_f32 v[118:119], v[118:119], v[242:243], v[240:241] op_sel_hi:[1,0,0]
    v_cvt_pk_bf16_f32 v116, v116, v117
    v_pk_fma_f32 v[180:181], v[180:181], v[242:243], v[240:241] op_sel_hi:[1,0,0]
    v_cvt_pk_bf16_f32 v117, v118, v119
    v_pk_fma_f32 v[182:183], v[182:183], v[242:243], v[240:241] op_sel_hi:[1,0,0]
    v_cvt_pk_bf16_f32 v118, v180, v181
    v_pk_fma_f32 v[120:121], v[120:121], v[242:243], v[240:241] op_sel_hi:[1,0,0]
    v_cvt_pk_bf16_f32 v119, v182, v183
    v_pk_fma_f32 v[122:123], v[122:123], v[242:243], v[240:241] op_sel_hi:[1,0,0]
    v_cvt_pk_bf16_f32 v120, v120, v121
    v_pk_fma_f32 v[184:185], v[184:185], v[242:243], v[240:241] op_sel_hi:[1,0,0]
    v_cvt_pk_bf16_f32 v121, v122, v123
    v_pk_fma_f32 v[186:187], v[186:187], v[242:243], v[240:241] op_sel_hi:[1,0,0]
    v_cvt_pk_bf16_f32 v122, v184, v185
    v_pk_fma_f32 v[124:125], v[124:125], v[242:243], v[240:241] op_sel_hi:[1,0,0]
    v_cvt_pk_bf16_f32 v123, v186, v187
    v_pk_fma_f32 v[126:127], v[126:127], v[242:243], v[240:241] op_sel_hi:[1,0,0]
    v_cvt_pk_bf16_f32 v124, v124, v125
    v_pk_fma_f32 v[188:189], v[188:189], v[242:243], v[240:241] op_sel_hi:[1,0,0]
    v_cvt_pk_bf16_f32 v125, v126, v127
    v_pk_fma_f32 v[190:191], v[190:191], v[242:243], v[240:241] op_sel_hi:[1,0,0]
    v_cvt_pk_bf16_f32 v126, v188, v189
    v_cvt_pk_bf16_f32 v127, v190, v191
    s_waitcnt lgkmcnt(0)
    v_mfma_f32_32x32x16_bf16 v[128:143], v[104:107], v[192:195], v[128:143]
    s_barrier
    ds_read_b64_tr_b16 v[192:193], v2 offset:57344
    ds_read_b64_tr_b16 v[194:195], v2 offset:57856
    v_mfma_f32_32x32x16_bf16 v[144:159], v[104:107], v[196:199], v[144:159]
    ds_read_b64_tr_b16 v[196:197], v5 offset:57344
    ds_read_b64_tr_b16 v[198:199], v5 offset:57856
    s_waitcnt lgkmcnt(0)
    v_mfma_f32_32x32x16_bf16 v[128:143], v[108:111], v[200:203], v[128:143]
    ds_read_b64_tr_b16 v[200:201], v2 offset:59392
    ds_read_b64_tr_b16 v[202:203], v2 offset:59904
    v_mfma_f32_32x32x16_bf16 v[144:159], v[108:111], v[204:207], v[144:159]
    ds_read_b64_tr_b16 v[204:205], v5 offset:59392
    ds_read_b64_tr_b16 v[206:207], v5 offset:59904
    s_waitcnt lgkmcnt(0)
    v_mfma_f32_32x32x16_bf16 v[128:143], v[112:115], v[192:195], v[128:143]
    ds_read_b64_tr_b16 v[192:193], v2 offset:61440
    ds_read_b64_tr_b16 v[194:195], v2 offset:61952
    v_mfma_f32_32x32x16_bf16 v[144:159], v[112:115], v[196:199], v[144:159]
    ds_read_b64_tr_b16 v[196:197], v5 offset:61440
    ds_read_b64_tr_b16 v[198:199], v5 offset:61952
    s_mov_b32 s72, 0x3fb8aa3b
    s_mov_b32 s73, 0x358637bd
    v_mov_b32 v220, 0xb5c1a2a0
    s_waitcnt lgkmcnt(0)
    v_mfma_f32_32x32x16_bf16 v[128:143], v[116:119], v[200:203], v[128:143]
    ds_read_b64_tr_b16 v[200:201], v2 offset:63488
    ds_read_b64_tr_b16 v[202:203], v2 offset:64000
    v_mfma_f32_32x32x16_bf16 v[144:159], v[116:119], v[204:207], v[144:159]
    ds_read_b64_tr_b16 v[204:205], v5 offset:63488
    ds_read_b64_tr_b16 v[206:207], v5 offset:64000
    s_waitcnt lgkmcnt(0)
    v_mfma_f32_32x32x16_bf16 v[128:143], v[120:123], v[192:195], v[128:143]
    ds_read_b64_tr_b16 v[192:193], v3 offset:0
    ds_read_b64_tr_b16 v[194:195], v3 offset:512
    v_mfma_f32_32x32x16_bf16 v[144:159], v[120:123], v[196:199], v[144:159]
    ds_read_b64_tr_b16 v[196:197], v6 offset:0
    ds_read_b64_tr_b16 v[198:199], v6 offset:512
    s_waitcnt lgkmcnt(0)
    v_mfma_f32_32x32x16_bf16 v[128:143], v[124:127], v[200:203], v[128:143]
    ds_read_b64_tr_b16 v[200:201], v3 offset:2048
    ds_read_b64_tr_b16 v[202:203], v3 offset:2560
    v_mfma_f32_32x32x16_bf16 v[144:159], v[124:127], v[204:207], v[144:159]
    ds_read_b64_tr_b16 v[204:205], v6 offset:2048
    ds_read_b64_tr_b16 v[206:207], v6 offset:2560
    v_mfma_f32_32x32x16_bf16 v[160:175], v[16:19], v[192:195], 0
    ds_read_b64_tr_b16 v[192:193], v3 offset:4096
    ds_read_b64_tr_b16 v[194:195], v3 offset:4608
    v_mfma_f32_32x32x16_bf16 v[176:191], v[16:19], v[196:199], 0
    ds_read_b64_tr_b16 v[196:197], v6 offset:4096
    ds_read_b64_tr_b16 v[198:199], v6 offset:4608
    s_waitcnt lgkmcnt(4)
    v_mfma_f32_32x32x16_bf16 v[160:175], v[20:23], v[200:203], v[160:175]
    v_fma_f32 v216, v128, s72, v220
    v_fma_f32 v217, v129, s72, v220
    v_fma_f32 v218, v130, s72, v220
    v_fma_f32 v219, v131, s72, v220
    v_exp_f32 v216, v216 clamp
    v_mfma_f32_32x32x16_bf16 v[176:191], v[20:23], v[204:207], v[176:191]
    ds_read_b64_tr_b16 v[200:201], v3 offset:6144
    ds_read_b64_tr_b16 v[202:203], v3 offset:6656
    ds_read_b64_tr_b16 v[204:205], v6 offset:6144
    ds_read_b64_tr_b16 v[206:207], v6 offset:6656
    v_exp_f32 v217, v217 clamp
    v_exp_f32 v218, v218 clamp
    s_waitcnt lgkmcnt(4)
    v_mfma_f32_32x32x16_bf16 v[160:175], v[24:27], v[192:195], v[160:175]
    v_exp_f32 v219, v219 clamp
    v_max_f32 v128, s73, v128
    v_max_f32 v129, s73, v129
    v_max_f32 v130, s73, v130
    v_max_f32 v131, s73, v131
    v_add_f32 v128, v128, v216
    v_mfma_f32_32x32x16_bf16 v[176:191], v[24:27], v[196:199], v[176:191]
    ds_read_b64_tr_b16 v[192:193], v3 offset:8192
    ds_read_b64_tr_b16 v[194:195], v3 offset:8704
    ds_read_b64_tr_b16 v[196:197], v6 offset:8192
    ds_read_b64_tr_b16 v[198:199], v6 offset:8704
    v_add_f32 v129, v129, v217
    v_add_f32 v130, v130, v218
    v_add_f32 v131, v131, v219
    s_waitcnt lgkmcnt(4)
    v_mfma_f32_32x32x16_bf16 v[160:175], v[28:31], v[200:203], v[160:175]
    v_fma_f32 v216, v132, s72, v220
    v_fma_f32 v217, v133, s72, v220
    v_fma_f32 v218, v134, s72, v220
    v_fma_f32 v219, v135, s72, v220
    v_exp_f32 v216, v216 clamp
    v_mfma_f32_32x32x16_bf16 v[176:191], v[28:31], v[204:207], v[176:191]
    ds_read_b64_tr_b16 v[200:201], v3 offset:10240
    ds_read_b64_tr_b16 v[202:203], v3 offset:10752
    ds_read_b64_tr_b16 v[204:205], v6 offset:10240
    ds_read_b64_tr_b16 v[206:207], v6 offset:10752
    v_exp_f32 v217, v217 clamp
    v_exp_f32 v218, v218 clamp
    s_waitcnt lgkmcnt(4)
    v_mfma_f32_32x32x16_bf16 v[160:175], v[32:35], v[192:195], v[160:175]
    v_exp_f32 v219, v219 clamp
    v_max_f32 v132, s73, v132
    v_max_f32 v133, s73, v133
    v_max_f32 v134, s73, v134
    v_max_f32 v135, s73, v135
    v_mfma_f32_32x32x16_bf16 v[176:191], v[32:35], v[196:199], v[176:191]
    ds_read_b64_tr_b16 v[192:193], v3 offset:12288
    ds_read_b64_tr_b16 v[194:195], v3 offset:12800
    ds_read_b64_tr_b16 v[196:197], v6 offset:12288
    ds_read_b64_tr_b16 v[198:199], v6 offset:12800
    v_add_f32 v132, v132, v216
    v_add_f32 v133, v133, v217
    v_add_f32 v134, v134, v218
    s_waitcnt lgkmcnt(4)
    v_mfma_f32_32x32x16_bf16 v[160:175], v[36:39], v[200:203], v[160:175]
    v_add_f32 v135, v135, v219
    v_cvt_pk_bf16_f32 v224, v128, v129
    v_cvt_pk_bf16_f32 v225, v130, v131
    v_cvt_pk_bf16_f32 v226, v132, v133
    v_cvt_pk_bf16_f32 v227, v134, v135
    v_fma_f32 v216, v136, s72, v220
    v_fma_f32 v217, v137, s72, v220
    v_mfma_f32_32x32x16_bf16 v[176:191], v[36:39], v[204:207], v[176:191]
    ds_read_b64_tr_b16 v[200:201], v3 offset:14336
    ds_read_b64_tr_b16 v[202:203], v3 offset:14848
    ds_read_b64_tr_b16 v[204:205], v6 offset:14336
    ds_read_b64_tr_b16 v[206:207], v6 offset:14848
    ds_write_b128 v8, v[224:227] offset:16384
    v_fma_f32 v218, v138, s72, v220
    v_fma_f32 v219, v139, s72, v220
    s_waitcnt lgkmcnt(5)
    v_mfma_f32_32x32x16_bf16 v[160:175], v[40:43], v[192:195], v[160:175]
    v_exp_f32 v216, v216 clamp
    v_exp_f32 v217, v217 clamp
    v_exp_f32 v218, v218 clamp
    v_exp_f32 v219, v219 clamp
    v_mfma_f32_32x32x16_bf16 v[176:191], v[40:43], v[196:199], v[176:191]
    s_barrier
    ds_read_b64_tr_b16 v[192:193], v3 offset:16384
    ds_read_b64_tr_b16 v[194:195], v3 offset:16896
    ds_read_b64_tr_b16 v[196:197], v6 offset:16384
    ds_read_b64_tr_b16 v[198:199], v6 offset:16896
    v_max_f32 v136, s73, v136
    v_max_f32 v137, s73, v137
    v_max_f32 v138, s73, v138
    s_waitcnt lgkmcnt(5)
    v_mfma_f32_32x32x16_bf16 v[160:175], v[44:47], v[200:203], v[160:175]
    v_max_f32 v139, s73, v139
    v_add_f32 v136, v136, v216
    v_add_f32 v137, v137, v217
    v_add_f32 v138, v138, v218
    v_add_f32 v139, v139, v219
    v_fma_f32 v216, v140, s72, v220
    v_fma_f32 v217, v141, s72, v220
    v_mfma_f32_32x32x16_bf16 v[176:191], v[44:47], v[204:207], v[176:191]
    ds_read_b64_tr_b16 v[200:201], v3 offset:18432
    ds_read_b64_tr_b16 v[202:203], v3 offset:18944
    ds_read_b64_tr_b16 v[204:205], v6 offset:18432
    ds_read_b64_tr_b16 v[206:207], v6 offset:18944
    v_fma_f32 v218, v142, s72, v220
    v_fma_f32 v219, v143, s72, v220
    s_waitcnt lgkmcnt(4)
    v_mfma_f32_32x32x16_bf16 v[160:175], v[48:51], v[192:195], v[160:175]
    v_exp_f32 v216, v216 clamp
    v_exp_f32 v217, v217 clamp
    v_exp_f32 v218, v218 clamp
    v_exp_f32 v219, v219 clamp
    v_mfma_f32_32x32x16_bf16 v[176:191], v[48:51], v[196:199], v[176:191]
    ds_read_b64_tr_b16 v[192:193], v3 offset:20480
    ds_read_b64_tr_b16 v[194:195], v3 offset:20992
    ds_read_b64_tr_b16 v[196:197], v6 offset:20480
    ds_read_b64_tr_b16 v[198:199], v6 offset:20992
    v_max_f32 v140, s73, v140
    v_max_f32 v141, s73, v141
    s_waitcnt lgkmcnt(4)
    v_mfma_f32_32x32x16_bf16 v[160:175], v[52:55], v[200:203], v[160:175]
    v_max_f32 v142, s73, v142
    v_max_f32 v143, s73, v143
    v_add_f32 v140, v140, v216
    v_add_f32 v141, v141, v217
    v_add_f32 v142, v142, v218
    v_add_f32 v143, v143, v219
    v_cvt_pk_bf16_f32 v228, v136, v137
    v_mfma_f32_32x32x16_bf16 v[176:191], v[52:55], v[204:207], v[176:191]
    ds_read_b64_tr_b16 v[200:201], v3 offset:22528
    ds_read_b64_tr_b16 v[202:203], v3 offset:23040
    ds_read_b64_tr_b16 v[204:205], v6 offset:22528
    ds_read_b64_tr_b16 v[206:207], v6 offset:23040
    v_cvt_pk_bf16_f32 v229, v138, v139
    v_cvt_pk_bf16_f32 v230, v140, v141
    v_cvt_pk_bf16_f32 v231, v142, v143
    s_waitcnt lgkmcnt(4)
    v_mfma_f32_32x32x16_bf16 v[160:175], v[56:59], v[192:195], v[160:175]
    v_fma_f32 v216, v144, s72, v220
    v_fma_f32 v217, v145, s72, v220
    v_fma_f32 v218, v146, s72, v220
    v_fma_f32 v219, v147, s72, v220
    v_exp_f32 v216, v216 clamp
    v_mfma_f32_32x32x16_bf16 v[176:191], v[56:59], v[196:199], v[176:191]
    ds_read_b64_tr_b16 v[192:193], v3 offset:24576
    ds_read_b64_tr_b16 v[194:195], v3 offset:25088
    ds_read_b64_tr_b16 v[196:197], v6 offset:24576
    ds_read_b64_tr_b16 v[198:199], v6 offset:25088
    ds_write_b128 v8, v[228:231] offset:17408
    v_exp_f32 v217, v217 clamp
    v_exp_f32 v218, v218 clamp
    s_waitcnt lgkmcnt(5)
    v_mfma_f32_32x32x16_bf16 v[160:175], v[60:63], v[200:203], v[160:175]
    v_exp_f32 v219, v219 clamp
    v_max_f32 v144, s73, v144
    v_max_f32 v145, s73, v145
    v_max_f32 v146, s73, v146
    v_max_f32 v147, s73, v147
    v_add_f32 v144, v144, v216
    v_mfma_f32_32x32x16_bf16 v[176:191], v[60:63], v[204:207], v[176:191]
    ds_read_b64_tr_b16 v[200:201], v3 offset:26624
    ds_read_b64_tr_b16 v[202:203], v3 offset:27136
    ds_read_b64_tr_b16 v[204:205], v6 offset:26624
    ds_read_b64_tr_b16 v[206:207], v6 offset:27136
    v_add_f32 v145, v145, v217
    v_add_f32 v146, v146, v218
    v_add_f32 v147, v147, v219
    s_waitcnt lgkmcnt(5)
    v_mfma_f32_32x32x16_bf16 v[160:175], v[64:67], v[192:195], v[160:175]
    v_fma_f32 v216, v148, s72, v220
    v_fma_f32 v217, v149, s72, v220
    v_fma_f32 v218, v150, s72, v220
    v_fma_f32 v219, v151, s72, v220
    v_exp_f32 v216, v216 clamp
    v_mfma_f32_32x32x16_bf16 v[176:191], v[64:67], v[196:199], v[176:191]
    ds_read_b64_tr_b16 v[192:193], v3 offset:28672
    ds_read_b64_tr_b16 v[194:195], v3 offset:29184
    ds_read_b64_tr_b16 v[196:197], v6 offset:28672
    ds_read_b64_tr_b16 v[198:199], v6 offset:29184
    v_exp_f32 v217, v217 clamp
    v_exp_f32 v218, v218 clamp
    s_waitcnt lgkmcnt(4)
    v_mfma_f32_32x32x16_bf16 v[160:175], v[68:71], v[200:203], v[160:175]
    v_exp_f32 v219, v219 clamp
    v_max_f32 v148, s73, v148
    v_max_f32 v149, s73, v149
    v_max_f32 v150, s73, v150
    v_max_f32 v151, s73, v151
    v_mfma_f32_32x32x16_bf16 v[176:191], v[68:71], v[204:207], v[176:191]
    ds_read_b64_tr_b16 v[200:201], v3 offset:30720
    ds_read_b64_tr_b16 v[202:203], v3 offset:31232
    ds_read_b64_tr_b16 v[204:205], v6 offset:30720
    ds_read_b64_tr_b16 v[206:207], v6 offset:31232
    v_add_f32 v148, v148, v216
    v_add_f32 v149, v149, v217
    v_add_f32 v150, v150, v218
    s_waitcnt lgkmcnt(4)
    v_mfma_f32_32x32x16_bf16 v[160:175], v[72:75], v[192:195], v[160:175]
    v_add_f32 v151, v151, v219
    v_cvt_pk_bf16_f32 v232, v144, v145
    v_cvt_pk_bf16_f32 v233, v146, v147
    v_cvt_pk_bf16_f32 v234, v148, v149
    v_cvt_pk_bf16_f32 v235, v150, v151
    v_fma_f32 v216, v152, s72, v220
    v_fma_f32 v217, v153, s72, v220
    v_mfma_f32_32x32x16_bf16 v[176:191], v[72:75], v[196:199], v[176:191]
    ds_read_b64_tr_b16 v[192:193], v3 offset:32768
    ds_read_b64_tr_b16 v[194:195], v3 offset:33280
    ds_read_b64_tr_b16 v[196:197], v6 offset:32768
    ds_read_b64_tr_b16 v[198:199], v6 offset:33280
    ds_write_b128 v8, v[232:235] offset:24576
    v_fma_f32 v218, v154, s72, v220
    v_fma_f32 v219, v155, s72, v220
    s_waitcnt lgkmcnt(5)
    v_mfma_f32_32x32x16_bf16 v[160:175], v[76:79], v[200:203], v[160:175]
    v_exp_f32 v216, v216 clamp
    v_exp_f32 v217, v217 clamp
    v_exp_f32 v218, v218 clamp
    v_exp_f32 v219, v219 clamp
    v_mfma_f32_32x32x16_bf16 v[176:191], v[76:79], v[204:207], v[176:191]
    ds_read_b64_tr_b16 v[200:201], v3 offset:34816
    ds_read_b64_tr_b16 v[202:203], v3 offset:35328
    ds_read_b64_tr_b16 v[204:205], v6 offset:34816
    ds_read_b64_tr_b16 v[206:207], v6 offset:35328
    v_max_f32 v152, s73, v152
    v_max_f32 v153, s73, v153
    v_max_f32 v154, s73, v154
    s_waitcnt lgkmcnt(5)
    v_mfma_f32_32x32x16_bf16 v[160:175], v[80:83], v[192:195], v[160:175]
    v_max_f32 v155, s73, v155
    v_add_f32 v152, v152, v216
    v_add_f32 v153, v153, v217
    v_add_f32 v154, v154, v218
    v_add_f32 v155, v155, v219
    v_fma_f32 v216, v156, s72, v220
    v_fma_f32 v217, v157, s72, v220
    v_mfma_f32_32x32x16_bf16 v[176:191], v[80:83], v[196:199], v[176:191]
    ds_read_b64_tr_b16 v[192:193], v3 offset:36864
    ds_read_b64_tr_b16 v[194:195], v3 offset:37376
    ds_read_b64_tr_b16 v[196:197], v6 offset:36864
    ds_read_b64_tr_b16 v[198:199], v6 offset:37376
    v_fma_f32 v218, v158, s72, v220
    v_fma_f32 v219, v159, s72, v220
    s_waitcnt lgkmcnt(4)
    v_mfma_f32_32x32x16_bf16 v[160:175], v[84:87], v[200:203], v[160:175]
    v_exp_f32 v216, v216 clamp
    v_exp_f32 v217, v217 clamp
    v_exp_f32 v218, v218 clamp
    v_exp_f32 v219, v219 clamp
    v_mfma_f32_32x32x16_bf16 v[176:191], v[84:87], v[204:207], v[176:191]
    ds_read_b64_tr_b16 v[200:201], v3 offset:38912
    ds_read_b64_tr_b16 v[202:203], v3 offset:39424
    ds_read_b64_tr_b16 v[204:205], v6 offset:38912
    ds_read_b64_tr_b16 v[206:207], v6 offset:39424
    v_max_f32 v156, s73, v156
    v_max_f32 v157, s73, v157
    s_waitcnt lgkmcnt(4)
    v_mfma_f32_32x32x16_bf16 v[160:175], v[88:91], v[192:195], v[160:175]
    v_max_f32 v158, s73, v158
    v_max_f32 v159, s73, v159
    v_add_f32 v156, v156, v216
    v_add_f32 v157, v157, v217
    v_add_f32 v158, v158, v218
    v_add_f32 v159, v159, v219
    v_cvt_pk_bf16_f32 v236, v152, v153
    v_mfma_f32_32x32x16_bf16 v[176:191], v[88:91], v[196:199], v[176:191]
    ds_read_b64_tr_b16 v[192:193], v3 offset:40960
    ds_read_b64_tr_b16 v[194:195], v3 offset:41472
    ds_read_b64_tr_b16 v[196:197], v6 offset:40960
    ds_read_b64_tr_b16 v[198:199], v6 offset:41472
    v_cvt_pk_bf16_f32 v237, v154, v155
    v_cvt_pk_bf16_f32 v238, v156, v157
    v_cvt_pk_bf16_f32 v239, v158, v159
    s_waitcnt lgkmcnt(4)
    v_mfma_f32_32x32x16_bf16 v[160:175], v[92:95], v[200:203], v[160:175]
    ds_read_b64_tr_b16 v[200:201], v3 offset:43008
    ds_read_b64_tr_b16 v[202:203], v3 offset:43520
    v_mfma_f32_32x32x16_bf16 v[176:191], v[92:95], v[204:207], v[176:191]
    ds_read_b64_tr_b16 v[204:205], v6 offset:43008
    ds_read_b64_tr_b16 v[206:207], v6 offset:43520
    ds_write_b128 v8, v[236:239] offset:25600
    s_waitcnt lgkmcnt(5)
    v_mfma_f32_32x32x16_bf16 v[160:175], v[96:99], v[192:195], v[160:175]
    ds_read_b64_tr_b16 v[192:193], v3 offset:45056
    ds_read_b64_tr_b16 v[194:195], v3 offset:45568
    v_mfma_f32_32x32x16_bf16 v[176:191], v[96:99], v[196:199], v[176:191]
    ds_read_b64_tr_b16 v[196:197], v6 offset:45056
    ds_read_b64_tr_b16 v[198:199], v6 offset:45568
    s_waitcnt lgkmcnt(4)
    s_barrier
    v_mfma_f32_32x32x16_bf16 v[160:175], v[100:103], v[200:203], v[160:175]
    ds_read_b64_tr_b16 v[200:201], v3 offset:47104
    ds_read_b64_tr_b16 v[202:203], v3 offset:47616
    v_mov_b32 v240, s73
    v_mov_b32 v241, s73
    v_mfma_f32_32x32x16_bf16 v[176:191], v[100:103], v[204:207], v[176:191]
    ds_read_b64_tr_b16 v[204:205], v6 offset:47104
    ds_read_b64_tr_b16 v[206:207], v6 offset:47616
    v_mov_b32 v242, s73
    v_mov_b32 v243, s73
    s_waitcnt lgkmcnt(4)
    v_mfma_f32_32x32x16_bf16 v[160:175], v[104:107], v[192:195], v[160:175]
    ds_read_b64_tr_b16 v[192:193], v2 offset:24576
    ds_read_b64_tr_b16 v[194:195], v2 offset:25088
    v_mov_b32 v244, s73
    v_mov_b32 v245, s73
    v_mfma_f32_32x32x16_bf16 v[176:191], v[104:107], v[196:199], v[176:191]
    ds_read_b64_tr_b16 v[196:197], v5 offset:24576
    ds_read_b64_tr_b16 v[198:199], v5 offset:25088
    v_mov_b32 v246, s73
    v_mov_b32 v247, s73
    s_waitcnt lgkmcnt(4)
    v_mfma_f32_32x32x16_bf16 v[160:175], v[108:111], v[200:203], v[160:175]
    ds_read_b64_tr_b16 v[200:201], v2 offset:26624
    ds_read_b64_tr_b16 v[202:203], v2 offset:27136
    v_mov_b32 v248, s73
    v_mov_b32 v249, s73
    v_mfma_f32_32x32x16_bf16 v[176:191], v[108:111], v[204:207], v[176:191]
    ds_read_b64_tr_b16 v[204:205], v5 offset:26624
    ds_read_b64_tr_b16 v[206:207], v5 offset:27136
    v_mov_b32 v250, s73
    v_mov_b32 v251, s73
    s_waitcnt lgkmcnt(4)
    v_mfma_f32_32x32x16_bf16 v[160:175], v[112:115], v[192:195], v[160:175]
    ds_read_b64_tr_b16 v[192:193], v2 offset:28672
    ds_read_b64_tr_b16 v[194:195], v2 offset:29184
    v_mov_b32 v252, s73
    v_mov_b32 v253, s73
    v_mfma_f32_32x32x16_bf16 v[176:191], v[112:115], v[196:199], v[176:191]
    ds_read_b64_tr_b16 v[196:197], v5 offset:28672
    ds_read_b64_tr_b16 v[198:199], v5 offset:29184
    v_mov_b32 v254, s73
    v_mov_b32 v255, s73
    s_waitcnt lgkmcnt(4)
    v_mfma_f32_32x32x16_bf16 v[160:175], v[116:119], v[200:203], v[160:175]
    ds_read_b64_tr_b16 v[200:201], v2 offset:30720
    ds_read_b64_tr_b16 v[202:203], v2 offset:31232
    v_mfma_f32_32x32x16_bf16 v[176:191], v[116:119], v[204:207], v[176:191]
    ds_read_b64_tr_b16 v[204:205], v5 offset:30720
    ds_read_b64_tr_b16 v[206:207], v5 offset:31232
    s_waitcnt lgkmcnt(4)
    v_mfma_f32_32x32x16_bf16 v[160:175], v[120:123], v[192:195], v[160:175]
    ds_read_b64_tr_b16 v[192:193], v2 offset:32768
    ds_read_b64_tr_b16 v[194:195], v2 offset:33280
    v_mfma_f32_32x32x16_bf16 v[176:191], v[120:123], v[196:199], v[176:191]
    ds_read_b64_tr_b16 v[196:197], v5 offset:32768
    ds_read_b64_tr_b16 v[198:199], v5 offset:33280
    s_waitcnt lgkmcnt(4)
    v_mfma_f32_32x32x16_bf16 v[160:175], v[124:127], v[200:203], v[160:175]
    ds_read_b64_tr_b16 v[200:201], v2 offset:34816
    ds_read_b64_tr_b16 v[202:203], v2 offset:35328
    v_mfma_f32_32x32x16_bf16 v[176:191], v[124:127], v[204:207], v[176:191]
    ds_read_b64_tr_b16 v[204:205], v5 offset:34816
    ds_read_b64_tr_b16 v[206:207], v5 offset:35328
    s_waitcnt lgkmcnt(4)
    v_mfma_f32_32x32x16_bf16 v[128:143], v[192:195], v[16:19], v[240:255]
    s_nop 4
    v_cvt_pk_bf16_f32 v224, v160, v161
    v_mfma_f32_32x32x16_bf16 v[144:159], v[196:199], v[16:19], v[240:255]
    ds_read_b64_tr_b16 v[192:193], v2 offset:36864
    ds_read_b64_tr_b16 v[194:195], v2 offset:37376
    ds_read_b64_tr_b16 v[196:197], v5 offset:36864
    ds_read_b64_tr_b16 v[198:199], v5 offset:37376
    v_cvt_pk_bf16_f32 v225, v162, v163
    v_cvt_pk_bf16_f32 v226, v164, v165
    s_waitcnt lgkmcnt(4)
    v_mfma_f32_32x32x16_bf16 v[128:143], v[200:203], v[20:23], v[128:143]
    v_cvt_pk_bf16_f32 v227, v166, v167
    v_cvt_pk_bf16_f32 v228, v168, v169
    v_cvt_pk_bf16_f32 v229, v170, v171
    v_mfma_f32_32x32x16_bf16 v[144:159], v[204:207], v[20:23], v[144:159]
    ds_read_b64_tr_b16 v[200:201], v2 offset:38912
    ds_read_b64_tr_b16 v[202:203], v2 offset:39424
    ds_read_b64_tr_b16 v[204:205], v5 offset:38912
    ds_read_b64_tr_b16 v[206:207], v5 offset:39424
    ds_write_b128 v8, v[224:227] offset:0
    v_cvt_pk_bf16_f32 v230, v172, v173
    v_cvt_pk_bf16_f32 v231, v174, v175
    s_waitcnt lgkmcnt(5)
    v_mfma_f32_32x32x16_bf16 v[128:143], v[192:195], v[24:27], v[128:143]
    v_cvt_pk_bf16_f32 v232, v176, v177
    v_cvt_pk_bf16_f32 v233, v178, v179
    v_cvt_pk_bf16_f32 v234, v180, v181
    v_cvt_pk_bf16_f32 v235, v182, v183
    v_mfma_f32_32x32x16_bf16 v[144:159], v[196:199], v[24:27], v[144:159]
    ds_read_b64_tr_b16 v[192:193], v2 offset:40960
    ds_read_b64_tr_b16 v[194:195], v2 offset:41472
    ds_read_b64_tr_b16 v[196:197], v5 offset:40960
    ds_read_b64_tr_b16 v[198:199], v5 offset:41472
    ds_write_b128 v8, v[228:231] offset:1024
    v_cvt_pk_bf16_f32 v236, v184, v185
    s_waitcnt lgkmcnt(6)
    v_mfma_f32_32x32x16_bf16 v[128:143], v[200:203], v[28:31], v[128:143]
    v_cvt_pk_bf16_f32 v237, v186, v187
    v_cvt_pk_bf16_f32 v238, v188, v189
    v_cvt_pk_bf16_f32 v239, v190, v191
    v_mfma_f32_32x32x16_bf16 v[144:159], v[204:207], v[28:31], v[144:159]
    ds_read_b64_tr_b16 v[200:201], v2 offset:43008
    ds_read_b64_tr_b16 v[202:203], v2 offset:43520
    ds_read_b64_tr_b16 v[204:205], v5 offset:43008
    ds_read_b64_tr_b16 v[206:207], v5 offset:43520
    ds_write_b128 v8, v[232:235] offset:8192
    s_waitcnt lgkmcnt(6)
    v_mfma_f32_32x32x16_bf16 v[128:143], v[192:195], v[32:35], v[128:143]
    ds_read_b64_tr_b16 v[192:193], v2 offset:45056
    ds_read_b64_tr_b16 v[194:195], v2 offset:45568
    v_mfma_f32_32x32x16_bf16 v[144:159], v[196:199], v[32:35], v[144:159]
    ds_read_b64_tr_b16 v[196:197], v5 offset:45056
    ds_read_b64_tr_b16 v[198:199], v5 offset:45568
    ds_write_b128 v8, v[236:239] offset:9216
    s_waitcnt lgkmcnt(6)
    v_mfma_f32_32x32x16_bf16 v[128:143], v[200:203], v[36:39], v[128:143]
    ds_read_b64_tr_b16 v[200:201], v2 offset:47104
    ds_read_b64_tr_b16 v[202:203], v2 offset:47616
    v_mfma_f32_32x32x16_bf16 v[144:159], v[204:207], v[36:39], v[144:159]
    ds_read_b64_tr_b16 v[204:205], v5 offset:47104
    ds_read_b64_tr_b16 v[206:207], v5 offset:47616
    s_waitcnt lgkmcnt(4)
    s_barrier
    v_mfma_f32_32x32x16_bf16 v[128:143], v[192:195], v[40:43], v[128:143]
    ds_read_b64_tr_b16 v[192:193], v2 offset:49152
    ds_read_b64_tr_b16 v[194:195], v2 offset:49664
    v_mfma_f32_32x32x16_bf16 v[144:159], v[196:199], v[40:43], v[144:159]
    ds_read_b64_tr_b16 v[196:197], v5 offset:49152
    ds_read_b64_tr_b16 v[198:199], v5 offset:49664
    s_waitcnt lgkmcnt(4)
    v_mfma_f32_32x32x16_bf16 v[128:143], v[200:203], v[44:47], v[128:143]
    ds_read_b64_tr_b16 v[200:201], v2 offset:51200
    ds_read_b64_tr_b16 v[202:203], v2 offset:51712
    v_mfma_f32_32x32x16_bf16 v[144:159], v[204:207], v[44:47], v[144:159]
    ds_read_b64_tr_b16 v[204:205], v5 offset:51200
    ds_read_b64_tr_b16 v[206:207], v5 offset:51712
    s_waitcnt lgkmcnt(4)
    v_mfma_f32_32x32x16_bf16 v[128:143], v[192:195], v[48:51], v[128:143]
    ds_read_b64_tr_b16 v[192:193], v2 offset:53248
    ds_read_b64_tr_b16 v[194:195], v2 offset:53760
    v_mfma_f32_32x32x16_bf16 v[144:159], v[196:199], v[48:51], v[144:159]
    ds_read_b64_tr_b16 v[196:197], v5 offset:53248
    ds_read_b64_tr_b16 v[198:199], v5 offset:53760
    s_waitcnt lgkmcnt(4)
    v_mfma_f32_32x32x16_bf16 v[128:143], v[200:203], v[52:55], v[128:143]
    ds_read_b64_tr_b16 v[200:201], v2 offset:55296
    ds_read_b64_tr_b16 v[202:203], v2 offset:55808
    v_mfma_f32_32x32x16_bf16 v[144:159], v[204:207], v[52:55], v[144:159]
    ds_read_b64_tr_b16 v[204:205], v5 offset:55296
    ds_read_b64_tr_b16 v[206:207], v5 offset:55808
    s_waitcnt lgkmcnt(4)
    v_mfma_f32_32x32x16_bf16 v[128:143], v[192:195], v[56:59], v[128:143]
    ds_read_b64_tr_b16 v[192:193], v2 offset:57344
    ds_read_b64_tr_b16 v[194:195], v2 offset:57856
    v_mfma_f32_32x32x16_bf16 v[144:159], v[196:199], v[56:59], v[144:159]
    ds_read_b64_tr_b16 v[196:197], v5 offset:57344
    ds_read_b64_tr_b16 v[198:199], v5 offset:57856
    s_waitcnt lgkmcnt(4)
    v_mfma_f32_32x32x16_bf16 v[128:143], v[200:203], v[60:63], v[128:143]
    ds_read_b64_tr_b16 v[200:201], v2 offset:59392
    ds_read_b64_tr_b16 v[202:203], v2 offset:59904
    v_mfma_f32_32x32x16_bf16 v[144:159], v[204:207], v[60:63], v[144:159]
    ds_read_b64_tr_b16 v[204:205], v5 offset:59392
    ds_read_b64_tr_b16 v[206:207], v5 offset:59904
    s_waitcnt lgkmcnt(4)
    v_mfma_f32_32x32x16_bf16 v[128:143], v[192:195], v[64:67], v[128:143]
    ds_read_b64_tr_b16 v[192:193], v2 offset:61440
    ds_read_b64_tr_b16 v[194:195], v2 offset:61952
    v_mfma_f32_32x32x16_bf16 v[144:159], v[196:199], v[64:67], v[144:159]
    ds_read_b64_tr_b16 v[196:197], v5 offset:61440
    ds_read_b64_tr_b16 v[198:199], v5 offset:61952
    s_waitcnt lgkmcnt(4)
    v_mfma_f32_32x32x16_bf16 v[128:143], v[200:203], v[68:71], v[128:143]
    ds_read_b64_tr_b16 v[200:201], v2 offset:63488
    ds_read_b64_tr_b16 v[202:203], v2 offset:64000
    v_mfma_f32_32x32x16_bf16 v[144:159], v[204:207], v[68:71], v[144:159]
    ds_read_b64_tr_b16 v[204:205], v5 offset:63488
    ds_read_b64_tr_b16 v[206:207], v5 offset:64000
    s_waitcnt lgkmcnt(4)
    v_mfma_f32_32x32x16_bf16 v[128:143], v[192:195], v[72:75], v[128:143]
    ds_read_b64_tr_b16 v[192:193], v3 offset:0
    ds_read_b64_tr_b16 v[194:195], v3 offset:512
    v_mfma_f32_32x32x16_bf16 v[144:159], v[196:199], v[72:75], v[144:159]
    ds_read_b64_tr_b16 v[196:197], v6 offset:0
    ds_read_b64_tr_b16 v[198:199], v6 offset:512
    s_waitcnt lgkmcnt(4)
    v_mfma_f32_32x32x16_bf16 v[128:143], v[200:203], v[76:79], v[128:143]
    ds_read_b64_tr_b16 v[200:201], v3 offset:2048
    ds_read_b64_tr_b16 v[202:203], v3 offset:2560
    v_mfma_f32_32x32x16_bf16 v[144:159], v[204:207], v[76:79], v[144:159]
    ds_read_b64_tr_b16 v[204:205], v6 offset:2048
    ds_read_b64_tr_b16 v[206:207], v6 offset:2560
    s_waitcnt lgkmcnt(4)
    v_mfma_f32_32x32x16_bf16 v[128:143], v[192:195], v[80:83], v[128:143]
    ds_read_b64_tr_b16 v[192:193], v3 offset:4096
    ds_read_b64_tr_b16 v[194:195], v3 offset:4608
    v_mfma_f32_32x32x16_bf16 v[144:159], v[196:199], v[80:83], v[144:159]
    ds_read_b64_tr_b16 v[196:197], v6 offset:4096
    ds_read_b64_tr_b16 v[198:199], v6 offset:4608
    s_waitcnt lgkmcnt(4)
    v_mfma_f32_32x32x16_bf16 v[128:143], v[200:203], v[84:87], v[128:143]
    ds_read_b64_tr_b16 v[200:201], v3 offset:6144
    ds_read_b64_tr_b16 v[202:203], v3 offset:6656
    v_mfma_f32_32x32x16_bf16 v[144:159], v[204:207], v[84:87], v[144:159]
    ds_read_b64_tr_b16 v[204:205], v6 offset:6144
    ds_read_b64_tr_b16 v[206:207], v6 offset:6656
    s_waitcnt lgkmcnt(4)
    v_mfma_f32_32x32x16_bf16 v[128:143], v[192:195], v[88:91], v[128:143]
    s_barrier
    ds_read_b64_tr_b16 v[192:193], v3 offset:8192
    ds_read_b64_tr_b16 v[194:195], v3 offset:8704
    v_mfma_f32_32x32x16_bf16 v[144:159], v[196:199], v[88:91], v[144:159]
    ds_read_b64_tr_b16 v[196:197], v6 offset:8192
    ds_read_b64_tr_b16 v[198:199], v6 offset:8704
    s_waitcnt lgkmcnt(4)
    v_mfma_f32_32x32x16_bf16 v[128:143], v[200:203], v[92:95], v[128:143]
    ds_read_b64_tr_b16 v[200:201], v3 offset:10240
    ds_read_b64_tr_b16 v[202:203], v3 offset:10752
    v_mfma_f32_32x32x16_bf16 v[144:159], v[204:207], v[92:95], v[144:159]
    ds_read_b64_tr_b16 v[204:205], v6 offset:10240
    ds_read_b64_tr_b16 v[206:207], v6 offset:10752
    s_waitcnt lgkmcnt(4)
    v_mfma_f32_32x32x16_bf16 v[128:143], v[192:195], v[96:99], v[128:143]
    ds_read_b64_tr_b16 v[192:193], v3 offset:12288
    ds_read_b64_tr_b16 v[194:195], v3 offset:12800
    v_mfma_f32_32x32x16_bf16 v[144:159], v[196:199], v[96:99], v[144:159]
    ds_read_b64_tr_b16 v[196:197], v6 offset:12288
    ds_read_b64_tr_b16 v[198:199], v6 offset:12800
    s_waitcnt lgkmcnt(4)
    v_mfma_f32_32x32x16_bf16 v[128:143], v[200:203], v[100:103], v[128:143]
    ds_read_b64_tr_b16 v[200:201], v3 offset:14336
    ds_read_b64_tr_b16 v[202:203], v3 offset:14848
    v_mfma_f32_32x32x16_bf16 v[144:159], v[204:207], v[100:103], v[144:159]
    ds_read_b64_tr_b16 v[204:205], v6 offset:14336
    ds_read_b64_tr_b16 v[206:207], v6 offset:14848
    s_waitcnt lgkmcnt(4)
    v_mfma_f32_32x32x16_bf16 v[128:143], v[192:195], v[104:107], v[128:143]
    ds_read_b64_tr_b16 v[192:193], v3 offset:16384
    ds_read_b64_tr_b16 v[194:195], v3 offset:16896
    v_mfma_f32_32x32x16_bf16 v[144:159], v[196:199], v[104:107], v[144:159]
    ds_read_b64_tr_b16 v[196:197], v6 offset:16384
    ds_read_b64_tr_b16 v[198:199], v6 offset:16896
    s_waitcnt lgkmcnt(4)
    v_mfma_f32_32x32x16_bf16 v[128:143], v[200:203], v[108:111], v[128:143]
    ds_read_b64_tr_b16 v[200:201], v3 offset:18432
    ds_read_b64_tr_b16 v[202:203], v3 offset:18944
    v_mfma_f32_32x32x16_bf16 v[144:159], v[204:207], v[108:111], v[144:159]
    ds_read_b64_tr_b16 v[204:205], v6 offset:18432
    ds_read_b64_tr_b16 v[206:207], v6 offset:18944
    s_waitcnt lgkmcnt(4)
    v_mfma_f32_32x32x16_bf16 v[128:143], v[192:195], v[112:115], v[128:143]
    ds_read_b64_tr_b16 v[192:193], v3 offset:20480
    ds_read_b64_tr_b16 v[194:195], v3 offset:20992
    v_mfma_f32_32x32x16_bf16 v[144:159], v[196:199], v[112:115], v[144:159]
    ds_read_b64_tr_b16 v[196:197], v6 offset:20480
    ds_read_b64_tr_b16 v[198:199], v6 offset:20992
    buffer_load_dwordx4 v[160:163], v1, s[20:23], s37 offen offset:0 sc1
    s_waitcnt lgkmcnt(4)
    v_mfma_f32_32x32x16_bf16 v[128:143], v[200:203], v[116:119], v[128:143]
    ds_read_b64_tr_b16 v[200:201], v3 offset:22528
    ds_read_b64_tr_b16 v[202:203], v3 offset:23040
    v_mfma_f32_32x32x16_bf16 v[144:159], v[204:207], v[116:119], v[144:159]
    ds_read_b64_tr_b16 v[204:205], v6 offset:22528
    ds_read_b64_tr_b16 v[206:207], v6 offset:23040
    buffer_load_dwordx4 v[164:167], v1, s[20:23], s37 offen offset:1024 sc1
    s_waitcnt lgkmcnt(4)
    v_mfma_f32_32x32x16_bf16 v[128:143], v[192:195], v[120:123], v[128:143]
    v_mfma_f32_32x32x16_bf16 v[144:159], v[196:199], v[120:123], v[144:159]
    s_waitcnt lgkmcnt(0)
    v_mfma_f32_32x32x16_bf16 v[128:143], v[200:203], v[124:127], v[128:143]
    v_mfma_f32_32x32x16_bf16 v[144:159], v[204:207], v[124:127], v[144:159]
    s_nop 10
    v_fma_f32 v216, v128, s72, v220
    v_fma_f32 v217, v129, s72, v220
    v_fma_f32 v218, v130, s72, v220
    v_fma_f32 v219, v131, s72, v220
    v_exp_f32 v216, v216 clamp
    v_exp_f32 v217, v217 clamp
    v_exp_f32 v218, v218 clamp
    v_exp_f32 v219, v219 clamp
    v_max_f32 v128, s73, v128
    v_max_f32 v129, s73, v129
    v_max_f32 v130, s73, v130
    v_max_f32 v131, s73, v131
    v_add_f32 v128, v128, v216
    v_add_f32 v129, v129, v217
    v_add_f32 v130, v130, v218
    v_add_f32 v131, v131, v219
    v_fma_f32 v216, v132, s72, v220
    v_fma_f32 v217, v133, s72, v220
    v_fma_f32 v218, v134, s72, v220
    v_fma_f32 v219, v135, s72, v220
    v_exp_f32 v216, v216 clamp
    v_exp_f32 v217, v217 clamp
    v_exp_f32 v218, v218 clamp
    v_exp_f32 v219, v219 clamp
    v_max_f32 v132, s73, v132
    v_max_f32 v133, s73, v133
    v_max_f32 v134, s73, v134
    v_max_f32 v135, s73, v135
    v_add_f32 v132, v132, v216
    v_add_f32 v133, v133, v217
    v_add_f32 v134, v134, v218
    v_add_f32 v135, v135, v219
    v_fma_f32 v216, v136, s72, v220
    v_fma_f32 v217, v137, s72, v220
    v_fma_f32 v218, v138, s72, v220
    v_fma_f32 v219, v139, s72, v220
    v_exp_f32 v216, v216 clamp
    v_exp_f32 v217, v217 clamp
    v_exp_f32 v218, v218 clamp
    v_exp_f32 v219, v219 clamp
    v_max_f32 v136, s73, v136
    v_max_f32 v137, s73, v137
    v_max_f32 v138, s73, v138
    v_max_f32 v139, s73, v139
    v_add_f32 v136, v136, v216
    v_add_f32 v137, v137, v217
    v_add_f32 v138, v138, v218
    v_add_f32 v139, v139, v219
    v_fma_f32 v216, v140, s72, v220
    v_fma_f32 v217, v141, s72, v220
    v_fma_f32 v218, v142, s72, v220
    v_fma_f32 v219, v143, s72, v220
    v_exp_f32 v216, v216 clamp
    v_exp_f32 v217, v217 clamp
    v_exp_f32 v218, v218 clamp
    v_exp_f32 v219, v219 clamp
    v_max_f32 v140, s73, v140
    v_max_f32 v141, s73, v141
    v_max_f32 v142, s73, v142
    v_max_f32 v143, s73, v143
    v_add_f32 v140, v140, v216
    v_add_f32 v141, v141, v217
    v_add_f32 v142, v142, v218
    v_add_f32 v143, v143, v219
    v_fma_f32 v216, v144, s72, v220
    v_fma_f32 v217, v145, s72, v220
    v_fma_f32 v218, v146, s72, v220
    v_fma_f32 v219, v147, s72, v220
    v_exp_f32 v216, v216 clamp
    v_exp_f32 v217, v217 clamp
    v_exp_f32 v218, v218 clamp
    v_exp_f32 v219, v219 clamp
    v_max_f32 v144, s73, v144
    v_max_f32 v145, s73, v145
    v_max_f32 v146, s73, v146
    v_max_f32 v147, s73, v147
    v_add_f32 v144, v144, v216
    v_add_f32 v145, v145, v217
    v_add_f32 v146, v146, v218
    v_add_f32 v147, v147, v219
    v_fma_f32 v216, v148, s72, v220
    v_fma_f32 v217, v149, s72, v220
    v_fma_f32 v218, v150, s72, v220
    v_fma_f32 v219, v151, s72, v220
    v_exp_f32 v216, v216 clamp
    v_exp_f32 v217, v217 clamp
    v_exp_f32 v218, v218 clamp
    v_exp_f32 v219, v219 clamp
    v_max_f32 v148, s73, v148
    v_max_f32 v149, s73, v149
    v_max_f32 v150, s73, v150
    v_max_f32 v151, s73, v151
    v_add_f32 v148, v148, v216
    v_add_f32 v149, v149, v217
    v_add_f32 v150, v150, v218
    v_add_f32 v151, v151, v219
    v_fma_f32 v216, v152, s72, v220
    v_fma_f32 v217, v153, s72, v220
    v_fma_f32 v218, v154, s72, v220
    v_fma_f32 v219, v155, s72, v220
    v_exp_f32 v216, v216 clamp
    v_exp_f32 v217, v217 clamp
    v_exp_f32 v218, v218 clamp
    v_exp_f32 v219, v219 clamp
    v_max_f32 v152, s73, v152
    v_max_f32 v153, s73, v153
    v_max_f32 v154, s73, v154
    v_max_f32 v155, s73, v155
    v_add_f32 v152, v152, v216
    v_add_f32 v153, v153, v217
    v_add_f32 v154, v154, v218
    v_add_f32 v155, v155, v219
    v_fma_f32 v216, v156, s72, v220
    v_fma_f32 v217, v157, s72, v220
    v_fma_f32 v218, v158, s72, v220
    v_fma_f32 v219, v159, s72, v220
    v_exp_f32 v216, v216 clamp
    v_exp_f32 v217, v217 clamp
    v_exp_f32 v218, v218 clamp
    v_exp_f32 v219, v219 clamp
    v_max_f32 v156, s73, v156
    v_max_f32 v157, s73, v157
    v_max_f32 v158, s73, v158
    v_max_f32 v159, s73, v159
    v_add_f32 v156, v156, v216
    v_add_f32 v157, v157, v217
    v_add_f32 v158, v158, v218
    v_add_f32 v159, v159, v219
    s_mov_b32 exec_lo, 0
    v_mov_b32 v140, 0
    v_mov_b32 v141, 0
    v_mov_b32 v142, 0
    v_mov_b32 v143, 0
    v_mov_b32 v156, 0
    v_mov_b32 v157, 0
    v_mov_b32 v158, 0
    v_mov_b32 v159, 0
    s_mov_b32 exec_lo, -1
    v_cvt_pk_bf16_f32 v176, v128, v129
    v_cvt_pk_bf16_f32 v177, v130, v131
    v_cvt_pk_bf16_f32 v178, v132, v133
    v_cvt_pk_bf16_f32 v179, v134, v135
    v_cvt_pk_bf16_f32 v180, v136, v137
    v_cvt_pk_bf16_f32 v181, v138, v139
    v_cvt_pk_bf16_f32 v182, v140, v141
    v_cvt_pk_bf16_f32 v183, v142, v143
    v_cvt_pk_bf16_f32 v184, v144, v145
    v_cvt_pk_bf16_f32 v185, v146, v147
    v_cvt_pk_bf16_f32 v186, v148, v149
    v_cvt_pk_bf16_f32 v187, v150, v151
    v_cvt_pk_bf16_f32 v188, v152, v153
    v_cvt_pk_bf16_f32 v189, v154, v155
    v_cvt_pk_bf16_f32 v190, v156, v157
    v_cvt_pk_bf16_f32 v191, v158, v159
    s_waitcnt vmcnt(0)
Lagain7:
    v_min3_u32 v12, v160, v163, v164
    v_min_u32 v12, v12, v167
    v_cmp_ne_u32 vcc, 0, v12
    s_nop 1
    s_cmp_eq_u64 vcc, exec
    s_cbranch_scc1 Lok8
    s_cmp_eq_u32 s71, 0
    s_cbranch_scc1 Lok8
    s_sub_u32 s71, s71, 1
    buffer_load_dwordx4 v[160:163], v1, s[20:23], s37 offen offset:0 sc1
    buffer_load_dwordx4 v[164:167], v1, s[20:23], s37 offen offset:1024 sc1
    s_waitcnt vmcnt(0)
    s_branch Lagain7
Lok8:
    v_mfma_f32_32x32x16_bf16 v[16:31], v[160:163], v[176:179], 0
    v_mfma_f32_32x32x16_bf16 v[32:47], v[160:163], v[184:187], 0
    v_mfma_f32_32x32x16_bf16 v[16:31], v[164:167], v[180:183], v[16:31]
    v_mfma_f32_32x32x16_bf16 v[32:47], v[164:167], v[188:191], v[32:47]
    s_lshl2_add_u32 s67, s5, s4
    s_lshl3_add_u32 s67, s67, s6
    s_lshl_b32 s67, s67, 12
    s_add_u32 s67, s67, 0x700000
    s_nop 6
    v_add_f32 v16, v16, v20
    v_add_f32 v40, v40, v44
    v_add_f32 v17, v17, v21
    v_add_f32 v41, v41, v45
    v_add_f32 v18, v18, v22
    v_add_f32 v42, v42, v46
    v_add_f32 v19, v19, v23
    v_add_f32 v43, v43, v47
    v_add_f32 v16, v16, v18
    v_add_f32 v40, v40, v42
    v_add_f32 v17, v17, v19
    v_add_f32 v41, v41, v43
    v_add_f32 v16, v16, v17
    v_add_f32 v40, v40, v41
    v_mov_b32 v17, v16
    v_mov_b32 v41, v40
    s_nop 0
    v_permlane32_swap_b32 v16, v17
    v_permlane32_swap_b32 v40, v41
    v_add_f32 v16, v16, v17
    v_add_f32 v40, v40, v41
    v_add_f32 v16, s73, v16
    v_add_f32 v40, s73, v40
    v_rcp_f32 v16, v16
    v_rcp_f32 v40, v40
    v_mul_f32 v16, 0x3eeff558, v16
    v_mul_f32 v40, 0x3eeff558, v40
    v_mul_f32 v128, v16, v128
    v_mul_f32 v129, v16, v129
    v_mul_f32 v130, v16, v130
    v_mul_f32 v131, v16, v131
    v_mul_f32 v132, v16, v132
    v_mul_f32 v133, v16, v133
    v_mul_f32 v134, v16, v134
    v_mul_f32 v135, v16, v135
    v_cvt_pk_bf16_f32 v176, v128, v129
    v_cvt_pk_bf16_f32 v177, v130, v131
    v_cvt_pk_bf16_f32 v178, v132, v133
    v_cvt_pk_bf16_f32 v179, v134, v135
    buffer_store_dwordx4 v[176:179], v1, s[20:23], s67 offen offset:0 sc1
    v_mul_f32 v136, v16, v136
    v_mul_f32 v137, v16, v137
    v_mul_f32 v138, v16, v138
    v_mul_f32 v139, v16, v139
    v_mul_f32 v140, v16, v140
    v_mul_f32 v141, v16, v141
    v_mul_f32 v142, v16, v142
    v_mul_f32 v143, v16, v143
    v_cvt_pk_bf16_f32 v180, v136, v137
    v_cvt_pk_bf16_f32 v181, v138, v139
    v_cvt_pk_bf16_f32 v182, v140, v141
    v_cvt_pk_bf16_f32 v183, v142, v143
    buffer_store_dwordx4 v[180:183], v1, s[20:23], s67 offen offset:1024 sc1
    v_mul_f32 v144, v40, v144
    v_mul_f32 v145, v40, v145
    v_mul_f32 v146, v40, v146
    v_mul_f32 v147, v40, v147
    v_mul_f32 v148, v40, v148
    v_mul_f32 v149, v40, v149
    v_mul_f32 v150, v40, v150
    v_mul_f32 v151, v40, v151
    v_cvt_pk_bf16_f32 v184, v144, v145
    v_cvt_pk_bf16_f32 v185, v146, v147
    v_cvt_pk_bf16_f32 v186, v148, v149
    v_cvt_pk_bf16_f32 v187, v150, v151
    buffer_store_dwordx4 v[184:187], v1, s[20:23], s67 offen offset:2048 sc1
    v_mul_f32 v152, v40, v152
    v_mul_f32 v153, v40, v153
    v_mul_f32 v154, v40, v154
    v_mul_f32 v155, v40, v155
    v_mul_f32 v156, v40, v156
    v_mul_f32 v157, v40, v157
    v_mul_f32 v158, v40, v158
    v_mul_f32 v159, v40, v159
    v_cvt_pk_bf16_f32 v188, v152, v153
    v_cvt_pk_bf16_f32 v189, v154, v155
    v_cvt_pk_bf16_f32 v190, v156, v157
    v_cvt_pk_bf16_f32 v191, v158, v159
    buffer_store_dwordx4 v[188:191], v1, s[20:23], s67 offen offset:3072 sc1
    s_waitcnt vmcnt(0)
    v_mov_b32 v2, 1
    s_mov_b64 exec, 1
    buffer_store_dword v2, off, s[20:23], s70 sc1
    s_mov_b64 exec, -1
    s_cmp_lg_u32 s7, 7
    s_cbranch_scc1 L_fin
    s_endpgm
    .p2align 10
L_fin:
    v_bfe_u32 v14, v0, 3, 1
    v_lshrrev_b32 v15, 5, v0
    v_lshl_add_u32 v14, v15, 1, v14
    v_bfe_u32 v15, v0, 4, 1
    v_lshl_add_u32 v10, v15, 2, v14
    v_and_b32 v11, 7, v0
    v_lshlrev_b32 v12, 4, v11
    v_mul_u32_u24 v13, 896, v10
    v_add_u32 v13, v13, v12
    s_lshl3_add_u32 s67, s66, s4
    s_mul_i32 s67, s67, 7168
    s_lshl_b32 s68, s7, 7
    s_add_u32 s67, s67, s68
    s_add_u32 s69, s67, 28672
    buffer_load_dwordx4 v[16:19], v13, s[8:11], s67 offen
    buffer_load_dwordx4 v[20:23], v13, s[8:11], s69 offen
    buffer_load_dwordx4 v[24:27], v12, s[32:35], s68 offen
    v_lshl_add_u32 v14, v14, 1, v15
    v_lshlrev_b32 v14, 7, v14
    v_and_b32 v15, 3, v0
    v_lshl_add_u32 v14, v15, 5, v14
    v_lshrrev_b32 v15, 2, v11
    v_mul_u32_u24 v15, 4112, v15
    s_lshl_b32 s36, s4, 10
    v_add3_u32 v14, v14, v15, s36
    s_mov_b32 s72, 0x40088e99
    s_waitcnt vmcnt(0)
    v_lshlrev_b32 v28, 16, v24
    v_and_b32 v29, 0xffff0000, v24
    v_lshlrev_b32 v30, 16, v25
    v_and_b32 v31, 0xffff0000, v25
    v_lshlrev_b32 v32, 16, v26
    v_and_b32 v33, 0xffff0000, v26
    v_lshlrev_b32 v34, 16, v27
    v_and_b32 v35, 0xffff0000, v27
    v_lshlrev_b32 v36, 16, v16
    v_and_b32 v37, 0xffff0000, v16
    v_add_f32 v36, v36, v28
    v_add_f32 v37, v37, v29
    v_lshlrev_b32 v38, 16, v17
    v_and_b32 v39, 0xffff0000, v17
    v_add_f32 v38, v38, v30
    v_add_f32 v39, v39, v31
    v_lshlrev_b32 v40, 16, v18
    v_and_b32 v41, 0xffff0000, v18
    v_add_f32 v40, v40, v32
    v_add_f32 v41, v41, v33
    v_lshlrev_b32 v42, 16, v19
    v_and_b32 v43, 0xffff0000, v19
    v_add_f32 v42, v42, v34
    v_add_f32 v43, v43, v35
    v_lshlrev_b32 v44, 16, v20
    v_and_b32 v45, 0xffff0000, v20
    v_add_f32 v44, v44, v28
    v_add_f32 v45, v45, v29
    v_lshlrev_b32 v46, 16, v21
    v_and_b32 v47, 0xffff0000, v21
    v_add_f32 v46, v46, v30
    v_add_f32 v47, v47, v31
    v_lshlrev_b32 v48, 16, v22
    v_and_b32 v49, 0xffff0000, v22
    v_add_f32 v48, v48, v32
    v_add_f32 v49, v49, v33
    v_lshlrev_b32 v50, 16, v23
    v_and_b32 v51, 0xffff0000, v23
    v_add_f32 v50, v50, v34
    v_add_f32 v51, v51, v35
    s_barrier
    s_barrier
    ds_read_b128 v[64:67], v14 offset:0
    ds_read_b128 v[68:71], v14 offset:16
    ds_read_b128 v[72:75], v14 offset:16448
    ds_read_b128 v[76:79], v14 offset:16464
    ds_read_b128 v[80:83], v14 offset:32896
    ds_read_b128 v[84:87], v14 offset:32912
    ds_read_b128 v[88:91], v14 offset:49344
    ds_read_b128 v[92:95], v14 offset:49360
    s_waitcnt lgkmcnt(4)
    v_pk_add_f32 v[64:65], v[64:65], v[72:73]
    v_pk_add_f32 v[66:67], v[66:67], v[74:75]
    v_pk_add_f32 v[68:69], v[68:69], v[76:77]
    v_pk_add_f32 v[70:71], v[70:71], v[78:79]
    s_waitcnt lgkmcnt(0)
    v_pk_add_f32 v[80:81], v[80:81], v[88:89]
    v_pk_add_f32 v[82:83], v[82:83], v[90:91]
    v_pk_add_f32 v[84:85], v[84:85], v[92:93]
    v_pk_add_f32 v[86:87], v[86:87], v[94:95]
    v_pk_add_f32 v[64:65], v[64:65], v[80:81]
    v_pk_add_f32 v[66:67], v[66:67], v[82:83]
    v_pk_add_f32 v[68:69], v[68:69], v[84:85]
    v_pk_add_f32 v[70:71], v[70:71], v[86:87]
    v_pk_fma_f32 v[64:65], v[64:65], s[72:73], v[36:37] op_sel_hi:[1,0,1]
    v_pk_fma_f32 v[66:67], v[66:67], s[72:73], v[38:39] op_sel_hi:[1,0,1]
    v_pk_fma_f32 v[68:69], v[68:69], s[72:73], v[40:41] op_sel_hi:[1,0,1]
    v_pk_fma_f32 v[70:71], v[70:71], s[72:73], v[42:43] op_sel_hi:[1,0,1]
    v_cvt_pk_bf16_f32 v72, v64, v65
    v_cvt_pk_bf16_f32 v73, v66, v67
    v_cvt_pk_bf16_f32 v74, v68, v69
    v_cvt_pk_bf16_f32 v75, v70, v71
    buffer_store_dwordx4 v[72:75], v13, s[24:27], s67 offen sc0 sc1
    s_barrier
    ds_read_b128 v[96:99], v14 offset:8224
    ds_read_b128 v[100:103], v14 offset:8240
    ds_read_b128 v[104:107], v14 offset:24672
    ds_read_b128 v[108:111], v14 offset:24688
    ds_read_b128 v[112:115], v14 offset:41120
    ds_read_b128 v[116:119], v14 offset:41136
    ds_read_b128 v[120:123], v14 offset:57568
    ds_read_b128 v[124:127], v14 offset:57584
    s_waitcnt lgkmcnt(4)
    v_pk_add_f32 v[96:97], v[96:97], v[104:105]
    v_pk_add_f32 v[98:99], v[98:99], v[106:107]
    v_pk_add_f32 v[100:101], v[100:101], v[108:109]
    v_pk_add_f32 v[102:103], v[102:103], v[110:111]
    s_waitcnt lgkmcnt(0)
    v_pk_add_f32 v[112:113], v[112:113], v[120:121]
    v_pk_add_f32 v[114:115], v[114:115], v[122:123]
    v_pk_add_f32 v[116:117], v[116:117], v[124:125]
    v_pk_add_f32 v[118:119], v[118:119], v[126:127]
    v_pk_add_f32 v[96:97], v[96:97], v[112:113]
    v_pk_add_f32 v[98:99], v[98:99], v[114:115]
    v_pk_add_f32 v[100:101], v[100:101], v[116:117]
    v_pk_add_f32 v[102:103], v[102:103], v[118:119]
    v_pk_fma_f32 v[96:97], v[96:97], s[72:73], v[44:45] op_sel_hi:[1,0,1]
    v_pk_fma_f32 v[98:99], v[98:99], s[72:73], v[46:47] op_sel_hi:[1,0,1]
    v_pk_fma_f32 v[100:101], v[100:101], s[72:73], v[48:49] op_sel_hi:[1,0,1]
    v_pk_fma_f32 v[102:103], v[102:103], s[72:73], v[50:51] op_sel_hi:[1,0,1]
    v_cvt_pk_bf16_f32 v104, v96, v97
    v_cvt_pk_bf16_f32 v105, v98, v99
    v_cvt_pk_bf16_f32 v106, v100, v101
    v_cvt_pk_bf16_f32 v107, v102, v103
    buffer_store_dwordx4 v[104:107], v13, s[24:27], s69 offen sc0 sc1
    s_endpgm
L_end:
    s_endpgm
.section .rodata,"a"
.p2align 6
.amdhsa_kernel parallel_sum__linear_attn_block__dense_activation_gelu__prompt_kernel
  .amdhsa_next_free_vgpr 256
  .amdhsa_next_free_sgpr 102
  .amdhsa_accum_offset 256
  .amdhsa_group_segment_fixed_size 0
  .amdhsa_kernarg_size 88
  .amdhsa_user_sgpr_count 2
  .amdhsa_user_sgpr_kernarg_segment_ptr 1
  .amdhsa_system_sgpr_workgroup_id_x 1
.end_amdhsa_kernel
```
